```python
import torch

def _softmax(x, axis=-1):
    return torch.softmax(x, dim=axis)
def _gelu(x):
    return torch.nn.functional.gelu(x, approximate="tanh")
def _silu(x):
    return torch.nn.functional.silu(x)
def _sigmoid(x):
    return torch.sigmoid(x)
def _layernorm(x, axis=-1, eps=1e-5):
    m = x.mean(dim=axis, keepdim=True)
    v = x.var(dim=axis, keepdim=True, unbiased=False)
    return (x - m) / torch.sqrt(v + eps)
def _scatter_add(tgt, idx, src, axis=0):
    return tgt.clone().index_add_(axis, idx, src)
def _segment_sum(src, seg, n):
    out = torch.zeros((n,) + src.shape[1:], dtype=src.dtype)
    return out.index_add_(0, seg, src)
def _pad(x, pw):
    flat = tuple(v for pair in reversed(pw) for v in pair)
    return torch.nn.functional.pad(x, flat)

kernel_name = 'gated_mix__linear_kernel_hedgehog__glu_gated_geglu__prompt'

def setup_inputs():

    _w = (lambda a: (lambda t: t.to(torch.bfloat16) if t.is_floating_point() else t)(torch.as_tensor(a)))
    def _A_setup():
        B, S, D, H = 1, 2048, 512, 32
        Dh = D // H
        return {
            "x": _w((lambda *s: torch.randn(*s, dtype=torch.bfloat16) * 0.05)(B, S, D)),
            "wqkv": _w((lambda *s: torch.randn(*s, dtype=torch.bfloat16) * 0.8)(D, 3 * D)),
            "w_phi": _w((lambda *s: torch.randn(*s, dtype=torch.bfloat16) * 0.8)(H, Dh, Dh) * (Dh ** -0.5)),
            "wo": _w((lambda *s: torch.randn(*s, dtype=torch.bfloat16) * 0.05)(D, D)),
        }
    _A_in = _A_setup()

    def _B_setup():
        B, S, Dm, Df = 1, 2048, 512, 1376
        return {
            "x": _w((lambda *s: torch.randn(*s, dtype=torch.bfloat16) * 0.05)(B, S, Dm)),
            "w_gate": _w((lambda *s: torch.randn(*s, dtype=torch.bfloat16) * 1.6)(Dm, Df) * (Dm ** -0.5)),
            "w_up": _w((lambda *s: torch.randn(*s, dtype=torch.bfloat16) * 1.6)(Dm, Df) * (Dm ** -0.5)),
            "w_down": _w((lambda *s: torch.randn(*s, dtype=torch.bfloat16) * 1.6)(Df, Dm) * (Df ** -0.5)),
        }
    _B_in = _B_setup()

    return {
        "A_x": _A_in["x"],
        "A_wqkv": _A_in["wqkv"],
        "A_w_phi": _A_in["w_phi"],
        "A_wo": _A_in["wo"],
        "B_x": _B_in["x"],
        "B_w_gate": _B_in["w_gate"],
        "B_w_up": _B_in["w_up"],
        "B_w_down": _B_in["w_down"],
        "gate_w": _w((lambda *s: torch.randn(*s, dtype=torch.bfloat16) * 0.05)(512) * 16.0),
    }

def reference(A_x, A_wqkv, A_w_phi, A_wo, B_x, B_w_gate, B_w_up, B_w_down, gate_w):
    def _A_ref(x, wqkv, w_phi, wo):
        B, S, D = x.shape
        H = 32; Dh = D // H
        qkv = (lambda x, *d: x.permute(*d))((x @ wqkv).reshape(B, S, 3, H, Dh), 2, 0, 3, 1, 4)
        q, k, v = qkv[0], qkv[1], qkv[2]
        pq = torch.einsum("bhsd,hdf->bhsf", q, w_phi)
        pk = torch.einsum("bhsd,hdf->bhsf", k, w_phi)
        phi_q = torch.concatenate([_softmax(pq, axis=-1), _softmax(-pq, axis=-1)], axis=-1)
        phi_k = torch.concatenate([_softmax(pk, axis=-1), _softmax(-pk, axis=-1)], axis=-1)
        kv = torch.einsum("bhsf,bhsd->bhfd", phi_k, v)
        z  = torch.einsum("bhsf->bhf", phi_k)
        num = torch.einsum("bhqf,bhfd->bhqd", phi_q, kv)
        den = torch.einsum("bhqf,bhf->bhq", phi_q, z)[..., None] + 1e-6
        o = num / den
        return (lambda x, *d: x.permute(*d))(o, 0, 2, 1, 3).reshape(B, S, D) @ wo

    def _B_ref(x, w_gate, w_up, w_down):
        g = torch.einsum("bsd,df->bsf", x, w_gate)
        u = torch.einsum("bsd,df->bsf", x, w_up)
        h = _gelu(g) * u
        return torch.einsum("bsf,fd->bsd", h, w_down)

    x = A_x
    g = _sigmoid((x * gate_w).sum(-1, keepdims=True))
    a = _A_ref(x, A_wqkv, A_w_phi, A_wo)
    b = _B_ref(x, B_w_gate, B_w_up, B_w_down)
    return g * a + (1 - g) * b
```

```asm
; @launch grid=(256,1,1) block=(256,1,1) lds=163840
.amdgcn_target "amdgcn-amd-amdhsa--gfx950"
.text
.globl gated_mix__linear_kernel_hedgehog__glu_gated_geglu__prompt_kernel
.p2align 8
.type gated_mix__linear_kernel_hedgehog__glu_gated_geglu__prompt_kernel,@function
gated_mix__linear_kernel_hedgehog__glu_gated_geglu__prompt_kernel:
s_load_dwordx16 s[4:19], s[0:1], 0
s_load_dwordx8 s[20:27], s[0:1], 64
s_getpc_b64 s[92:93]
Lpc:
v_lshrrev_b32 v2, 6, v0
s_lshr_b32 s84, s2, 3
s_cmp_ge_u32 s84, 32
s_cbranch_scc1 Lend
v_readfirstlane_b32 s68, v2
v_and_b32 v1, 63, v0
s_and_b32 s3, s84, 7
s_mulk_i32 s3, 6272
v_min_u32 v2, 48, v0
v_lshl_add_u32 v2, v2, 7, s3
global_load_dword v58, v2, s[92:93]
s_and_b32 s3, s2, 4
s_lshr_b32 s69, s2, 5
s_lshl1_add_u32 s69, s3, s69
s_lshl2_add_u32 s3, s69, s68
s_lshl_b32 s74, s3, 15
s_lshl_b32 m0, s68, 12
v_lshrrev_b32 v4, 4, v1
v_lshrrev_b32 v2, 3, v1
v_and_b32 v3, 7, v1
v_xor_b32 v6, v3, v4
v_lshlrev_b32 v6, 4, v6
v_lshl_add_u32 v16, v2, 10, v6
s_movk_i32 s3, 7168
v_xad_u32 v17, v16, 64, s3
s_lshl_b32 s3, s3, 1
v_add_u32 v18, s3, v16
v_add_u32 v19, s3, v17
s_lshl_b32 s30, 1, 21
s_mov_b32 s31, 0x20000
s_waitcnt lgkmcnt(0)
s_mov_b64 s[28:29], s[4:5]
buffer_load_dwordx4 v16, s[28:31], s74 offen offset:0 lds
buffer_load_dwordx4 v17, s[28:31], s74 offen offset:1024 lds
buffer_load_dwordx4 v18, s[28:31], s74 offen offset:2048 lds
buffer_load_dwordx4 v19, s[28:31], s74 offen offset:3072 lds
Lwin:
s_and_b32 s83, s2, 7
s_mov_b32 s99, 0x20000
s_lshl_b32 s78, s68, 12
s_and_b32 s77, s68, 1
v_and_b32 v5, 1, v4
s_and_b32 s3, s83, 3
s_bfe_u32 s70, s84, 0x10001
s_lshl1_add_u32 s70, s3, s70
s_cmp_lt_u32 s68, 2
s_cselect_b64 s[32:33], s[14:15], s[16:17]
s_mov_b32 s34, 0x158000
s_mov_b32 s35, 0x20000
s_bitcmp0_b32 s2, 3
s_cbranch_scc1 LpathA
s_mul_i32 s71, s70, 7
s_mul_i32 s75, s77, 88064
s_lshl_b32 s3, s71, 5
s_add_u32 s75, s75, s3
s_mul_i32 s79, s68, 7680
v_mul_u32_u24 v8, 4682, v1
v_lshrrev_b32 v8, 16, v8
v_lshrrev_b32 v6, 2, v8
v_mul_u32_u24 v8, 2528, v8
v_lshl_add_u32 v8, v1, 4, v8
v_lshl_or_b32 v20, v6, 30, v8
v_add_u32 v21, 10112, v20
v_add_u32 v22, 20096, v20
v_add_u32 v23, 30208, v20
s_add_u32 m0, s79, 49152
s_nop 0
buffer_load_dwordx4 v20, s[32:35], s75 offen offset:0 lds
buffer_load_dwordx4 v21, s[32:35], s75 offen offset:896 lds
buffer_load_dwordx4 v22, s[32:35], s75 offen offset:1920 lds
buffer_load_dwordx4 v23, s[32:35], s75 offen offset:2816 lds
s_add_u32 m0, s79, 52992
s_add_u32 s75, s75, 44032
buffer_load_dwordx4 v20, s[32:35], s75 offen offset:0 lds
buffer_load_dwordx4 v21, s[32:35], s75 offen offset:896 lds
buffer_load_dwordx4 v22, s[32:35], s75 offen offset:1920 lds
buffer_load_dwordx4 v23, s[32:35], s75 offen offset:2816 lds
s_mov_b64 exec, 0
s_cmp_eq_u32 s68, 0
s_cbranch_scc1 LhopB0
s_cmp_eq_u32 s68, 1
s_cbranch_scc1 LhopB1
s_cmp_eq_u32 s68, 2
s_cbranch_scc1 LhopB2
s_branch LhopB3
LbackB:
s_mov_b64 exec, -1
s_branch LbodyB
LpathA:
s_lshr_b32 s100, s2, 4
s_cmp_ge_u32 s68, 2
s_cbranch_scc1 LtGa
s_lshr_b32 s101, s83, 2
s_and_b32 s3, s2, 3
s_cmp_eq_u32 s68, 0
s_cbranch_scc1 LtXa
s_lshl1_add_u32 s100, s100, s101
s_mulk_i32 s100, 24
s_add_u32 s100, s100, s3
s_add_u32 s100, s100, 4
s_lshl_b32 s100, s100, 8
s_add_u32 s101, s100, 786432
v_and_b32 v6, 1, v1
v_lshlrev_b32 v6, 7, v6
v_bfe_u32 v7, v1, 1, 1
v_lshl_or_b32 v6, v7, 10, v6
v_bfe_u32 v7, v1, 2, 1
v_lshl_or_b32 v7, v4, 6, v7
v_mul_u32_u24 v7, 3072, v7
v_bfe_u32 v8, v1, 3, 1
v_lshl_or_b32 v6, v8, 30, v6
v_add_u32 v57, v6, v7
s_mov_b32 s98, 0x180000
s_mov_b64 s[96:97], s[6:7]
s_branch LtTa
LtXa:
s_lshl4_add_u32 s100, s101, s100
s_lshl2_add_u32 s100, s100, s3
s_lshl_b32 s100, s100, 14
s_add_u32 s101, s100, 512
v_and_b32 v6, 15, v1
v_lshlrev_b32 v6, 10, v6
v_lshl_or_b32 v57, v4, 7, v6
s_mov_b32 s98, 0x200000
s_mov_b64 s[96:97], s[28:29]
s_branch LtTa
LtGa:
s_mulk_i32 s100, 11008
s_and_b32 s3, s2, 3
s_mulk_i32 s3, 448
s_add_u32 s100, s100, s3
s_add_u32 s101, s100, 704512
v_and_b32 v6, 3, v1
v_lshlrev_b32 v6, 7, v6
v_bfe_u32 v7, v1, 2, 2
v_lshl_or_b32 v7, v4, 6, v7
v_mul_u32_u24 v7, 2752, v7
v_add_u32 v57, v6, v7
s_mov_b32 s98, 0x158000
s_cmp_eq_u32 s68, 2
s_cselect_b64 s[96:97], s[14:15], s[16:17]
LtTa:
s_mov_b32 exec_hi, 0x0
s_cmp_lt_u32 s68, 2
s_cselect_b32 s93, s100, 0x20000000
buffer_load_dword v75, v57, s[96:99], s93 offen
s_mov_b64 exec, -1
s_mov_b32 exec_hi, 0xffff
s_cmp_ge_u32 s68, 2
s_cselect_b32 s93, s100, 0x20000000
buffer_load_dword v76, v57, s[96:99], s93 offen
s_mov_b64 exec, -1
s_mov_b32 s36, s6
s_mov_b32 s37, s7
s_mov_b32 s38, 0x180000
s_mov_b32 s39, 0x20000
s_lshr_b32 s76, s68, 1
s_lshl_b32 s3, s76, 2
v_lshlrev_b32 v6, 1, v5
v_xor_b32 v6, v3, v6
v_lshlrev_b32 v6, 4, v6
v_mul_u32_u24 v7, 3072, v2
v_add_u32 v20, v6, v7
v_xad_u32 v7, v6, 64, v7
v_add_u32 v21, 23552, v7
v_add_u32 v22, 47104, v20
v_add_u32 v23, 70656, v7
s_lshl_b32 s75, s76, 10
s_lshl_b32 s3, s70, 7
s_add_u32 s75, s75, s3
s_mul_i32 s3, s77, 98304
s_add_u32 s75, s75, s3
s_add_u32 s75, s75, 1024
s_add_u32 m0, s78, 49152
s_nop 0
buffer_load_dwordx4 v20, s[36:39], s75 offen offset:0 lds
buffer_load_dwordx4 v21, s[36:39], s75 offen offset:1024 lds
buffer_load_dwordx4 v22, s[36:39], s75 offen offset:2048 lds
buffer_load_dwordx4 v23, s[36:39], s75 offen offset:3072 lds
s_mov_b32 s64, s20
s_mov_b32 s65, s21
s_mov_b32 s66, 0x400
s_mov_b32 s67, 0x20000
s_lshl_b32 s3, s68, 8
s_add_u32 m0, s3, 162560
v_lshlrev_b32 v7, 4, v1
s_mov_b64 exec, 0xffff
buffer_load_dwordx4 v7, s[64:67], s3 offen lds
s_mov_b64 exec, -1
s_cmp_lg_u32 s69, 0
s_cbranch_scc1 Lnz
s_mov_b32 s48, s26
s_mov_b32 s49, s27
s_mov_b32 s50, 0x2000000
s_mov_b32 s51, 0x20000
s_lshl2_add_u32 s3, s70, s68
s_mul_i32 s3, s3, 4352
s_add_u32 s3, s3, 0x1f00000
v_lshlrev_b32 v7, 4, v3
v_lshl_add_u32 v8, v2, 8, v7
v_lshl_add_u32 v7, v2, 8, v7
v_mov_b32 v96, 0
v_mov_b32 v97, 0
v_mov_b32 v98, 0
v_mov_b32 v99, 0
buffer_store_dwordx4 v[96:99], v7, s[48:51], s3 offen sc1
s_add_u32 s3, s3, 2048
buffer_store_dwordx4 v[96:99], v7, s[48:51], s3 offen sc1
s_add_u32 s3, s3, 2048
buffer_store_dwordx4 v[96:99], v7, s[48:51], s3 offen sc1
s_lshl_b32 s3, s68, 14
s_add_u32 s3, s3, s70
s_lshl_b32 s3, s3, 11
s_add_u32 s3, s3, 0x1fc0000
buffer_store_dwordx4 v[96:99], v8, s[48:51], s3 offen sc1
Lnz:
s_mov_b32 exec_lo, 0x0
s_cmp_lt_u32 s68, 2
s_cselect_b32 s93, s100, 0x20000000
buffer_load_dword v77, v57, s[96:99], s93 offen
s_mov_b64 exec, -1
s_mov_b32 exec_lo, 0x0
s_mov_b32 exec_hi, 0xffff0000
s_cmp_ge_u32 s68, 2
s_cselect_b32 s93, s100, 0x20000000
buffer_load_dword v70, v57, s[96:99], s93 offen
s_mov_b64 exec, -1
s_branch LbodyA
.p2align 12
LbodyA:
s_mov_b64 exec, 0
s_cmp_eq_u32 s68, 0
s_cbranch_scc1 LhopA0
s_cmp_eq_u32 s68, 1
s_cbranch_scc1 LhopA1
s_cmp_eq_u32 s68, 2
s_cbranch_scc1 LhopA2
s_branch LhopA3
LbackA:
s_mov_b64 exec, -1
s_nop 0
s_add_u32 m0, s78, 16384
s_add_u32 s74, s74, 128
buffer_load_dwordx4 v16, s[28:31], s74 offen offset:0 lds
buffer_load_dwordx4 v17, s[28:31], s74 offen offset:1024 lds
buffer_load_dwordx4 v18, s[28:31], s74 offen offset:2048 lds
buffer_load_dwordx4 v19, s[28:31], s74 offen offset:3072 lds
s_add_u32 m0, s78, 65536
s_add_u32 s75, s75, 196608
buffer_load_dwordx4 v20, s[36:39], s75 offen offset:0 lds
buffer_load_dwordx4 v21, s[36:39], s75 offen offset:1024 lds
buffer_load_dwordx4 v22, s[36:39], s75 offen offset:2048 lds
buffer_load_dwordx4 v23, s[36:39], s75 offen offset:3072 lds
v_mul_u32_u24 v7, 2752, v2
v_add_u32_e64 v24, v6, v7
v_xad_u32 v7, v6, 64, v7
v_add_u32 v25, 20992, v7
v_add_u32 v26, 41984, v24
v_add_u32 v27, 62976, v7
s_cmp_eq_u32 s70, 3
s_cselect_b32 s3, 4, 0
v_and_b32 v7, s3, v3
v_xor_b32 v8, s3, v7
v_lshl_or_b32 v24, v7, 28, v24
v_lshl_or_b32 v25, v8, 28, v25
v_lshl_or_b32 v26, v7, 28, v26
v_lshl_or_b32 v27, v8, 28, v27
s_cmp_gt_u32 s70, 3
s_cselect_b32 s3, 54, 56
s_lshl2_add_u32 s71, s70, s3
s_lshl_b32 s76, s71, 5
s_mul_i32 s3, s77, 88064
s_add_u32 s76, s76, s3
s_and_b32 s83, s2, 7
s_lshr_b32 s84, s2, 3
s_lshl_b32 s72, s83, 2
s_lshr_b32 s3, s84, 3
s_add_u32 s72, s72, s3
s_and_b32 s3, s3, 1
s_xor_b32 s3, s3, s84
s_and_b32 s73, s3, 7
s_lshr_b32 s3, s2, 4
s_bfe_u32 s83, s2, 0x10002
s_lshl1_add_u32 s3, s3, s83
s_lshr_b32 s83, s98, 9
s_mul_i32 s3, s3, s83
s_lshl_b32 s3, s3, 4
s_and_b32 s0, s2, 3
s_lshl_b32 s0, s0, 8
s_add_u32 s3, s3, s0
s_movk_i32 s0, 1792
s_bitcmp1_b32 s2, 1
s_cselect_b32 s0, 1728, s0
s_cmp_ge_u32 s68, 2
s_cselect_b32 s0, s0, 0
s_add_u32 s3, s3, s0
s_cmp_eq_u32 s68, 0
s_cselect_b32 s3, 0x40000000, s3
v_lshrrev_b32 v8, 2, v1
v_and_b32 v9, 3, v1
v_lshlrev_b32_e64 v9, 7, v9
v_min_u32 v9, 252, v9
v_mad_u32_u24 v8, v8, s83, v9
v_add_u32 v52, s3, v8
v_lshlrev_b32 v6, 2, v5
v_xor_b32 v6, v3, v6
v_lshlrev_b32 v7, 4, v6
v_and_b32 v6, 6, v2
v_xor_b32 v6, v3, v6
v_lshlrev_b32_e64 v6, 4, v6
v_lshl_add_u32 v44, v2, 10, v6
v_add_u32 v45, 7168, v44
v_add_u32 v46, 63488, v44
v_add_u32 v47, 63488, v45
s_mov_b32 s40, s18
s_mov_b32 s41, s19
s_mov_b32 s42, 0x158000
s_mov_b32 s43, 0x20000
s_mov_b32 s44, s10
s_mov_b32 s45, s11
s_mov_b32 s46, 0x80000
s_mov_b32 s47, 0x20000
s_mov_b32 s48, s26
s_mov_b32 s49, s27
s_mov_b32 s50, 0x2000000
s_mov_b32 s51, 0x20000
s_mov_b32 s52, s24
s_mov_b32 s53, s25
s_mov_b32 s54, 0x100
s_mov_b32 s55, 0x20000
s_mov_b32 s56, s22
s_mov_b32 s57, s23
s_mov_b32 s58, 0x200000
s_mov_b32 s59, 0x20000
s_mov_b32 s60, s8
s_mov_b32 s61, s9
s_mov_b32 s62, 0x4000
s_mov_b32 s63, 0x20000
s_mov_b32 s64, s20
s_mov_b32 s65, s21
s_mov_b32 s66, 0x400
s_mov_b32 s67, 0x20000
v_lshlrev_b32 v14, 4, v1
v_lshrrev_b32 v6, 3, v0
v_lshlrev_b32_e64 v7, 7, v0
v_lshl_or_b32 v15, v6, 24, v7
s_mov_b32 s88, 0x3fb8aa3b
s_mov_b32 s89, 0x3fb8aa3b
s_mov_b32 s90, 0xbdd2d3e8
s_mov_b32 s91, 0xbdd2d3e8
v_mov_b32 v54, 0xc0135761
s_cmp_eq_u32 s68, 0
s_cselect_b32 s85, 0xffff, 0
s_cselect_b32 s87, 0xff, 0
s_mov_b32 s85, 1
s_lshl_b32 s81, s68, 14
s_lshl_b32 s3, s73, 7
s_add_u32 s81, s81, s3
s_lshl2_add_u32 s3, s70, s68
s_mul_i32 s3, s3, 4352
s_add_u32 s82, s3, 0x1f00000
v_and_b32 v2, 15, v1
v_lshrrev_b32 v3, 4, v1
v_lshrrev_b32 v6, 1, v2
v_xor_b32 v6, v3, v6
v_lshlrev_b32_e64 v6, 4, v6
v_lshl_add_u32 v6, v2, 7, v6
v_bfe_u32 v4, v1, 2, 2
v_lshrrev_b32_e64 v9, 1, v4
v_lshl_or_b32 v9, v5, 1, v9
v_and_b32 v7, 1, v1
v_lshlrev_b32 v7, 4, v7
v_and_b32_e64 v8, 2, v1
v_lshl_or_b32 v7, v8, 2, v7
v_lshl_add_u32 v8, v3, 3, v4
s_lshr_b32 s3, s68, 1
s_lshl_b32 s3, s3, 13
v_add_u32 v28, s3, v6
v_xor_b32 v29, 64, v28
s_lshl_b32 s3, s77, 1
v_xor_b32 v9, s3, v9
v_lshl_add_u32 v9, v9, 5, v7
v_lshl_add_u32 v9, v8, 7, v9
v_add_u32 v32, 49152, v9
v_xor_b32_e64 v33, 32, v32
v_add_u32 v34, 98304, v9
v_xor_b32 v35, 32, v34
s_lshl_b32 s3, s70, 2
s_add_u32 s3, s3, s68
s_lshl_b32 s3, s3, 2
v_bfe_u32 v2, v1, 3, 2
v_add_u32 v2, s3, v2
v_and_b32 v3, 7, v1
v_bfe_u32 v4, v2, 1, 3
v_xor_b32 v4, v3, v4
v_lshlrev_b32 v4, 4, v4
v_lshl_add_u32 v78, v2, 7, v4
v_lshlrev_b32_e64 v3, 4, v3
v_add_u32 v79, 162560, v3
v_mov_b32 v74, 0
s_lshl_b32 s79, s69, 7
s_add_u32 s79, s79, s3
s_lshl_b32 s79, s79, 2
s_add_u32 s79, s79, 0x1f80000
s_waitcnt vmcnt(10)
s_barrier
ds_read_b128 a[0:3], v28 offset:0
ds_read_b64_tr_b16 v[80:81], v32 offset:0
ds_read_b64_tr_b16 v[82:83], v32 offset:512
ds_read_b128 a[4:7], v28 offset:2048
ds_read_b128 a[8:11], v28 offset:4096
ds_read_b128 a[12:15], v28 offset:6144
ds_read_b64_tr_b16 v[84:85], v33 offset:0
ds_read_b64_tr_b16 v[86:87], v33 offset:512
s_waitcnt lgkmcnt(5)
v_mfma_f32_16x16x32_bf16 v[128:131], v[80:83], a[0:3], 0
ds_read_b64_tr_b16 v[88:89], v32 offset:8192
ds_read_b128 v[112:115], v78 offset:0
ds_read_b128 v[116:119], v79 offset:0
s_waitcnt lgkmcnt(3)
v_mfma_f32_16x16x32_bf16 v[160:163], v[84:87], a[0:3], 0
ds_read_b64_tr_b16 v[90:91], v32 offset:8704
s_add_u32 m0, s78, 32768
s_add_u32 s74, s74, 128
buffer_load_dwordx4 v16, s[28:31], s74 offen offset:0 lds
v_and_b32 v2, 31, v1
v_lshrrev_b32 v3, 5, v1
v_mfma_f32_16x16x32_bf16 v[164:167], v[84:87], a[4:7], 0
ds_read_b64_tr_b16 v[92:93], v33 offset:8192
v_bfe_u32 v4, v1, 1, 2
v_mfma_f32_16x16x32_bf16 v[132:135], v[80:83], a[4:7], 0
ds_read_b64_tr_b16 v[94:95], v33 offset:8704
buffer_load_dwordx4 v17, s[28:31], s74 offen offset:1024 lds
v_lshlrev_b32_e64 v5, 1, v3
v_mfma_f32_16x16x32_bf16 v[144:147], v[80:83], a[8:11], 0
ds_read_b128 a[16:19], v29 offset:0
v_xor_b32_e64 v4, v4, v5
v_mfma_f32_16x16x32_bf16 v[176:179], v[84:87], a[8:11], 0
ds_read_b128 a[20:23], v29 offset:2048
v_lshlrev_b32_e64 v4, 4, v4
v_mfma_f32_16x16x32_bf16 v[180:183], v[84:87], a[12:15], 0
buffer_load_dwordx4 v18, s[28:31], s74 offen offset:2048 lds
v_lshl_add_u32 v4, v2, 6, v4
v_mfma_f32_16x16x32_bf16 v[148:151], v[80:83], a[12:15], 0
s_lshl_b32 s3, s77, 2
s_waitcnt lgkmcnt(4)
v_mfma_f32_16x16x32_bf16 v[136:139], v[88:91], a[0:3], 0
ds_read_b64_tr_b16 v[80:81], v32 offset:4096
s_lshr_b32 s83, s68, 1
s_waitcnt lgkmcnt(3)
v_mfma_f32_16x16x32_bf16 v[168:171], v[92:95], a[0:3], 0
ds_read_b64_tr_b16 v[82:83], v32 offset:4608
buffer_load_dwordx4 v19, s[28:31], s74 offen offset:3072 lds
s_add_u32 s83, s83, s3
v_mfma_f32_16x16x32_bf16 v[172:175], v[92:95], a[4:7], 0
ds_read_b64_tr_b16 v[84:85], v33 offset:4096
s_lshl_b32 s3, s83, 12
v_mfma_f32_16x16x32_bf16 v[140:143], v[88:91], a[4:7], 0
ds_read_b64_tr_b16 v[86:87], v33 offset:4608
s_add_u32 m0, s78, 81920
s_add_u32 s75, s75, 196608
buffer_load_dwordx4 v20, s[36:39], s75 offen offset:0 lds
s_add_u32 s3, s3, 49152
v_mfma_f32_16x16x32_bf16 v[152:155], v[88:91], a[8:11], 0
ds_read_b128 a[24:27], v29 offset:4096
v_add_u32_e64 v36, s3, v4
v_mfma_f32_16x16x32_bf16 v[184:187], v[92:95], a[8:11], 0
ds_read_b128 a[28:31], v29 offset:6144
v_xor_b32_e64 v37, 16, v36
v_mfma_f32_16x16x32_bf16 v[188:191], v[92:95], a[12:15], 0
buffer_load_dwordx4 v21, s[36:39], s75 offen offset:1024 lds
v_bfe_u32 v4, v1, 2, 1
v_mfma_f32_16x16x32_bf16 v[156:159], v[88:91], a[12:15], 0
v_xor_b32 v4, v4, v3
s_waitcnt lgkmcnt(4)
v_mfma_f32_16x16x32_bf16 v[128:131], v[80:83], a[16:19], v[128:131]
ds_read_b64_tr_b16 v[88:89], v32 offset:12288
v_dot2c_f32_bf16 v74, v112, v116
v_dot2c_f32_bf16 v74, v113, v117
s_waitcnt lgkmcnt(3)
v_mfma_f32_16x16x32_bf16 v[160:163], v[84:87], a[16:19], v[160:163]
ds_read_b64_tr_b16 v[90:91], v32 offset:12800
buffer_load_dwordx4 v22, s[36:39], s75 offen offset:2048 lds
v_dot2c_f32_bf16 v74, v114, v118
v_dot2c_f32_bf16 v74, v115, v119
v_mfma_f32_16x16x32_bf16 v[164:167], v[84:87], a[20:23], v[164:167]
ds_read_b64_tr_b16 v[92:93], v33 offset:12288
v_lshlrev_b32 v4, 4, v4
v_lshl_add_u32 v4, v2, 5, v4
v_mfma_f32_16x16x32_bf16 v[132:135], v[80:83], a[20:23], v[132:135]
ds_read_b64_tr_b16 v[94:95], v33 offset:12800
buffer_load_dwordx4 v23, s[36:39], s75 offen offset:3072 lds
s_lshl_b32 s3, s83, 11
s_add_u32 s3, s3, 81920
s_waitcnt lgkmcnt(5)
v_mfma_f32_16x16x32_bf16 v[144:147], v[80:83], a[24:27], v[144:147]
v_add_u32 v38, s3, v4
v_and_b32 v4, 15, v1
v_mfma_f32_16x16x32_bf16 v[176:179], v[84:87], a[24:27], v[176:179]
v_lshlrev_b32 v4, 2, v4
s_waitcnt lgkmcnt(4)
v_mfma_f32_16x16x32_bf16 v[180:183], v[84:87], a[28:31], v[180:183]
s_cmp_lt_u32 s68, 2
s_cselect_b32 s93, s101, 0x20000000
buffer_load_dword v71, v57, s[96:99], s93 offen
v_lshrrev_b32 v5, 4, v1
v_mfma_f32_16x16x32_bf16 v[148:151], v[80:83], a[28:31], v[148:151]
v_lshl_add_u32 v43, v5, 10, v4
s_waitcnt vmcnt(9) lgkmcnt(0)
s_barrier
v_mfma_f32_16x16x32_bf16 v[136:139], v[88:91], a[16:19], v[136:139]
ds_read_b128 a[32:35], v28 offset:16384
ds_read_b64_tr_b16 v[80:81], v32 offset:16384
s_lshl_b32 s0, s70, 2
s_or_b32 s1, s69, s68
s_cbranch_scc1 Lni
s_atomic_add s85, s[52:53], s0
Lni:
v_lshlrev_b32 v4, 2, v1
v_mfma_f32_16x16x32_bf16 v[168:171], v[92:95], a[16:19], v[168:171]
ds_read_b64_tr_b16 v[82:83], v32 offset:16896
ds_read_b128 a[36:39], v28 offset:18432
s_add_u32 m0, s78, 49152
s_add_u32 s75, s75, 196608
buffer_load_dwordx4 v20, s[36:39], s75 offen offset:0 lds
v_add_u32 v42, 4096, v4
v_mfma_f32_16x16x32_bf16 v[172:175], v[92:95], a[20:23], v[172:175]
ds_read_b128 a[40:43], v28 offset:20480
ds_read_b128 a[44:47], v28 offset:22528
v_bfe_u32 v5, v1, 2, 3
v_mfma_f32_16x16x32_bf16 v[140:143], v[88:91], a[20:23], v[140:143]
ds_read_b64_tr_b16 v[84:85], v33 offset:16384
ds_read_b64_tr_b16 v[86:87], v33 offset:16896
buffer_load_dwordx4 v21, s[36:39], s75 offen offset:1024 lds
v_lshrrev_b32_e64 v9, 1, v5
v_mfma_f32_16x16x32_bf16 v[152:155], v[88:91], a[24:27], v[152:155]
v_lshl_or_b32 v5, v3, 4, v5
v_mfma_f32_16x16x32_bf16 v[184:187], v[92:95], a[24:27], v[184:187]
v_bfe_u32 v6, v1, 1, 1
v_mfma_f32_16x16x32_bf16 v[188:191], v[92:95], a[28:31], v[188:191]
buffer_load_dwordx4 v22, s[36:39], s75 offen offset:2048 lds
v_xor_b32_e64 v8, v6, v9
v_mfma_f32_16x16x32_bf16 v[156:159], v[88:91], a[28:31], v[156:159]
v_lshlrev_b32 v8, 4, v8
s_waitcnt lgkmcnt(5)
v_mfma_f32_16x16x32_bf16 v[128:131], v[80:83], a[32:35], v[128:131]
ds_read_b64_tr_b16 v[88:89], v32 offset:24576
ds_read_b128 v[112:115], v78 offset:16384
ds_read_b128 v[116:119], v79 offset:128
s_waitcnt lgkmcnt(3)
v_mfma_f32_16x16x32_bf16 v[160:163], v[84:87], a[32:35], v[160:163]
ds_read_b64_tr_b16 v[90:91], v32 offset:25088
buffer_load_dwordx4 v23, s[36:39], s75 offen offset:3072 lds
v_and_b32 v7, 1, v1
v_lshl_add_u32 v8, v7, 3, v8
v_mfma_f32_16x16x32_bf16 v[164:167], v[84:87], a[36:39], v[164:167]
ds_read_b64_tr_b16 v[92:93], v33 offset:24576
v_lshl_add_u32 v8, v5, 6, v8
s_lshl_b32 s3, s68, 13
v_mfma_f32_16x16x32_bf16 v[132:135], v[80:83], a[36:39], v[132:135]
ds_read_b64_tr_b16 v[94:95], v33 offset:25088
s_add_u32 s3, s3, 49152
v_mfma_f32_16x16x32_bf16 v[144:147], v[80:83], a[40:43], v[144:147]
ds_read_b128 a[48:51], v29 offset:16384
v_add_u32 v39, s3, v8
v_mfma_f32_16x16x32_bf16 v[176:179], v[84:87], a[40:43], v[176:179]
ds_read_b128 a[52:55], v29 offset:18432
s_add_u32 m0, s78, 0
s_add_u32 s74, s74, 128
buffer_load_dwordx4 v16, s[28:31], s74 offen offset:0 lds
v_xor_b32 v41, 32, v39
v_mfma_f32_16x16x32_bf16 v[180:183], v[84:87], a[44:47], v[180:183]
v_lshrrev_b32_e64 v9, 1, v9
v_mfma_f32_16x16x32_bf16 v[148:151], v[80:83], a[44:47], v[148:151]
v_xor_b32 v9, v9, v7
s_waitcnt lgkmcnt(4)
v_mfma_f32_16x16x32_bf16 v[136:139], v[88:91], a[32:35], v[136:139]
ds_read_b64_tr_b16 v[80:81], v32 offset:20480
v_lshlrev_b32 v9, 4, v9
s_waitcnt lgkmcnt(3)
v_mfma_f32_16x16x32_bf16 v[168:171], v[92:95], a[32:35], v[168:171]
ds_read_b64_tr_b16 v[82:83], v32 offset:20992
buffer_load_dwordx4 v17, s[28:31], s74 offen offset:1024 lds
v_lshl_add_u32 v9, v6, 3, v9
v_mfma_f32_16x16x32_bf16 v[172:175], v[92:95], a[36:39], v[172:175]
ds_read_b64_tr_b16 v[84:85], v33 offset:20480
v_lshl_add_u32 v9, v5, 5, v9
v_mfma_f32_16x16x32_bf16 v[140:143], v[88:91], a[36:39], v[140:143]
ds_read_b64_tr_b16 v[86:87], v33 offset:20992
s_add_u32 s3, s78, 81920
v_mfma_f32_16x16x32_bf16 v[152:155], v[88:91], a[40:43], v[152:155]
ds_read_b128 a[56:59], v29 offset:20480
v_add_u32_e64 v40, s3, v9
v_mfma_f32_16x16x32_bf16 v[184:187], v[92:95], a[40:43], v[184:187]
ds_read_b128 a[60:63], v29 offset:22528
buffer_load_dwordx4 v18, s[28:31], s74 offen offset:2048 lds
v_bfe_u32 v2, v1, 2, 3
v_mfma_f32_16x16x32_bf16 v[188:191], v[92:95], a[44:47], v[188:191]
v_lshrrev_b32_e64 v3, 1, v2
v_mfma_f32_16x16x32_bf16 v[156:159], v[88:91], a[44:47], v[156:159]
v_and_b32 v4, 3, v1
s_waitcnt lgkmcnt(4)
v_mfma_f32_16x16x32_bf16 v[128:131], v[80:83], a[48:51], v[128:131]
ds_read_b64_tr_b16 v[88:89], v32 offset:28672
v_dot2c_f32_bf16 v74, v112, v116
v_dot2c_f32_bf16 v74, v113, v117
s_waitcnt lgkmcnt(3)
v_mfma_f32_16x16x32_bf16 v[160:163], v[84:87], a[48:51], v[160:163]
ds_read_b64_tr_b16 v[90:91], v32 offset:29184
buffer_load_dwordx4 v19, s[28:31], s74 offen offset:3072 lds
v_dot2c_f32_bf16 v74, v114, v118
v_dot2c_f32_bf16 v74, v115, v119
v_mfma_f32_16x16x32_bf16 v[164:167], v[84:87], a[52:55], v[164:167]
ds_read_b64_tr_b16 v[92:93], v33 offset:28672
v_lshlrev_b32 v4, 3, v4
v_lshl_add_u32 v4, v3, 5, v4
v_mfma_f32_16x16x32_bf16 v[132:135], v[80:83], a[52:55], v[132:135]
ds_read_b64_tr_b16 v[94:95], v33 offset:29184
v_lshl_add_u32 v4, v2, 7, v4
v_lshrrev_b32 v3, 5, v1
s_waitcnt lgkmcnt(5)
v_mfma_f32_16x16x32_bf16 v[144:147], v[80:83], a[56:59], v[144:147]
v_lshl_add_u32 v4, v3, 11, v4
v_add_u32_e64 v48, s78, v4
v_mfma_f32_16x16x32_bf16 v[176:179], v[84:87], a[56:59], v[176:179]
s_lshl_b32 s0, s68, 9
s_add_u32 m0, s0, 160512
s_lshl_b32 s1, s70, 11
s_add_u32 s0, s0, s1
s_mov_b32 exec_hi, 0
buffer_load_dwordx4 v14, s[60:63], s0 offen lds
s_mov_b32 exec_hi, -1
v_xor_b32_e64 v49, 32, v48
s_waitcnt lgkmcnt(4)
v_mfma_f32_16x16x32_bf16 v[180:183], v[84:87], a[60:63], v[180:183]
v_xor_b32_e64 v50, 64, v48
v_mfma_f32_16x16x32_bf16 v[148:151], v[80:83], a[60:63], v[148:151]
v_xor_b32 v51, 96, v48
ds_read_b32 v12, v14
s_waitcnt vmcnt(10) lgkmcnt(1)
s_barrier
v_mfma_f32_16x16x32_bf16 v[136:139], v[88:91], a[48:51], v[136:139]
ds_read_b128 a[64:67], v28 offset:32768
ds_read_b64_tr_b16 v[80:81], v32 offset:32768
v_lshrrev_b32_e64 v2, 3, v1
v_mfma_f32_16x16x32_bf16 v[168:171], v[92:95], a[48:51], v[168:171]
ds_read_b64_tr_b16 v[82:83], v32 offset:33280
ds_read_b128 a[68:71], v28 offset:34816
s_add_u32 m0, s78, 65536
s_add_u32 s75, s75, 196608
buffer_load_dwordx4 v20, s[36:39], s75 offen offset:0 lds
v_lshl_add_u32 v14, v2, 7, v14
v_mfma_f32_16x16x32_bf16 v[172:175], v[92:95], a[52:55], v[172:175]
ds_read_b128 a[72:75], v28 offset:36864
ds_read_b128 a[76:79], v28 offset:38912
s_lshl_b32 s60, s69, 8
v_mfma_f32_16x16x32_bf16 v[140:143], v[88:91], a[52:55], v[140:143]
ds_read_b64_tr_b16 v[84:85], v33 offset:32768
ds_read_b64_tr_b16 v[86:87], v33 offset:33280
s_add_u32 s60, s60, 0x1fc1800
v_mfma_f32_16x16x32_bf16 v[152:155], v[88:91], a[56:59], v[152:155]
s_lshl_b32 s61, s70, 8
v_mfma_f32_16x16x32_bf16 v[184:187], v[92:95], a[56:59], v[184:187]
buffer_load_dwordx4 v21, s[36:39], s75 offen offset:1024 lds
v_mfma_f32_16x16x32_bf16 v[188:191], v[92:95], a[60:63], v[188:191]
v_mfma_f32_16x16x32_bf16 v[156:159], v[88:91], a[60:63], v[156:159]
s_waitcnt lgkmcnt(5)
v_mfma_f32_16x16x32_bf16 v[128:131], v[80:83], a[64:67], v[128:131]
ds_read_b64_tr_b16 v[88:89], v32 offset:40960
ds_read_b128 v[112:115], v78 offset:32768
s_waitcnt lgkmcnt(2)
v_mfma_f32_16x16x32_bf16 v[160:163], v[84:87], a[64:67], v[160:163]
ds_read_b64_tr_b16 v[90:91], v32 offset:41472
buffer_load_dwordx4 v22, s[36:39], s75 offen offset:2048 lds
ds_read_b128 v[116:119], v79 offset:256
v_mfma_f32_16x16x32_bf16 v[164:167], v[84:87], a[68:71], v[164:167]
ds_read_b64_tr_b16 v[92:93], v33 offset:40960
s_add_u32 s61, s61, 0x1fc0000
v_mfma_f32_16x16x32_bf16 v[132:135], v[80:83], a[68:71], v[132:135]
ds_read_b64_tr_b16 v[94:95], v33 offset:41472
s_lshr_b32 s63, s72, 1
v_mfma_f32_16x16x32_bf16 v[144:147], v[80:83], a[72:75], v[144:147]
ds_read_b128 a[80:83], v29 offset:32768
s_lshl_b32 s63, s63, 8
v_mfma_f32_16x16x32_bf16 v[176:179], v[84:87], a[72:75], v[176:179]
ds_read_b128 a[84:87], v29 offset:34816
buffer_load_dwordx4 v23, s[36:39], s75 offen offset:3072 lds
s_add_u32 s63, s63, 0x1fc0800
v_mfma_f32_16x16x32_bf16 v[180:183], v[84:87], a[76:79], v[180:183]
s_lshr_b32 s64, s72, 1
v_mfma_f32_16x16x32_bf16 v[148:151], v[80:83], a[76:79], v[148:151]
s_lshl_b32 s64, s64, 8
s_waitcnt lgkmcnt(5)
v_mfma_f32_16x16x32_bf16 v[136:139], v[88:91], a[64:67], v[136:139]
ds_read_b64_tr_b16 v[80:81], v32 offset:36864
s_add_u32 s64, s64, 0x1fc2800
s_waitcnt lgkmcnt(3)
v_mfma_f32_16x16x32_bf16 v[168:171], v[92:95], a[64:67], v[168:171]
ds_read_b64_tr_b16 v[82:83], v32 offset:37376
s_add_u32 m0, s78, 16384
s_add_u32 s74, s74, 128
buffer_load_dwordx4 v16, s[28:31], s74 offen offset:0 lds
s_lshl_b32 s65, s72, 8
v_mfma_f32_16x16x32_bf16 v[172:175], v[92:95], a[68:71], v[172:175]
ds_read_b64_tr_b16 v[84:85], v33 offset:36864
s_add_u32 s65, s65, 0x1f80000
v_mfma_f32_16x16x32_bf16 v[140:143], v[88:91], a[68:71], v[140:143]
ds_read_b64_tr_b16 v[86:87], v33 offset:37376
s_lshl_b32 s66, s72, 16
v_mfma_f32_16x16x32_bf16 v[152:155], v[88:91], a[72:75], v[152:155]
ds_read_b128 a[88:91], v29 offset:36864
s_lshl_b32 s3, s73, 7
v_mfma_f32_16x16x32_bf16 v[184:187], v[92:95], a[72:75], v[184:187]
ds_read_b128 a[92:95], v29 offset:38912
buffer_load_dwordx4 v17, s[28:31], s74 offen offset:1024 lds
s_add_u32 s66, s66, s3
v_mfma_f32_16x16x32_bf16 v[188:191], v[92:95], a[76:79], v[188:191]
v_mfma_f32_16x16x32_bf16 v[156:159], v[88:91], a[76:79], v[156:159]
s_waitcnt lgkmcnt(4)
v_mfma_f32_16x16x32_bf16 v[128:131], v[80:83], a[80:83], v[128:131]
ds_read_b64_tr_b16 v[88:89], v32 offset:45056
v_dot2c_f32_bf16 v74, v112, v116
v_dot2c_f32_bf16 v74, v113, v117
s_waitcnt lgkmcnt(3)
v_mfma_f32_16x16x32_bf16 v[160:163], v[84:87], a[80:83], v[160:163]
ds_read_b64_tr_b16 v[90:91], v32 offset:45568
buffer_load_dwordx4 v18, s[28:31], s74 offen offset:2048 lds
v_dot2c_f32_bf16 v74, v114, v118
v_mfma_f32_16x16x32_bf16 v[164:167], v[84:87], a[84:87], v[164:167]
ds_read_b64_tr_b16 v[92:93], v33 offset:45056
v_dot2c_f32_bf16 v74, v115, v119
v_mfma_f32_16x16x32_bf16 v[132:135], v[80:83], a[84:87], v[132:135]
ds_read_b64_tr_b16 v[94:95], v33 offset:45568
s_add_u32 s67, s66, 32768
s_waitcnt lgkmcnt(5)
v_mfma_f32_16x16x32_bf16 v[144:147], v[80:83], a[88:91], v[144:147]
s_lshl_b32 s3, s69, 1
v_mfma_f32_16x16x32_bf16 v[176:179], v[84:87], a[88:91], v[176:179]
buffer_load_dwordx4 v19, s[28:31], s74 offen offset:3072 lds
s_lshr_b32 s83, s68, 1
s_waitcnt lgkmcnt(4)
v_mfma_f32_16x16x32_bf16 v[180:183], v[84:87], a[92:95], v[180:183]
s_add_u32 s3, s3, s83
v_mfma_f32_16x16x32_bf16 v[148:151], v[80:83], a[92:95], v[148:151]
s_mul_i32 s86, s3, 540672
ds_read_b32 v12, v14
s_waitcnt vmcnt(9) lgkmcnt(1)
s_barrier
v_mfma_f32_16x16x32_bf16 v[136:139], v[88:91], a[80:83], v[136:139]
ds_read_b128 a[96:99], v28 offset:0
ds_read_b64_tr_b16 v[80:81], v32 offset:0
s_lshl1_add_u32 s83, s70, s77
v_mfma_f32_16x16x32_bf16 v[168:171], v[92:95], a[80:83], v[168:171]
ds_read_b64_tr_b16 v[82:83], v32 offset:512
ds_read_b128 a[100:103], v28 offset:2048
s_add_u32 m0, s78, 81920
s_add_u32 s75, s75, 196608
buffer_load_dwordx4 v20, s[36:39], s75 offen offset:0 lds
s_lshl1_add_u32 s83, s83, 56
v_mfma_f32_16x16x32_bf16 v[172:175], v[92:95], a[84:87], v[172:175]
ds_read_b128 a[104:107], v28 offset:4096
ds_read_b128 a[108:111], v28 offset:6144
s_and_b32 s3, s83, 3
v_mfma_f32_16x16x32_bf16 v[140:143], v[88:91], a[84:87], v[140:143]
ds_read_b64_tr_b16 v[84:85], v33 offset:0
ds_read_b64_tr_b16 v[86:87], v33 offset:512
s_mul_i32 s3, s3, 33
v_mfma_f32_16x16x32_bf16 v[152:155], v[88:91], a[88:91], v[152:155]
s_lshr_b32 s6, s83, 2
v_mfma_f32_16x16x32_bf16 v[184:187], v[92:95], a[88:91], v[184:187]
buffer_load_dwordx4 v21, s[36:39], s75 offen offset:1024 lds
s_add_u32 s3, s3, s6
v_mfma_f32_16x16x32_bf16 v[188:191], v[92:95], a[92:95], v[188:191]
v_mfma_f32_16x16x32_bf16 v[156:159], v[88:91], a[92:95], v[156:159]
s_waitcnt lgkmcnt(5)
v_mfma_f32_16x16x32_bf16 v[128:131], v[80:83], a[96:99], v[128:131]
ds_read_b64_tr_b16 v[88:89], v32 offset:8192
ds_read_b128 v[112:115], v78 offset:0
s_waitcnt lgkmcnt(2)
v_mfma_f32_16x16x32_bf16 v[160:163], v[84:87], a[96:99], v[160:163]
ds_read_b64_tr_b16 v[90:91], v32 offset:8704
buffer_load_dwordx4 v22, s[36:39], s75 offen offset:2048 lds
ds_read_b128 v[116:119], v79 offset:384
v_mfma_f32_16x16x32_bf16 v[164:167], v[84:87], a[100:103], v[164:167]
ds_read_b64_tr_b16 v[92:93], v33 offset:8192
s_lshl_b32 s3, s3, 12
v_mfma_f32_16x16x32_bf16 v[132:135], v[80:83], a[100:103], v[132:135]
ds_read_b64_tr_b16 v[94:95], v33 offset:8704
s_add_u32 s6, s3, s86
v_mfma_f32_16x16x32_bf16 v[144:147], v[80:83], a[104:107], v[144:147]
ds_read_b128 a[112:115], v29 offset:0
s_add_u32 s83, s83, 1
v_mfma_f32_16x16x32_bf16 v[176:179], v[84:87], a[104:107], v[176:179]
ds_read_b128 a[116:119], v29 offset:2048
buffer_load_dwordx4 v23, s[36:39], s75 offen offset:3072 lds
s_and_b32 s3, s83, 3
v_mfma_f32_16x16x32_bf16 v[180:183], v[84:87], a[108:111], v[180:183]
s_mul_i32 s3, s3, 33
v_mfma_f32_16x16x32_bf16 v[148:151], v[80:83], a[108:111], v[148:151]
s_lshr_b32 s7, s83, 2
s_waitcnt lgkmcnt(5)
v_mfma_f32_16x16x32_bf16 v[136:139], v[88:91], a[96:99], v[136:139]
ds_read_b64_tr_b16 v[80:81], v32 offset:4096
s_add_u32 s3, s3, s7
s_waitcnt lgkmcnt(3)
v_mfma_f32_16x16x32_bf16 v[168:171], v[92:95], a[96:99], v[168:171]
ds_read_b64_tr_b16 v[82:83], v32 offset:4608
s_add_u32 m0, s78, 32768
s_add_u32 s74, s74, 128
buffer_load_dwordx4 v16, s[28:31], s74 offen offset:0 lds
s_lshl_b32 s3, s3, 12
v_mfma_f32_16x16x32_bf16 v[172:175], v[92:95], a[100:103], v[172:175]
ds_read_b64_tr_b16 v[84:85], v33 offset:4096
s_add_u32 s7, s3, s86
v_mfma_f32_16x16x32_bf16 v[140:143], v[88:91], a[100:103], v[140:143]
ds_read_b64_tr_b16 v[86:87], v33 offset:4608
s_lshl_b32 s3, s72, 2
v_mfma_f32_16x16x32_bf16 v[152:155], v[88:91], a[104:107], v[152:155]
ds_read_b128 a[120:123], v29 offset:4096
s_add_u32 s3, s3, s68
v_mfma_f32_16x16x32_bf16 v[184:187], v[92:95], a[104:107], v[184:187]
ds_read_b128 a[124:127], v29 offset:6144
buffer_load_dwordx4 v17, s[28:31], s74 offen offset:1024 lds
s_mul_i32 s86, s3, 135168
v_mfma_f32_16x16x32_bf16 v[188:191], v[92:95], a[108:111], v[188:191]
v_mfma_f32_16x16x32_bf16 v[156:159], v[88:91], a[108:111], v[156:159]
s_waitcnt lgkmcnt(4)
v_mfma_f32_16x16x32_bf16 v[128:131], v[80:83], a[112:115], v[128:131]
ds_read_b64_tr_b16 v[88:89], v32 offset:12288
v_dot2c_f32_bf16 v74, v112, v116
s_waitcnt lgkmcnt(3)
v_mfma_f32_16x16x32_bf16 v[160:163], v[84:87], a[112:115], v[160:163]
ds_read_b64_tr_b16 v[90:91], v32 offset:12800
buffer_load_dwordx4 v18, s[28:31], s74 offen offset:2048 lds
v_dot2c_f32_bf16 v74, v113, v117
v_mfma_f32_16x16x32_bf16 v[164:167], v[84:87], a[116:119], v[164:167]
ds_read_b64_tr_b16 v[92:93], v33 offset:12288
v_dot2c_f32_bf16 v74, v114, v118
v_mfma_f32_16x16x32_bf16 v[132:135], v[80:83], a[116:119], v[132:135]
ds_read_b64_tr_b16 v[94:95], v33 offset:12800
v_dot2c_f32_bf16 v74, v115, v119
s_waitcnt lgkmcnt(5)
v_mfma_f32_16x16x32_bf16 v[144:147], v[80:83], a[120:123], v[144:147]
v_mfma_f32_16x16x32_bf16 v[176:179], v[84:87], a[120:123], v[176:179]
buffer_load_dwordx4 v19, s[28:31], s74 offen offset:3072 lds
s_waitcnt lgkmcnt(4)
v_mfma_f32_16x16x32_bf16 v[180:183], v[84:87], a[124:127], v[180:183]
v_mfma_f32_16x16x32_bf16 v[148:151], v[80:83], a[124:127], v[148:151]
s_waitcnt vmcnt(8) lgkmcnt(0)
s_barrier
v_mfma_f32_16x16x32_bf16 v[136:139], v[88:91], a[112:115], v[136:139]
ds_read_b128 a[128:131], v28 offset:16384
ds_read_b64_tr_b16 v[80:81], v32 offset:16384
LhopA0:
s_cbranch_execz LhopA4
v_bfe_u32 v2, v1, 2, 2
v_mfma_f32_16x16x32_bf16 v[168:171], v[92:95], a[112:115], v[168:171]
ds_read_b64_tr_b16 v[82:83], v32 offset:16896
ds_read_b128 a[132:135], v28 offset:18432
s_add_u32 m0, s78, 49152
s_add_u32 s75, s75, 196608
buffer_load_dwordx4 v20, s[36:39], s75 offen offset:0 lds
v_lshrrev_b32 v3, 5, v1
v_mfma_f32_16x16x32_bf16 v[172:175], v[92:95], a[116:119], v[172:175]
ds_read_b128 a[136:139], v28 offset:20480
ds_read_b128 a[140:143], v28 offset:22528
v_lshl_add_u32 v3, v3, 2, v2
v_mfma_f32_16x16x32_bf16 v[140:143], v[88:91], a[116:119], v[140:143]
ds_read_b64_tr_b16 v[84:85], v33 offset:16384
ds_read_b64_tr_b16 v[86:87], v33 offset:16896
v_bfe_u32 v2, v1, 1, 1
v_mfma_f32_16x16x32_bf16 v[152:155], v[88:91], a[120:123], v[152:155]
v_and_b32_e64 v4, 16, v1
v_mfma_f32_16x16x32_bf16 v[184:187], v[92:95], a[120:123], v[184:187]
buffer_load_dwordx4 v21, s[36:39], s75 offen offset:1024 lds
v_lshl_add_u32 v4, v2, 3, v4
v_mfma_f32_16x16x32_bf16 v[188:191], v[92:95], a[124:127], v[188:191]
v_mfma_f32_16x16x32_bf16 v[156:159], v[88:91], a[124:127], v[156:159]
s_waitcnt lgkmcnt(5)
v_mfma_f32_16x16x32_bf16 v[128:131], v[80:83], a[128:131], v[128:131]
ds_read_b64_tr_b16 v[88:89], v32 offset:24576
ds_read_b128 v[112:115], v78 offset:16384
s_waitcnt lgkmcnt(2)
v_mfma_f32_16x16x32_bf16 v[160:163], v[84:87], a[128:131], v[160:163]
ds_read_b64_tr_b16 v[90:91], v32 offset:25088
buffer_load_dwordx4 v22, s[36:39], s75 offen offset:2048 lds
ds_read_b128 v[116:119], v79 offset:512
v_mfma_f32_16x16x32_bf16 v[164:167], v[84:87], a[132:135], v[164:167]
ds_read_b64_tr_b16 v[92:93], v33 offset:24576
v_lshl_add_u32 v4, v3, 5, v4
v_mfma_f32_16x16x32_bf16 v[132:135], v[80:83], a[132:135], v[132:135]
ds_read_b64_tr_b16 v[94:95], v33 offset:25088
s_lshl_b32 s3, s77, 10
v_mfma_f32_16x16x32_bf16 v[144:147], v[80:83], a[136:139], v[144:147]
ds_read_b128 a[144:147], v29 offset:16384
s_add_u32 s3, s3, 160512
v_mfma_f32_16x16x32_bf16 v[176:179], v[84:87], a[136:139], v[176:179]
ds_read_b128 a[148:151], v29 offset:18432
buffer_load_dwordx4 v23, s[36:39], s75 offen offset:3072 lds
v_add_u32 v4, s3, v4
v_mfma_f32_16x16x32_bf16 v[180:183], v[84:87], a[140:143], v[180:183]
v_mfma_f32_16x16x32_bf16 v[148:151], v[80:83], a[140:143], v[148:151]
ds_read_b64_tr_b16 v[60:61], v4 offset:0
s_waitcnt lgkmcnt(6)
v_mfma_f32_16x16x32_bf16 v[136:139], v[88:91], a[128:131], v[136:139]
ds_read_b64_tr_b16 v[80:81], v32 offset:20480
ds_read_b64_tr_b16 v[62:63], v4 offset:256
s_waitcnt lgkmcnt(5)
v_mfma_f32_16x16x32_bf16 v[168:171], v[92:95], a[128:131], v[168:171]
ds_read_b64_tr_b16 v[82:83], v32 offset:20992
s_add_u32 m0, s78, 0
s_add_u32 s74, s74, 128
buffer_load_dwordx4 v16, s[28:31], s74 offen offset:0 lds
ds_read_b64_tr_b16 v[64:65], v4 offset:512
v_mfma_f32_16x16x32_bf16 v[172:175], v[92:95], a[132:135], v[172:175]
ds_read_b64_tr_b16 v[84:85], v33 offset:20480
ds_read_b64_tr_b16 v[66:67], v4 offset:768
v_mfma_f32_16x16x32_bf16 v[140:143], v[88:91], a[132:135], v[140:143]
ds_read_b64_tr_b16 v[86:87], v33 offset:20992
v_bfe_u32 v6, v1, 2, 1
v_mfma_f32_16x16x32_bf16 v[152:155], v[88:91], a[136:139], v[152:155]
ds_read_b128 a[152:155], v29 offset:20480
v_mul_u32_u24 v6, 0x8000, v6
v_mfma_f32_16x16x32_bf16 v[184:187], v[92:95], a[136:139], v[184:187]
ds_read_b128 a[156:159], v29 offset:22528
buffer_load_dwordx4 v17, s[28:31], s74 offen offset:1024 lds
v_lshl_or_b32 v56, v6, 16, v6
v_mfma_f32_16x16x32_bf16 v[188:191], v[92:95], a[140:143], v[188:191]
v_mfma_f32_16x16x32_bf16 v[156:159], v[88:91], a[140:143], v[156:159]
s_waitcnt lgkmcnt(6)
v_mfma_f32_16x16x32_bf16 v[128:131], v[80:83], a[144:147], v[128:131]
ds_read_b64_tr_b16 v[88:89], v32 offset:28672
v_dot2c_f32_bf16 v74, v112, v116
s_waitcnt lgkmcnt(3)
v_mfma_f32_16x16x32_bf16 v[160:163], v[84:87], a[144:147], v[160:163]
ds_read_b64_tr_b16 v[90:91], v32 offset:29184
buffer_load_dwordx4 v18, s[28:31], s74 offen offset:2048 lds
v_dot2c_f32_bf16 v74, v113, v117
v_mfma_f32_16x16x32_bf16 v[164:167], v[84:87], a[148:151], v[164:167]
ds_read_b64_tr_b16 v[92:93], v33 offset:28672
v_dot2c_f32_bf16 v74, v114, v118
v_mfma_f32_16x16x32_bf16 v[132:135], v[80:83], a[148:151], v[132:135]
ds_read_b64_tr_b16 v[94:95], v33 offset:29184
v_dot2c_f32_bf16 v74, v115, v119
s_waitcnt lgkmcnt(5)
v_mfma_f32_16x16x32_bf16 v[144:147], v[80:83], a[152:155], v[144:147]
v_mfma_f32_16x16x32_bf16 v[176:179], v[84:87], a[152:155], v[176:179]
buffer_load_dwordx4 v19, s[28:31], s74 offen offset:3072 lds
s_waitcnt lgkmcnt(4)
v_mfma_f32_16x16x32_bf16 v[180:183], v[84:87], a[156:159], v[180:183]
v_mfma_f32_16x16x32_bf16 v[148:151], v[80:83], a[156:159], v[148:151]
s_waitcnt vmcnt(8) lgkmcnt(0)
s_barrier
v_mfma_f32_16x16x32_bf16 v[136:139], v[88:91], a[144:147], v[136:139]
ds_read_b128 a[160:163], v28 offset:32768
ds_read_b64_tr_b16 v[80:81], v32 offset:32768
v_xor_b32 v60, v60, v56
v_mfma_f32_16x16x32_bf16 v[168:171], v[92:95], a[144:147], v[168:171]
ds_read_b64_tr_b16 v[82:83], v32 offset:33280
ds_read_b128 a[164:167], v28 offset:34816
s_add_u32 m0, s78, 65536
s_add_u32 s75, s75, 196608
buffer_load_dwordx4 v20, s[36:39], s75 offen offset:0 lds
v_xor_b32_e64 v61, v61, v56
v_mfma_f32_16x16x32_bf16 v[172:175], v[92:95], a[148:151], v[172:175]
ds_read_b128 a[168:171], v28 offset:36864
ds_read_b128 a[172:175], v28 offset:38912
v_xor_b32_e64 v62, v62, v56
v_mfma_f32_16x16x32_bf16 v[140:143], v[88:91], a[148:151], v[140:143]
ds_read_b64_tr_b16 v[84:85], v33 offset:32768
ds_read_b64_tr_b16 v[86:87], v33 offset:33280
buffer_load_dwordx4 v21, s[36:39], s75 offen offset:1024 lds
v_xor_b32_e64 v63, v63, v56
v_mfma_f32_16x16x32_bf16 v[152:155], v[88:91], a[152:155], v[152:155]
v_mfma_f32_16x16x32_bf16 v[184:187], v[92:95], a[152:155], v[184:187]
v_mfma_f32_16x16x32_bf16 v[188:191], v[92:95], a[156:159], v[188:191]
buffer_load_dwordx4 v22, s[36:39], s75 offen offset:2048 lds
v_mfma_f32_16x16x32_bf16 v[156:159], v[88:91], a[156:159], v[156:159]
s_waitcnt lgkmcnt(5)
v_mfma_f32_16x16x32_bf16 v[128:131], v[80:83], a[160:163], v[128:131]
ds_read_b64_tr_b16 v[88:89], v32 offset:40960
ds_read_b128 v[112:115], v78 offset:32768
s_waitcnt lgkmcnt(2)
v_mfma_f32_16x16x32_bf16 v[160:163], v[84:87], a[160:163], v[160:163]
ds_read_b64_tr_b16 v[90:91], v32 offset:41472
buffer_load_dwordx4 v23, s[36:39], s75 offen offset:3072 lds
ds_read_b128 v[116:119], v79 offset:640
v_mfma_f32_16x16x32_bf16 v[164:167], v[84:87], a[164:167], v[164:167]
ds_read_b64_tr_b16 v[92:93], v33 offset:40960
v_xor_b32_e64 v64, v64, v56
v_mfma_f32_16x16x32_bf16 v[132:135], v[80:83], a[164:167], v[132:135]
ds_read_b64_tr_b16 v[94:95], v33 offset:41472
v_xor_b32_e64 v65, v65, v56
v_mfma_f32_16x16x32_bf16 v[144:147], v[80:83], a[168:171], v[144:147]
ds_read_b128 a[176:179], v29 offset:32768
v_xor_b32_e64 v66, v66, v56
v_mfma_f32_16x16x32_bf16 v[176:179], v[84:87], a[168:171], v[176:179]
ds_read_b128 a[180:183], v29 offset:34816
s_add_u32 m0, s78, 16384
s_add_u32 s74, s74, 128
buffer_load_dwordx4 v16, s[28:31], s74 offen offset:0 lds
v_xor_b32_e64 v67, v67, v56
v_mfma_f32_16x16x32_bf16 v[180:183], v[84:87], a[172:175], v[180:183]
v_mfma_f32_16x16x32_bf16 v[148:151], v[80:83], a[172:175], v[148:151]
s_waitcnt lgkmcnt(5)
v_mfma_f32_16x16x32_bf16 v[136:139], v[88:91], a[160:163], v[136:139]
ds_read_b64_tr_b16 v[80:81], v32 offset:36864
s_waitcnt lgkmcnt(3)
v_mfma_f32_16x16x32_bf16 v[168:171], v[92:95], a[160:163], v[168:171]
ds_read_b64_tr_b16 v[82:83], v32 offset:37376
buffer_load_dwordx4 v17, s[28:31], s74 offen offset:1024 lds
v_mfma_f32_16x16x32_bf16 v[172:175], v[92:95], a[164:167], v[172:175]
ds_read_b64_tr_b16 v[84:85], v33 offset:36864
v_mfma_f32_16x16x32_bf16 v[140:143], v[88:91], a[164:167], v[140:143]
ds_read_b64_tr_b16 v[86:87], v33 offset:37376
v_mfma_f32_16x16x32_bf16 v[152:155], v[88:91], a[168:171], v[152:155]
ds_read_b128 a[184:187], v29 offset:36864
v_mfma_f32_16x16x32_bf16 v[184:187], v[92:95], a[168:171], v[184:187]
ds_read_b128 a[188:191], v29 offset:38912
buffer_load_dwordx4 v18, s[28:31], s74 offen offset:2048 lds
v_mfma_f32_16x16x32_bf16 v[188:191], v[92:95], a[172:175], v[188:191]
v_mfma_f32_16x16x32_bf16 v[156:159], v[88:91], a[172:175], v[156:159]
s_waitcnt lgkmcnt(4)
v_mfma_f32_16x16x32_bf16 v[128:131], v[80:83], a[176:179], v[128:131]
ds_read_b64_tr_b16 v[88:89], v32 offset:45056
v_dot2c_f32_bf16 v74, v112, v116
s_waitcnt lgkmcnt(3)
v_mfma_f32_16x16x32_bf16 v[160:163], v[84:87], a[176:179], v[160:163]
ds_read_b64_tr_b16 v[90:91], v32 offset:45568
buffer_load_dwordx4 v19, s[28:31], s74 offen offset:3072 lds
v_dot2c_f32_bf16 v74, v113, v117
v_mfma_f32_16x16x32_bf16 v[164:167], v[84:87], a[180:183], v[164:167]
ds_read_b64_tr_b16 v[92:93], v33 offset:45056
v_dot2c_f32_bf16 v74, v114, v118
v_mfma_f32_16x16x32_bf16 v[132:135], v[80:83], a[180:183], v[132:135]
ds_read_b64_tr_b16 v[94:95], v33 offset:45568
v_dot2c_f32_bf16 v74, v115, v119
s_waitcnt lgkmcnt(5)
v_mfma_f32_16x16x32_bf16 v[144:147], v[80:83], a[184:187], v[144:147]
v_mfma_f32_16x16x32_bf16 v[176:179], v[84:87], a[184:187], v[176:179]
s_cmp_ge_u32 s68, 2
s_cselect_b32 s93, 0, 0x20000000
buffer_load_dword v68, v52, s[96:99], s93 offen
s_waitcnt lgkmcnt(4)
v_mfma_f32_16x16x32_bf16 v[180:183], v[84:87], a[188:191], v[180:183]
v_mfma_f32_16x16x32_bf16 v[148:151], v[80:83], a[188:191], v[148:151]
s_waitcnt vmcnt(9) lgkmcnt(0)
s_barrier
v_mfma_f32_16x16x32_bf16 v[136:139], v[88:91], a[176:179], v[136:139]
ds_read_b128 a[192:195], v28 offset:0
ds_read_b64_tr_b16 v[80:81], v32 offset:0
v_mfma_f32_16x16x32_bf16 v[168:171], v[92:95], a[176:179], v[168:171]
ds_read_b64_tr_b16 v[82:83], v32 offset:512
ds_read_b128 a[196:199], v28 offset:2048
v_mfma_f32_16x16x32_bf16 v[172:175], v[92:95], a[180:183], v[172:175]
ds_read_b128 a[200:203], v28 offset:4096
ds_read_b128 a[204:207], v28 offset:6144
v_mfma_f32_16x16x32_bf16 v[140:143], v[88:91], a[180:183], v[140:143]
ds_read_b64_tr_b16 v[84:85], v33 offset:0
ds_read_b64_tr_b16 v[86:87], v33 offset:512
v_mfma_f32_16x16x32_bf16 v[152:155], v[88:91], a[184:187], v[152:155]
v_mfma_f32_16x16x32_bf16 v[184:187], v[92:95], a[184:187], v[184:187]
v_mfma_f32_16x16x32_bf16 v[188:191], v[92:95], a[188:191], v[188:191]
v_mfma_f32_16x16x32_bf16 v[156:159], v[88:91], a[188:191], v[156:159]
s_waitcnt lgkmcnt(5)
v_mfma_f32_16x16x32_bf16 v[128:131], v[80:83], a[192:195], v[128:131]
ds_read_b64_tr_b16 v[88:89], v32 offset:8192
ds_read_b128 v[112:115], v78 offset:0
s_waitcnt lgkmcnt(2)
v_mfma_f32_16x16x32_bf16 v[160:163], v[84:87], a[192:195], v[160:163]
ds_read_b64_tr_b16 v[90:91], v32 offset:8704
ds_read_b128 v[116:119], v79 offset:768
v_mfma_f32_16x16x32_bf16 v[164:167], v[84:87], a[196:199], v[164:167]
ds_read_b64_tr_b16 v[92:93], v33 offset:8192
v_mfma_f32_16x16x32_bf16 v[132:135], v[80:83], a[196:199], v[132:135]
ds_read_b64_tr_b16 v[94:95], v33 offset:8704
v_mfma_f32_16x16x32_bf16 v[144:147], v[80:83], a[200:203], v[144:147]
ds_read_b128 a[208:211], v29 offset:0
v_mfma_f32_16x16x32_bf16 v[176:179], v[84:87], a[200:203], v[176:179]
ds_read_b128 a[212:215], v29 offset:2048
v_mfma_f32_16x16x32_bf16 v[180:183], v[84:87], a[204:207], v[180:183]
v_mfma_f32_16x16x32_bf16 v[148:151], v[80:83], a[204:207], v[148:151]
s_waitcnt lgkmcnt(5)
v_mfma_f32_16x16x32_bf16 v[136:139], v[88:91], a[192:195], v[136:139]
ds_read_b64_tr_b16 v[80:81], v32 offset:4096
s_waitcnt lgkmcnt(3)
v_mfma_f32_16x16x32_bf16 v[168:171], v[92:95], a[192:195], v[168:171]
ds_read_b64_tr_b16 v[82:83], v32 offset:4608
v_mfma_f32_16x16x32_bf16 v[172:175], v[92:95], a[196:199], v[172:175]
ds_read_b64_tr_b16 v[84:85], v33 offset:4096
v_mfma_f32_16x16x32_bf16 v[140:143], v[88:91], a[196:199], v[140:143]
ds_read_b64_tr_b16 v[86:87], v33 offset:4608
v_mfma_f32_16x16x32_bf16 v[152:155], v[88:91], a[200:203], v[152:155]
ds_read_b128 a[216:219], v29 offset:4096
v_mfma_f32_16x16x32_bf16 v[184:187], v[92:95], a[200:203], v[184:187]
ds_read_b128 a[220:223], v29 offset:6144
v_mfma_f32_16x16x32_bf16 v[188:191], v[92:95], a[204:207], v[188:191]
v_mfma_f32_16x16x32_bf16 v[156:159], v[88:91], a[204:207], v[156:159]
s_waitcnt lgkmcnt(4)
v_mfma_f32_16x16x32_bf16 v[128:131], v[80:83], a[208:211], v[128:131]
ds_read_b64_tr_b16 v[88:89], v32 offset:12288
v_dot2c_f32_bf16 v74, v112, v116
s_waitcnt lgkmcnt(3)
v_mfma_f32_16x16x32_bf16 v[160:163], v[84:87], a[208:211], v[160:163]
ds_read_b64_tr_b16 v[90:91], v32 offset:12800
v_dot2c_f32_bf16 v74, v113, v117
v_mfma_f32_16x16x32_bf16 v[164:167], v[84:87], a[212:215], v[164:167]
ds_read_b64_tr_b16 v[92:93], v33 offset:12288
v_dot2c_f32_bf16 v74, v114, v118
v_mfma_f32_16x16x32_bf16 v[132:135], v[80:83], a[212:215], v[132:135]
ds_read_b64_tr_b16 v[94:95], v33 offset:12800
v_dot2c_f32_bf16 v74, v115, v119
s_waitcnt lgkmcnt(5)
v_mfma_f32_16x16x32_bf16 v[144:147], v[80:83], a[216:219], v[144:147]
v_mfma_f32_16x16x32_bf16 v[176:179], v[84:87], a[216:219], v[176:179]
s_waitcnt lgkmcnt(4)
v_mfma_f32_16x16x32_bf16 v[180:183], v[84:87], a[220:223], v[180:183]
v_mfma_f32_16x16x32_bf16 v[148:151], v[80:83], a[220:223], v[148:151]
s_waitcnt vmcnt(1) lgkmcnt(0)
s_barrier
v_mfma_f32_16x16x32_bf16 v[136:139], v[88:91], a[208:211], v[136:139]
ds_read_b128 a[224:227], v28 offset:16384
ds_read_b64_tr_b16 v[80:81], v32 offset:16384
v_mfma_f32_16x16x32_bf16 v[168:171], v[92:95], a[208:211], v[168:171]
ds_read_b64_tr_b16 v[82:83], v32 offset:16896
ds_read_b128 a[228:231], v28 offset:18432
s_add_u32 m0, s78, 98304
s_nop 0
buffer_load_dwordx4 v24, s[32:35], s76 offen offset:0 lds
v_mfma_f32_16x16x32_bf16 v[172:175], v[92:95], a[212:215], v[172:175]
ds_read_b128 a[232:235], v28 offset:20480
ds_read_b128 a[236:239], v28 offset:22528
v_mfma_f32_16x16x32_bf16 v[140:143], v[88:91], a[212:215], v[140:143]
ds_read_b64_tr_b16 v[84:85], v33 offset:16384
ds_read_b64_tr_b16 v[86:87], v33 offset:16896
v_mfma_f32_16x16x32_bf16 v[152:155], v[88:91], a[216:219], v[152:155]
v_mfma_f32_16x16x32_bf16 v[184:187], v[92:95], a[216:219], v[184:187]
buffer_load_dwordx4 v25, s[32:35], s76 offen offset:1024 lds
v_mfma_f32_16x16x32_bf16 v[188:191], v[92:95], a[220:223], v[188:191]
v_mfma_f32_16x16x32_bf16 v[156:159], v[88:91], a[220:223], v[156:159]
s_waitcnt lgkmcnt(5)
v_mfma_f32_16x16x32_bf16 v[128:131], v[80:83], a[224:227], v[128:131]
ds_read_b64_tr_b16 v[88:89], v32 offset:24576
ds_read_b128 v[112:115], v78 offset:16384
s_waitcnt lgkmcnt(2)
v_mfma_f32_16x16x32_bf16 v[160:163], v[84:87], a[224:227], v[160:163]
ds_read_b64_tr_b16 v[90:91], v32 offset:25088
buffer_load_dwordx4 v26, s[32:35], s76 offen offset:2048 lds
ds_read_b128 v[116:119], v79 offset:896
v_mfma_f32_16x16x32_bf16 v[164:167], v[84:87], a[228:231], v[164:167]
ds_read_b64_tr_b16 v[92:93], v33 offset:24576
v_mfma_f32_16x16x32_bf16 v[132:135], v[80:83], a[228:231], v[132:135]
ds_read_b64_tr_b16 v[94:95], v33 offset:25088
v_mfma_f32_16x16x32_bf16 v[144:147], v[80:83], a[232:235], v[144:147]
ds_read_b128 a[240:243], v29 offset:16384
v_mfma_f32_16x16x32_bf16 v[176:179], v[84:87], a[232:235], v[176:179]
ds_read_b128 a[244:247], v29 offset:18432
buffer_load_dwordx4 v27, s[32:35], s76 offen offset:3072 lds
v_mfma_f32_16x16x32_bf16 v[180:183], v[84:87], a[236:239], v[180:183]
v_mfma_f32_16x16x32_bf16 v[148:151], v[80:83], a[236:239], v[148:151]
s_waitcnt lgkmcnt(5)
v_mfma_f32_16x16x32_bf16 v[136:139], v[88:91], a[224:227], v[136:139]
ds_read_b64_tr_b16 v[80:81], v32 offset:20480
v_lshrrev_b32 v59, 5, v15
buffer_load_dword v13, v59, s[52:55], 0 offen sc1
s_waitcnt lgkmcnt(3)
v_mfma_f32_16x16x32_bf16 v[168:171], v[92:95], a[224:227], v[168:171]
ds_read_b64_tr_b16 v[82:83], v32 offset:20992
s_add_u32 m0, s78, 114688
s_add_u32 s76, s76, 176128
buffer_load_dwordx4 v24, s[32:35], s76 offen offset:0 lds
v_mfma_f32_16x16x32_bf16 v[172:175], v[92:95], a[228:231], v[172:175]
ds_read_b64_tr_b16 v[84:85], v33 offset:20480
v_mfma_f32_16x16x32_bf16 v[140:143], v[88:91], a[228:231], v[140:143]
ds_read_b64_tr_b16 v[86:87], v33 offset:20992
v_mfma_f32_16x16x32_bf16 v[152:155], v[88:91], a[232:235], v[152:155]
ds_read_b128 a[248:251], v29 offset:20480
v_mfma_f32_16x16x32_bf16 v[184:187], v[92:95], a[232:235], v[184:187]
ds_read_b128 a[252:255], v29 offset:22528
buffer_load_dwordx4 v25, s[32:35], s76 offen offset:1024 lds
v_mfma_f32_16x16x32_bf16 v[188:191], v[92:95], a[236:239], v[188:191]
v_mfma_f32_16x16x32_bf16 v[156:159], v[88:91], a[236:239], v[156:159]
s_waitcnt lgkmcnt(4)
v_mfma_f32_16x16x32_bf16 v[128:131], v[80:83], a[240:243], v[128:131]
ds_read_b64_tr_b16 v[88:89], v32 offset:28672
v_dot2c_f32_bf16 v74, v112, v116
s_waitcnt lgkmcnt(3)
v_mfma_f32_16x16x32_bf16 v[160:163], v[84:87], a[240:243], v[160:163]
ds_read_b64_tr_b16 v[90:91], v32 offset:29184
buffer_load_dwordx4 v26, s[32:35], s76 offen offset:2048 lds
v_dot2c_f32_bf16 v74, v113, v117
v_mfma_f32_16x16x32_bf16 v[164:167], v[84:87], a[244:247], v[164:167]
ds_read_b64_tr_b16 v[92:93], v33 offset:28672
v_dot2c_f32_bf16 v74, v114, v118
v_mfma_f32_16x16x32_bf16 v[132:135], v[80:83], a[244:247], v[132:135]
ds_read_b64_tr_b16 v[94:95], v33 offset:29184
v_dot2c_f32_bf16 v74, v115, v119
s_waitcnt lgkmcnt(5)
v_mfma_f32_16x16x32_bf16 v[144:147], v[80:83], a[248:251], v[144:147]
v_mfma_f32_16x16x32_bf16 v[176:179], v[84:87], a[248:251], v[176:179]
buffer_load_dwordx4 v27, s[32:35], s76 offen offset:3072 lds
s_waitcnt lgkmcnt(4)
v_mfma_f32_16x16x32_bf16 v[180:183], v[84:87], a[252:255], v[180:183]
v_mfma_f32_16x16x32_bf16 v[148:151], v[80:83], a[252:255], v[148:151]
s_waitcnt lgkmcnt(0)
s_barrier
v_mfma_f32_16x16x32_bf16 v[136:139], v[88:91], a[240:243], v[136:139]
v_mfma_f32_16x16x32_bf16 v[168:171], v[92:95], a[240:243], v[168:171]
v_mfma_f32_16x16x32_bf16 v[172:175], v[92:95], a[244:247], v[172:175]
v_mfma_f32_16x16x32_bf16 v[140:143], v[88:91], a[244:247], v[140:143]
v_mfma_f32_16x16x32_bf16 v[152:155], v[88:91], a[248:251], v[152:155]
v_mfma_f32_16x16x32_bf16 v[184:187], v[92:95], a[248:251], v[184:187]
v_mfma_f32_16x16x32_bf16 v[188:191], v[92:95], a[252:255], v[188:191]
v_mfma_f32_16x16x32_bf16 v[156:159], v[88:91], a[252:255], v[156:159]
s_nop 0
v_subrev_u32 v32, 49152, v32
v_subrev_u32 v33, 49152, v33
v_cvt_pk_bf16_f32 v96, v128, v129
v_cvt_pk_bf16_f32 v97, v130, v131
v_cvt_pk_bf16_f32 v98, v132, v133
v_cvt_pk_bf16_f32 v99, v134, v135
v_cvt_pk_bf16_f32 v104, v136, v137
v_cvt_pk_bf16_f32 v105, v138, v139
v_cvt_pk_bf16_f32 v106, v140, v141
v_cvt_pk_bf16_f32 v107, v142, v143
v_permlane16_swap_b32 v96, v98
v_permlane16_swap_b32 v97, v99
v_permlane16_swap_b32 v104, v106
v_permlane16_swap_b32 v105, v107
s_add_u32 m0, s78, 131072
s_add_u32 s76, s76, 176128
buffer_load_dwordx4 v24, s[32:35], s76 offen offset:0 lds
ds_write_b128 v38, v[104:107] offset:0
v_mfma_f32_32x32x16_bf16 v[128:143], v[60:63], v[96:99], 0
v_cvt_pk_bf16_f32 v100, v144, v145
v_cvt_pk_bf16_f32 v101, v146, v147
v_cvt_pk_bf16_f32 v102, v148, v149
v_cvt_pk_bf16_f32 v103, v150, v151
v_cvt_pk_bf16_f32 v108, v152, v153
v_cvt_pk_bf16_f32 v109, v154, v155
v_cvt_pk_bf16_f32 v110, v156, v157
v_cvt_pk_bf16_f32 v111, v158, v159
v_permlane16_swap_b32 v100, v102
v_permlane16_swap_b32 v101, v103
v_permlane16_swap_b32 v108, v110
v_permlane16_swap_b32 v109, v111
buffer_load_dwordx4 v25, s[32:35], s76 offen offset:1024 lds
ds_write_b128 v38, v[108:111] offset:1024
v_mfma_f32_32x32x16_bf16 v[144:159], v[60:63], v[100:103], 0
v_max3_f32 v2, v128, v129, v130
v_max3_f32 v3, v131, v132, v133
v_max3_f32 v4, v134, v135, v136
v_max3_f32 v5, v137, v138, v139
v_max3_f32 v6, v140, v141, v142
v_max3_f32 v2, v2, v3, v143
v_max3_f32 v4, v4, v5, v6
v_max_f32_e64 v2, v2, v4
v_mul_f32 v2, 0xbfb8aa3b, v2
v_pk_fma_f32 v[128:129], v[128:129], s[88:89], v[2:3] op_sel_hi:[1,0,0]
v_pk_fma_f32 v[130:131], v[130:131], s[88:89], v[2:3] op_sel_hi:[1,0,0]
v_pk_fma_f32 v[132:133], v[132:133], s[88:89], v[2:3] op_sel_hi:[1,0,0]
buffer_load_dwordx4 v26, s[32:35], s76 offen offset:2048 lds
v_pk_fma_f32 v[134:135], v[134:135], s[88:89], v[2:3] op_sel_hi:[1,0,0]
v_pk_fma_f32 v[136:137], v[136:137], s[88:89], v[2:3] op_sel_hi:[1,0,0]
v_pk_fma_f32 v[138:139], v[138:139], s[88:89], v[2:3] op_sel_hi:[1,0,0]
v_pk_fma_f32 v[140:141], v[140:141], s[88:89], v[2:3] op_sel_hi:[1,0,0]
v_pk_fma_f32 v[142:143], v[142:143], s[88:89], v[2:3] op_sel_hi:[1,0,0]
v_cvt_pk_bf16_f32 v96, v160, v161
v_cvt_pk_bf16_f32 v97, v162, v163
v_cvt_pk_bf16_f32 v98, v164, v165
v_cvt_pk_bf16_f32 v99, v166, v167
v_cvt_pk_bf16_f32 v104, v168, v169
v_cvt_pk_bf16_f32 v105, v170, v171
v_cvt_pk_bf16_f32 v106, v172, v173
v_cvt_pk_bf16_f32 v107, v174, v175
v_permlane16_swap_b32 v96, v98
buffer_load_dwordx4 v27, s[32:35], s76 offen offset:3072 lds
v_permlane16_swap_b32 v97, v99
v_permlane16_swap_b32 v104, v106
v_permlane16_swap_b32 v105, v107
ds_write_b128 v38, v[104:107] offset:4096
v_mfma_f32_32x32x16_bf16 v[160:175], v[64:67], v[96:99], 0
v_exp_f32 v128, v128
v_exp_f32 v129, v129
v_exp_f32 v130, v130
v_exp_f32 v131, v131
v_exp_f32 v132, v132
v_exp_f32 v133, v133
v_exp_f32 v134, v134
v_exp_f32 v135, v135
v_exp_f32_e64 v136, v136
s_add_u32 m0, s78, 147456
s_add_u32 s76, s76, 176128
buffer_load_dwordx4 v24, s[32:35], s76 offen offset:0 lds
v_exp_f32 v137, v137
v_exp_f32 v138, v138
v_exp_f32 v139, v139
v_exp_f32 v140, v140
v_exp_f32 v141, v141
v_exp_f32 v142, v142
v_exp_f32_e64 v143, v143
v_pk_add_f32 v[2:3], v[128:129], v[130:131]
v_pk_add_f32 v[4:5], v[132:133], v[134:135]
v_pk_add_f32 v[6:7], v[136:137], v[138:139]
v_pk_add_f32 v[8:9], v[140:141], v[142:143]
v_pk_add_f32 v[2:3], v[2:3], v[4:5]
v_pk_add_f32 v[6:7], v[6:7], v[8:9]
v_pk_add_f32 v[2:3], v[2:3], v[6:7]
buffer_load_dwordx4 v25, s[32:35], s76 offen offset:1024 lds
v_add_f32 v2, v2, v3
v_rcp_f32 v2, v2
v_nop_e64
v_pk_mul_f32 v[128:129], v[128:129], v[2:3] op_sel_hi:[1,0]
v_pk_mul_f32 v[130:131], v[130:131], v[2:3] op_sel_hi:[1,0]
v_pk_mul_f32 v[132:133], v[132:133], v[2:3] op_sel_hi:[1,0]
v_pk_mul_f32 v[134:135], v[134:135], v[2:3] op_sel_hi:[1,0]
v_pk_mul_f32 v[136:137], v[136:137], v[2:3] op_sel_hi:[1,0]
v_pk_mul_f32 v[138:139], v[138:139], v[2:3] op_sel_hi:[1,0]
v_pk_mul_f32 v[140:141], v[140:141], v[2:3] op_sel_hi:[1,0]
v_pk_mul_f32 v[142:143], v[142:143], v[2:3] op_sel_hi:[1,0]
v_cvt_pk_bf16_f32 v112, v128, v129
v_cvt_pk_bf16_f32 v113, v130, v131
v_cvt_pk_bf16_f32 v114, v132, v133
v_cvt_pk_bf16_f32 v115, v134, v135
buffer_load_dwordx4 v26, s[32:35], s76 offen offset:2048 lds
ds_write_b128 v36, v[112:115] offset:0
v_cvt_pk_bf16_f32 v116, v136, v137
v_cvt_pk_bf16_f32 v117, v138, v139
v_cvt_pk_bf16_f32 v118, v140, v141
v_cvt_pk_bf16_f32 v119, v142, v143
ds_write_b128 v37, v[116:119] offset:0
v_max3_f32 v2, v144, v145, v146
v_max3_f32 v3, v147, v148, v149
v_max3_f32 v4, v150, v151, v152
v_max3_f32 v5, v153, v154, v155
v_max3_f32 v6, v156, v157, v158
v_max3_f32 v2, v2, v3, v159
v_max3_f32 v4, v4, v5, v6
v_max_f32_e64 v2, v2, v4
buffer_load_dwordx4 v27, s[32:35], s76 offen offset:3072 lds
v_mul_f32 v2, 0xbfb8aa3b, v2
v_pk_fma_f32 v[144:145], v[144:145], s[88:89], v[2:3] op_sel_hi:[1,0,0]
v_pk_fma_f32 v[146:147], v[146:147], s[88:89], v[2:3] op_sel_hi:[1,0,0]
v_pk_fma_f32 v[148:149], v[148:149], s[88:89], v[2:3] op_sel_hi:[1,0,0]
v_pk_fma_f32 v[150:151], v[150:151], s[88:89], v[2:3] op_sel_hi:[1,0,0]
v_pk_fma_f32 v[152:153], v[152:153], s[88:89], v[2:3] op_sel_hi:[1,0,0]
v_pk_fma_f32 v[154:155], v[154:155], s[88:89], v[2:3] op_sel_hi:[1,0,0]
v_pk_fma_f32 v[156:157], v[156:157], s[88:89], v[2:3] op_sel_hi:[1,0,0]
v_pk_fma_f32 v[158:159], v[158:159], s[88:89], v[2:3] op_sel_hi:[1,0,0]
v_cvt_pk_bf16_f32 v100, v176, v177
v_cvt_pk_bf16_f32 v101, v178, v179
v_cvt_pk_bf16_f32 v102, v180, v181
v_cvt_pk_bf16_f32 v103, v182, v183
v_cvt_pk_bf16_f32 v108, v184, v185
s_add_u32 m0, s78, 0
s_add_u32 s76, s76, 176128
buffer_load_dwordx4 v24, s[32:35], s76 offen offset:0 lds
v_cvt_pk_bf16_f32 v109, v186, v187
v_cvt_pk_bf16_f32 v110, v188, v189
v_cvt_pk_bf16_f32 v111, v190, v191
v_permlane16_swap_b32 v100, v102
v_permlane16_swap_b32 v101, v103
v_permlane16_swap_b32 v108, v110
v_permlane16_swap_b32 v109, v111
ds_write_b128 v38, v[108:111] offset:5120
v_mfma_f32_32x32x16_bf16 v[176:191], v[64:67], v[100:103], 0
v_exp_f32 v144, v144
v_exp_f32 v145, v145
v_exp_f32 v146, v146
v_exp_f32 v147, v147
v_exp_f32 v148, v148
buffer_load_dwordx4 v25, s[32:35], s76 offen offset:1024 lds
v_exp_f32 v149, v149
v_exp_f32 v150, v150
v_exp_f32 v151, v151
v_exp_f32 v152, v152
v_exp_f32 v153, v153
v_exp_f32 v154, v154
v_exp_f32 v155, v155
v_exp_f32 v156, v156
v_exp_f32 v157, v157
v_exp_f32 v158, v158
v_exp_f32_e64 v159, v159
v_pk_add_f32 v[2:3], v[144:145], v[146:147]
v_pk_add_f32 v[4:5], v[148:149], v[150:151]
v_pk_add_f32 v[6:7], v[152:153], v[154:155]
buffer_load_dwordx4 v26, s[32:35], s76 offen offset:2048 lds
v_pk_add_f32 v[8:9], v[156:157], v[158:159]
v_pk_add_f32 v[2:3], v[2:3], v[4:5]
v_pk_add_f32 v[6:7], v[6:7], v[8:9]
v_pk_add_f32 v[2:3], v[2:3], v[6:7]
v_add_f32 v2, v2, v3
v_rcp_f32 v2, v2
v_nop_e64
v_pk_mul_f32 v[144:145], v[144:145], v[2:3] op_sel_hi:[1,0]
v_pk_mul_f32 v[146:147], v[146:147], v[2:3] op_sel_hi:[1,0]
v_pk_mul_f32 v[148:149], v[148:149], v[2:3] op_sel_hi:[1,0]
v_pk_mul_f32 v[150:151], v[150:151], v[2:3] op_sel_hi:[1,0]
v_pk_mul_f32 v[152:153], v[152:153], v[2:3] op_sel_hi:[1,0]
v_pk_mul_f32 v[154:155], v[154:155], v[2:3] op_sel_hi:[1,0]
v_pk_mul_f32 v[156:157], v[156:157], v[2:3] op_sel_hi:[1,0]
v_pk_mul_f32 v[158:159], v[158:159], v[2:3] op_sel_hi:[1,0]
buffer_load_dwordx4 v27, s[32:35], s76 offen offset:3072 lds
v_cvt_pk_bf16_f32 v120, v144, v145
v_cvt_pk_bf16_f32 v121, v146, v147
v_cvt_pk_bf16_f32 v122, v148, v149
v_cvt_pk_bf16_f32 v123, v150, v151
ds_write_b128 v36, v[120:123] offset:2048
v_cvt_pk_bf16_f32 v124, v152, v153
v_cvt_pk_bf16_f32 v125, v154, v155
v_cvt_pk_bf16_f32 v126, v156, v157
v_cvt_pk_bf16_f32 v127, v158, v159
ds_write_b128 v37, v[124:127] offset:2048
v_max3_f32 v2, v160, v161, v162
v_max3_f32 v3, v163, v164, v165
v_max3_f32 v4, v166, v167, v168
v_max3_f32 v5, v169, v170, v171
s_add_u32 m0, s78, 16384
s_add_u32 s76, s76, 176128
buffer_load_dwordx4 v24, s[32:35], s76 offen offset:0 lds
v_max3_f32 v6, v172, v173, v174
v_max3_f32 v2, v2, v3, v175
v_max3_f32 v4, v4, v5, v6
v_max_f32_e64 v2, v2, v4
v_mul_f32 v2, 0xbfb8aa3b, v2
LhopA1:
s_cbranch_execz LbackA
s_nop 0
v_pk_fma_f32 v[160:161], v[160:161], s[88:89], v[2:3] op_sel_hi:[1,0,0]
v_pk_fma_f32 v[162:163], v[162:163], s[88:89], v[2:3] op_sel_hi:[1,0,0]
v_pk_fma_f32 v[164:165], v[164:165], s[88:89], v[2:3] op_sel_hi:[1,0,0]
v_pk_fma_f32 v[166:167], v[166:167], s[88:89], v[2:3] op_sel_hi:[1,0,0]
v_pk_fma_f32 v[168:169], v[168:169], s[88:89], v[2:3] op_sel_hi:[1,0,0]
v_pk_fma_f32 v[170:171], v[170:171], s[88:89], v[2:3] op_sel_hi:[1,0,0]
v_pk_fma_f32 v[172:173], v[172:173], s[88:89], v[2:3] op_sel_hi:[1,0,0]
v_pk_fma_f32 v[174:175], v[174:175], s[88:89], v[2:3] op_sel_hi:[1,0,0]
v_exp_f32_e64 v160, v160
buffer_load_dwordx4 v25, s[32:35], s76 offen offset:1024 lds
v_exp_f32 v161, v161
v_exp_f32 v162, v162
v_exp_f32 v163, v163
v_exp_f32 v164, v164
v_exp_f32 v165, v165
v_exp_f32 v166, v166
v_exp_f32 v167, v167
v_exp_f32 v168, v168
v_exp_f32 v169, v169
v_exp_f32 v170, v170
v_exp_f32 v171, v171
v_exp_f32 v172, v172
v_exp_f32 v173, v173
v_exp_f32 v174, v174
buffer_load_dwordx4 v26, s[32:35], s76 offen offset:2048 lds
v_exp_f32_e64 v175, v175
v_pk_add_f32 v[2:3], v[160:161], v[162:163]
v_pk_add_f32 v[4:5], v[164:165], v[166:167]
v_pk_add_f32 v[6:7], v[168:169], v[170:171]
v_pk_add_f32 v[8:9], v[172:173], v[174:175]
v_pk_add_f32 v[2:3], v[2:3], v[4:5]
v_pk_add_f32 v[6:7], v[6:7], v[8:9]
v_pk_add_f32 v[2:3], v[2:3], v[6:7]
v_add_f32 v2, v2, v3
v_rcp_f32 v2, v2
v_nop_e64
v_pk_mul_f32 v[160:161], v[160:161], v[2:3] op_sel_hi:[1,0]
v_pk_mul_f32 v[162:163], v[162:163], v[2:3] op_sel_hi:[1,0]
v_pk_mul_f32 v[164:165], v[164:165], v[2:3] op_sel_hi:[1,0]
v_pk_mul_f32 v[166:167], v[166:167], v[2:3] op_sel_hi:[1,0]
buffer_load_dwordx4 v27, s[32:35], s76 offen offset:3072 lds
v_pk_mul_f32 v[168:169], v[168:169], v[2:3] op_sel_hi:[1,0]
v_pk_mul_f32 v[170:171], v[170:171], v[2:3] op_sel_hi:[1,0]
v_pk_mul_f32 v[172:173], v[172:173], v[2:3] op_sel_hi:[1,0]
v_pk_mul_f32 v[174:175], v[174:175], v[2:3] op_sel_hi:[1,0]
v_cvt_pk_bf16_f32 v112, v160, v161
v_cvt_pk_bf16_f32 v113, v162, v163
v_cvt_pk_bf16_f32 v114, v164, v165
v_cvt_pk_bf16_f32 v115, v166, v167
ds_write_b128 v36, v[112:115] offset:8192
v_cvt_pk_bf16_f32 v116, v168, v169
v_cvt_pk_bf16_f32 v117, v170, v171
v_cvt_pk_bf16_f32 v118, v172, v173
v_cvt_pk_bf16_f32 v119, v174, v175
ds_write_b128 v37, v[116:119] offset:8192
s_add_u32 m0, s78, 32768
s_add_u32 s76, s76, 176128
buffer_load_dwordx4 v24, s[32:35], s76 offen offset:0 lds
v_max3_f32 v2, v176, v177, v178
v_max3_f32 v3, v179, v180, v181
v_max3_f32 v4, v182, v183, v184
v_max3_f32 v5, v185, v186, v187
v_max3_f32 v6, v188, v189, v190
v_max3_f32 v2, v2, v3, v191
v_max3_f32 v4, v4, v5, v6
v_max_f32_e64 v2, v2, v4
v_mul_f32 v2, 0xbfb8aa3b, v2
v_pk_fma_f32 v[176:177], v[176:177], s[88:89], v[2:3] op_sel_hi:[1,0,0]
v_pk_fma_f32 v[178:179], v[178:179], s[88:89], v[2:3] op_sel_hi:[1,0,0]
v_pk_fma_f32 v[180:181], v[180:181], s[88:89], v[2:3] op_sel_hi:[1,0,0]
v_pk_fma_f32 v[182:183], v[182:183], s[88:89], v[2:3] op_sel_hi:[1,0,0]
v_pk_fma_f32 v[184:185], v[184:185], s[88:89], v[2:3] op_sel_hi:[1,0,0]
buffer_load_dwordx4 v25, s[32:35], s76 offen offset:1024 lds
v_pk_fma_f32 v[186:187], v[186:187], s[88:89], v[2:3] op_sel_hi:[1,0,0]
v_pk_fma_f32 v[188:189], v[188:189], s[88:89], v[2:3] op_sel_hi:[1,0,0]
v_pk_fma_f32 v[190:191], v[190:191], s[88:89], v[2:3] op_sel_hi:[1,0,0]
v_exp_f32 v176, v176
v_exp_f32 v177, v177
v_exp_f32 v178, v178
v_exp_f32 v179, v179
v_exp_f32 v180, v180
v_exp_f32 v181, v181
v_exp_f32 v182, v182
v_exp_f32 v183, v183
v_exp_f32 v184, v184
v_exp_f32 v185, v185
v_exp_f32_e64 v186, v186
buffer_load_dwordx4 v26, s[32:35], s76 offen offset:2048 lds
v_exp_f32 v187, v187
v_exp_f32 v188, v188
v_exp_f32 v189, v189
v_exp_f32 v190, v190
v_exp_f32_e64 v191, v191
v_pk_add_f32 v[2:3], v[176:177], v[178:179]
v_pk_add_f32 v[4:5], v[180:181], v[182:183]
v_pk_add_f32 v[6:7], v[184:185], v[186:187]
v_pk_add_f32 v[8:9], v[188:189], v[190:191]
v_pk_add_f32 v[2:3], v[2:3], v[4:5]
v_pk_add_f32 v[6:7], v[6:7], v[8:9]
v_pk_add_f32 v[2:3], v[2:3], v[6:7]
v_add_f32 v2, v2, v3
v_rcp_f32 v2, v2
buffer_load_dwordx4 v27, s[32:35], s76 offen offset:3072 lds
v_pk_mul_f32 v[176:177], v[176:177], v[2:3] op_sel_hi:[1,0]
v_pk_mul_f32 v[178:179], v[178:179], v[2:3] op_sel_hi:[1,0]
v_pk_mul_f32 v[180:181], v[180:181], v[2:3] op_sel_hi:[1,0]
v_pk_mul_f32 v[182:183], v[182:183], v[2:3] op_sel_hi:[1,0]
v_pk_mul_f32 v[184:185], v[184:185], v[2:3] op_sel_hi:[1,0]
v_pk_mul_f32 v[186:187], v[186:187], v[2:3] op_sel_hi:[1,0]
v_pk_mul_f32 v[188:189], v[188:189], v[2:3] op_sel_hi:[1,0]
v_pk_mul_f32 v[190:191], v[190:191], v[2:3] op_sel_hi:[1,0]
v_cvt_pk_bf16_f32 v120, v176, v177
v_cvt_pk_bf16_f32 v121, v178, v179
v_cvt_pk_bf16_f32 v122, v180, v181
v_cvt_pk_bf16_f32 v123, v182, v183
ds_write_b128 v36, v[120:123] offset:10240
v_cvt_pk_bf16_f32 v124, v184, v185
v_cvt_pk_bf16_f32 v125, v186, v187
v_cvt_pk_bf16_f32 v126, v188, v189
v_cvt_pk_bf16_f32 v127, v190, v191
ds_write_b128 v37, v[124:127] offset:10240
s_waitcnt vmcnt(24)
v_cmp_ne_u32 vcc, 0, v13
s_nop 1
s_and_b32 s92, vcc_lo, s87
s_cmp_eq_u32 s92, s87
s_cbranch_scc1 Lok0
s_mov_b32 s93, 0
Lsp0:
buffer_load_dword v13, v59, s[52:55], 0 offen sc1
s_waitcnt vmcnt(0)
v_cmp_ne_u32 vcc, 0, v13
s_add_u32 s93, s93, 1
s_nop 0
s_and_b32 s92, vcc_lo, s87
s_cmp_eq_u32 s92, s87
s_cbranch_scc1 Lok0
s_cmp_lt_u32 s93, 0x8000
s_cbranch_scc1 Lsp0
Lok0:
s_waitcnt lgkmcnt(0)
s_barrier
ds_read_b64_tr_b16 v[80:81], v34 offset:0
ds_read_b64_tr_b16 v[82:83], v34 offset:512
ds_read_b64_tr_b16 v[84:85], v35 offset:0
ds_read_b64_tr_b16 v[86:87], v35 offset:512
s_waitcnt lgkmcnt(2)
v_mfma_f32_16x16x32_bf16 v[192:195], v[80:83], a[0:3], 0
ds_read_b64_tr_b16 v[88:89], v34 offset:8192
v_mov_b32 v176, 0x3f803f80
v_mov_b32 v177, 0x3f803f80
s_waitcnt lgkmcnt(1)
v_mfma_f32_16x16x32_bf16 v[224:227], v[84:87], a[0:3], 0
ds_read_b64_tr_b16 v[90:91], v34 offset:8704
v_mov_b32 v178, 0x3f803f80
v_mov_b32 v179, 0x3f803f80
v_mfma_f32_16x16x32_bf16 v[228:231], v[84:87], a[4:7], 0
ds_read_b64_tr_b16 v[92:93], v35 offset:8192
ds_read_b64_tr_b16 v[128:129], v40 offset:0
ds_read_b64_tr_b16 v[130:131], v40 offset:256
v_mfma_f32_16x16x32_bf16 v[196:199], v[80:83], a[4:7], 0
ds_read_b64_tr_b16 v[94:95], v35 offset:8704
ds_read_b64_tr_b16 v[132:133], v39 offset:0
ds_read_b64_tr_b16 v[134:135], v39 offset:512
v_mfma_f32_16x16x32_bf16 v[208:211], v[80:83], a[8:11], 0
ds_read_b64_tr_b16 v[136:137], v41 offset:0
ds_read_b64_tr_b16 v[138:139], v41 offset:512
v_mfma_f32_16x16x32_bf16 v[240:243], v[84:87], a[8:11], 0
ds_read_b64_tr_b16 v[140:141], v40 offset:1024
ds_read_b64_tr_b16 v[142:143], v40 offset:1280
v_mfma_f32_16x16x32_bf16 v[244:247], v[84:87], a[12:15], 0
ds_read_b64_tr_b16 v[144:145], v39 offset:2048
v_mfma_f32_16x16x32_bf16 v[212:215], v[80:83], a[12:15], 0
ds_read_b64_tr_b16 v[146:147], v39 offset:2560
s_waitcnt lgkmcnt(12)
v_mfma_f32_16x16x32_bf16 v[200:203], v[88:91], a[0:3], 0
ds_read_b64_tr_b16 v[80:81], v34 offset:4096
ds_read_b64_tr_b16 v[148:149], v41 offset:2048
ds_read_b64_tr_b16 v[150:151], v41 offset:2560
s_waitcnt lgkmcnt(11)
v_mfma_f32_16x16x32_bf16 v[232:235], v[92:95], a[0:3], 0
ds_read_b64_tr_b16 v[82:83], v34 offset:4608
ds_read_b64_tr_b16 v[152:153], v40 offset:2048
ds_read_b64_tr_b16 v[154:155], v40 offset:2304
v_mfma_f32_16x16x32_bf16 v[236:239], v[92:95], a[4:7], 0
ds_read_b64_tr_b16 v[84:85], v35 offset:4096
ds_read_b64_tr_b16 v[156:157], v39 offset:4096
ds_read_b64_tr_b16 v[158:159], v39 offset:4608
v_mfma_f32_16x16x32_bf16 v[204:207], v[88:91], a[4:7], 0
ds_read_b64_tr_b16 v[86:87], v35 offset:4608
ds_read_b64_tr_b16 v[160:161], v41 offset:4096
ds_read_b64_tr_b16 v[162:163], v41 offset:4608
v_mfma_f32_16x16x32_bf16 v[216:219], v[88:91], a[8:11], 0
s_waitcnt lgkmcnt(14)
v_mfma_f32_16x16x32_bf16 v[96:99], v[128:131], v[132:135], 0
v_mfma_f32_16x16x32_bf16 v[104:107], v[176:179], v[132:135], 0
v_mfma_f32_16x16x32_bf16 v[248:251], v[92:95], a[8:11], 0
v_mfma_f32_16x16x32_bf16 v[108:111], v[176:179], v[136:139], 0
v_mfma_f32_16x16x32_bf16 v[100:103], v[128:131], v[136:139], 0
v_mfma_f32_16x16x32_bf16 v[252:255], v[92:95], a[12:15], 0
ds_read_b64_tr_b16 v[164:165], v40 offset:3072
ds_read_b64_tr_b16 v[166:167], v40 offset:3328
v_mfma_f32_16x16x32_bf16 v[220:223], v[88:91], a[12:15], 0
ds_read_b64_tr_b16 v[168:169], v39 offset:6144
s_waitcnt lgkmcnt(11)
v_mfma_f32_16x16x32_bf16 v[192:195], v[80:83], a[16:19], v[192:195]
ds_read_b64_tr_b16 v[88:89], v34 offset:12288
ds_read_b64_tr_b16 v[170:171], v39 offset:6656
ds_read_b64_tr_b16 v[172:173], v41 offset:6144
s_waitcnt lgkmcnt(8)
v_mfma_f32_16x16x32_bf16 v[224:227], v[84:87], a[16:19], v[224:227]
ds_read_b64_tr_b16 v[90:91], v34 offset:12800
ds_read_b64_tr_b16 v[174:175], v41 offset:6656
v_mfma_f32_16x16x32_bf16 v[96:99], v[140:143], v[144:147], v[96:99]
v_mfma_f32_16x16x32_bf16 v[228:231], v[84:87], a[20:23], v[228:231]
ds_read_b64_tr_b16 v[92:93], v35 offset:12288
v_mfma_f32_16x16x32_bf16 v[104:107], v[176:179], v[144:147], v[104:107]
v_mfma_f32_16x16x32_bf16 v[108:111], v[176:179], v[148:151], v[108:111]
v_mfma_f32_16x16x32_bf16 v[196:199], v[80:83], a[20:23], v[196:199]
ds_read_b64_tr_b16 v[94:95], v35 offset:12800
v_mfma_f32_16x16x32_bf16 v[100:103], v[140:143], v[148:151], v[100:103]
v_mfma_f32_16x16x32_bf16 v[96:99], v[152:155], v[156:159], v[96:99]
v_mfma_f32_16x16x32_bf16 v[208:211], v[80:83], a[24:27], v[208:211]
v_mfma_f32_16x16x32_bf16 v[104:107], v[176:179], v[156:159], v[104:107]
s_waitcnt lgkmcnt(10)
v_mfma_f32_16x16x32_bf16 v[108:111], v[176:179], v[160:163], v[108:111]
v_mfma_f32_16x16x32_bf16 v[240:243], v[84:87], a[24:27], v[240:243]
v_mfma_f32_16x16x32_bf16 v[100:103], v[152:155], v[160:163], v[100:103]
s_waitcnt lgkmcnt(5)
v_mfma_f32_16x16x32_bf16 v[96:99], v[164:167], v[168:171], v[96:99]
v_mfma_f32_16x16x32_bf16 v[244:247], v[84:87], a[28:31], v[244:247]
v_mfma_f32_16x16x32_bf16 v[104:107], v[176:179], v[168:171], v[104:107]
s_waitcnt lgkmcnt(2)
v_mfma_f32_16x16x32_bf16 v[108:111], v[176:179], v[172:175], v[108:111]
v_mfma_f32_16x16x32_bf16 v[212:215], v[80:83], a[28:31], v[212:215]
v_mfma_f32_16x16x32_bf16 v[100:103], v[164:167], v[172:175], v[100:103]
s_waitcnt vmcnt(12) lgkmcnt(0)
s_barrier
v_mfma_f32_16x16x32_bf16 v[200:203], v[88:91], a[16:19], v[200:203]
ds_read_b64_tr_b16 v[80:81], v34 offset:16384
v_and_b32 v6, 0x27, v1
v_mfma_f32_16x16x32_bf16 v[232:235], v[92:95], a[16:19], v[232:235]
ds_read_b64_tr_b16 v[82:83], v34 offset:16896
s_add_u32 m0, s78, 98304
s_add_u32 s76, s76, 176128
buffer_load_dwordx4 v24, s[32:35], s76 offen offset:0 lds
v_lshrrev_b32_e64 v7, 1, v1
v_mfma_f32_16x16x32_bf16 v[236:239], v[92:95], a[20:23], v[236:239]
ds_read_b64_tr_b16 v[84:85], v35 offset:16384
v_lshl_or_b32 v21, v6, 24, v7
v_mfma_f32_16x16x32_bf16 v[204:207], v[88:91], a[20:23], v[204:207]
ds_read_b64_tr_b16 v[86:87], v35 offset:16896
v_mfma_f32_16x16x32_bf16 v[216:219], v[88:91], a[24:27], v[216:219]
v_mfma_f32_16x16x32_bf16 v[248:251], v[92:95], a[24:27], v[248:251]
buffer_load_dwordx4 v25, s[32:35], s76 offen offset:1024 lds
v_mfma_f32_16x16x32_bf16 v[252:255], v[92:95], a[28:31], v[252:255]
v_mfma_f32_16x16x32_bf16 v[220:223], v[88:91], a[28:31], v[220:223]
s_waitcnt lgkmcnt(2)
v_mfma_f32_16x16x32_bf16 v[192:195], v[80:83], a[32:35], v[192:195]
ds_read_b64_tr_b16 v[88:89], v34 offset:24576
v_add_f32_dpp v74, v74, v74 quad_perm:[1,0,3,2] row_mask:0xf bank_mask:0xf
s_waitcnt lgkmcnt(1)
v_mfma_f32_16x16x32_bf16 v[224:227], v[84:87], a[32:35], v[224:227]
ds_read_b64_tr_b16 v[90:91], v34 offset:25088
buffer_load_dwordx4 v26, s[32:35], s76 offen offset:2048 lds
v_add_f32_dpp v74, v74, v74 quad_perm:[2,3,0,1] row_mask:0xf bank_mask:0xf
v_mfma_f32_16x16x32_bf16 v[228:231], v[84:87], a[36:39], v[228:231]
ds_read_b64_tr_b16 v[92:93], v35 offset:24576
v_add_f32_dpp v74, v74, v74 row_half_mirror row_mask:0xf bank_mask:0xf
v_mfma_f32_16x16x32_bf16 v[196:199], v[80:83], a[36:39], v[196:199]
ds_read_b64_tr_b16 v[94:95], v35 offset:25088
v_mfma_f32_16x16x32_bf16 v[208:211], v[80:83], a[40:43], v[208:211]
v_mfma_f32_16x16x32_bf16 v[240:243], v[84:87], a[40:43], v[240:243]
buffer_load_dwordx4 v27, s[32:35], s76 offen offset:3072 lds
v_mfma_f32_16x16x32_bf16 v[244:247], v[84:87], a[44:47], v[244:247]
v_mfma_f32_16x16x32_bf16 v[212:215], v[80:83], a[44:47], v[212:215]
s_waitcnt lgkmcnt(2)
v_mfma_f32_16x16x32_bf16 v[200:203], v[88:91], a[32:35], v[200:203]
ds_read_b64_tr_b16 v[80:81], v34 offset:20480
v_mul_f32 v2, 0xbfb8aa3b, v74
s_waitcnt lgkmcnt(1)
v_mfma_f32_16x16x32_bf16 v[232:235], v[92:95], a[32:35], v[232:235]
ds_read_b64_tr_b16 v[82:83], v34 offset:20992
v_exp_f32_e64 v2, v2
v_mfma_f32_16x16x32_bf16 v[236:239], v[92:95], a[36:39], v[236:239]
ds_read_b64_tr_b16 v[84:85], v35 offset:20480
v_add_f32_e64 v2, 1.0, v2
v_mfma_f32_16x16x32_bf16 v[204:207], v[88:91], a[36:39], v[204:207]
ds_read_b64_tr_b16 v[86:87], v35 offset:20992
v_rcp_f32_e64 v20, v2
v_mfma_f32_16x16x32_bf16 v[216:219], v[88:91], a[40:43], v[216:219]
buffer_atomic_add_f32 v96, v43, s[48:51], s82 offen offset:0
v_mfma_f32_16x16x32_bf16 v[248:251], v[92:95], a[40:43], v[248:251]
buffer_atomic_add_f32 v100, v43, s[48:51], s82 offen offset:64
v_mfma_f32_16x16x32_bf16 v[252:255], v[92:95], a[44:47], v[252:255]
v_mfma_f32_16x16x32_bf16 v[220:223], v[88:91], a[44:47], v[220:223]
s_waitcnt lgkmcnt(2)
v_mfma_f32_16x16x32_bf16 v[192:195], v[80:83], a[48:51], v[192:195]
ds_read_b64_tr_b16 v[88:89], v34 offset:28672
buffer_atomic_add_f32 v97, v43, s[48:51], s82 offen offset:256
v_permlane16_swap_b32 v104, v108
s_waitcnt lgkmcnt(1)
v_mfma_f32_16x16x32_bf16 v[224:227], v[84:87], a[48:51], v[224:227]
ds_read_b64_tr_b16 v[90:91], v34 offset:29184
buffer_atomic_add_f32 v101, v43, s[48:51], s82 offen offset:320
v_mfma_f32_16x16x32_bf16 v[228:231], v[84:87], a[52:55], v[228:231]
ds_read_b64_tr_b16 v[92:93], v35 offset:28672
v_mfma_f32_16x16x32_bf16 v[196:199], v[80:83], a[52:55], v[196:199]
ds_read_b64_tr_b16 v[94:95], v35 offset:29184
v_mfma_f32_16x16x32_bf16 v[208:211], v[80:83], a[56:59], v[208:211]
v_mfma_f32_16x16x32_bf16 v[240:243], v[84:87], a[56:59], v[240:243]
v_mfma_f32_16x16x32_bf16 v[244:247], v[84:87], a[60:63], v[244:247]
v_mfma_f32_16x16x32_bf16 v[212:215], v[80:83], a[60:63], v[212:215]
s_waitcnt lgkmcnt(2)
v_mfma_f32_16x16x32_bf16 v[200:203], v[88:91], a[48:51], v[200:203]
ds_read_b64_tr_b16 v[80:81], v34 offset:32768
buffer_atomic_add_f32 v98, v43, s[48:51], s82 offen offset:512
s_waitcnt lgkmcnt(1)
v_mfma_f32_16x16x32_bf16 v[232:235], v[92:95], a[48:51], v[232:235]
ds_read_b64_tr_b16 v[82:83], v34 offset:33280
buffer_atomic_add_f32 v102, v43, s[48:51], s82 offen offset:576
v_mfma_f32_16x16x32_bf16 v[236:239], v[92:95], a[52:55], v[236:239]
ds_read_b64_tr_b16 v[84:85], v35 offset:32768
v_mfma_f32_16x16x32_bf16 v[204:207], v[88:91], a[52:55], v[204:207]
ds_read_b64_tr_b16 v[86:87], v35 offset:33280
v_mfma_f32_16x16x32_bf16 v[216:219], v[88:91], a[56:59], v[216:219]
v_mfma_f32_16x16x32_bf16 v[248:251], v[92:95], a[56:59], v[248:251]
v_mfma_f32_16x16x32_bf16 v[252:255], v[92:95], a[60:63], v[252:255]
v_mfma_f32_16x16x32_bf16 v[220:223], v[88:91], a[60:63], v[220:223]
s_waitcnt lgkmcnt(2)
v_mfma_f32_16x16x32_bf16 v[192:195], v[80:83], a[64:67], v[192:195]
ds_read_b64_tr_b16 v[88:89], v34 offset:40960
buffer_atomic_add_f32 v99, v43, s[48:51], s82 offen offset:768
s_waitcnt lgkmcnt(1)
v_mfma_f32_16x16x32_bf16 v[224:227], v[84:87], a[64:67], v[224:227]
ds_read_b64_tr_b16 v[90:91], v34 offset:41472
buffer_atomic_add_f32 v103, v43, s[48:51], s82 offen offset:832
v_mfma_f32_16x16x32_bf16 v[228:231], v[84:87], a[68:71], v[228:231]
ds_read_b64_tr_b16 v[92:93], v35 offset:40960
s_mov_b32 exec_hi, 0
buffer_atomic_add_f32 v104, v42, s[48:51], s82 offen
s_mov_b32 exec_hi, -1
buffer_store_dword v20, v21, s[48:51], s79 offen sc1
v_mfma_f32_16x16x32_bf16 v[196:199], v[80:83], a[68:71], v[196:199]
ds_read_b64_tr_b16 v[94:95], v35 offset:41472
v_mfma_f32_16x16x32_bf16 v[208:211], v[80:83], a[72:75], v[208:211]
v_mfma_f32_16x16x32_bf16 v[240:243], v[84:87], a[72:75], v[240:243]
v_mfma_f32_16x16x32_bf16 v[244:247], v[84:87], a[76:79], v[244:247]
v_mfma_f32_16x16x32_bf16 v[212:215], v[80:83], a[76:79], v[212:215]
s_waitcnt lgkmcnt(2)
v_mfma_f32_16x16x32_bf16 v[200:203], v[88:91], a[64:67], v[200:203]
ds_read_b64_tr_b16 v[80:81], v34 offset:36864
s_waitcnt lgkmcnt(1)
v_mfma_f32_16x16x32_bf16 v[232:235], v[92:95], a[64:67], v[232:235]
ds_read_b64_tr_b16 v[82:83], v34 offset:37376
v_mfma_f32_16x16x32_bf16 v[236:239], v[92:95], a[68:71], v[236:239]
ds_read_b64_tr_b16 v[84:85], v35 offset:36864
v_mfma_f32_16x16x32_bf16 v[204:207], v[88:91], a[68:71], v[204:207]
ds_read_b64_tr_b16 v[86:87], v35 offset:37376
v_mfma_f32_16x16x32_bf16 v[216:219], v[88:91], a[72:75], v[216:219]
v_mfma_f32_16x16x32_bf16 v[248:251], v[92:95], a[72:75], v[248:251]
v_mfma_f32_16x16x32_bf16 v[252:255], v[92:95], a[76:79], v[252:255]
v_mfma_f32_16x16x32_bf16 v[220:223], v[88:91], a[76:79], v[220:223]
s_waitcnt lgkmcnt(2)
v_mfma_f32_16x16x32_bf16 v[192:195], v[80:83], a[80:83], v[192:195]
ds_read_b64_tr_b16 v[88:89], v34 offset:45056
s_waitcnt lgkmcnt(1)
v_mfma_f32_16x16x32_bf16 v[224:227], v[84:87], a[80:83], v[224:227]
ds_read_b64_tr_b16 v[90:91], v34 offset:45568
v_mfma_f32_16x16x32_bf16 v[228:231], v[84:87], a[84:87], v[228:231]
ds_read_b64_tr_b16 v[92:93], v35 offset:45056
v_mfma_f32_16x16x32_bf16 v[196:199], v[80:83], a[84:87], v[196:199]
ds_read_b64_tr_b16 v[94:95], v35 offset:45568
v_mfma_f32_16x16x32_bf16 v[208:211], v[80:83], a[88:91], v[208:211]
v_mfma_f32_16x16x32_bf16 v[240:243], v[84:87], a[88:91], v[240:243]
v_mfma_f32_16x16x32_bf16 v[244:247], v[84:87], a[92:95], v[244:247]
v_mfma_f32_16x16x32_bf16 v[212:215], v[80:83], a[92:95], v[212:215]
s_waitcnt lgkmcnt(2)
v_mfma_f32_16x16x32_bf16 v[200:203], v[88:91], a[80:83], v[200:203]
ds_read_b64_tr_b16 v[80:81], v34 offset:49152
s_waitcnt lgkmcnt(1)
v_mfma_f32_16x16x32_bf16 v[232:235], v[92:95], a[80:83], v[232:235]
ds_read_b64_tr_b16 v[82:83], v34 offset:49664
v_mfma_f32_16x16x32_bf16 v[236:239], v[92:95], a[84:87], v[236:239]
ds_read_b64_tr_b16 v[84:85], v35 offset:49152
v_mfma_f32_16x16x32_bf16 v[204:207], v[88:91], a[84:87], v[204:207]
ds_read_b64_tr_b16 v[86:87], v35 offset:49664
v_mfma_f32_16x16x32_bf16 v[216:219], v[88:91], a[88:91], v[216:219]
v_mfma_f32_16x16x32_bf16 v[248:251], v[92:95], a[88:91], v[248:251]
v_mfma_f32_16x16x32_bf16 v[252:255], v[92:95], a[92:95], v[252:255]
v_mfma_f32_16x16x32_bf16 v[220:223], v[88:91], a[92:95], v[220:223]
s_waitcnt lgkmcnt(2)
v_mfma_f32_16x16x32_bf16 v[192:195], v[80:83], a[96:99], v[192:195]
ds_read_b64_tr_b16 v[88:89], v34 offset:57344
s_waitcnt lgkmcnt(1)
v_mfma_f32_16x16x32_bf16 v[224:227], v[84:87], a[96:99], v[224:227]
ds_read_b64_tr_b16 v[90:91], v34 offset:57856
v_mfma_f32_16x16x32_bf16 v[228:231], v[84:87], a[100:103], v[228:231]
ds_read_b64_tr_b16 v[92:93], v35 offset:57344
v_mfma_f32_16x16x32_bf16 v[196:199], v[80:83], a[100:103], v[196:199]
ds_read_b64_tr_b16 v[94:95], v35 offset:57856
v_mfma_f32_16x16x32_bf16 v[208:211], v[80:83], a[104:107], v[208:211]
v_mfma_f32_16x16x32_bf16 v[240:243], v[84:87], a[104:107], v[240:243]
v_mfma_f32_16x16x32_bf16 v[244:247], v[84:87], a[108:111], v[244:247]
v_mfma_f32_16x16x32_bf16 v[212:215], v[80:83], a[108:111], v[212:215]
s_waitcnt lgkmcnt(2)
v_mfma_f32_16x16x32_bf16 v[200:203], v[88:91], a[96:99], v[200:203]
ds_read_b64_tr_b16 v[80:81], v34 offset:53248
s_waitcnt lgkmcnt(1)
v_mfma_f32_16x16x32_bf16 v[232:235], v[92:95], a[96:99], v[232:235]
ds_read_b64_tr_b16 v[82:83], v34 offset:53760
v_mfma_f32_16x16x32_bf16 v[236:239], v[92:95], a[100:103], v[236:239]
ds_read_b64_tr_b16 v[84:85], v35 offset:53248
v_mfma_f32_16x16x32_bf16 v[204:207], v[88:91], a[100:103], v[204:207]
ds_read_b64_tr_b16 v[86:87], v35 offset:53760
v_mfma_f32_16x16x32_bf16 v[216:219], v[88:91], a[104:107], v[216:219]
v_mfma_f32_16x16x32_bf16 v[248:251], v[92:95], a[104:107], v[248:251]
v_mfma_f32_16x16x32_bf16 v[252:255], v[92:95], a[108:111], v[252:255]
v_mfma_f32_16x16x32_bf16 v[220:223], v[88:91], a[108:111], v[220:223]
s_waitcnt lgkmcnt(2)
v_mfma_f32_16x16x32_bf16 v[192:195], v[80:83], a[112:115], v[192:195]
ds_read_b64_tr_b16 v[88:89], v34 offset:61440
s_waitcnt lgkmcnt(1)
v_mfma_f32_16x16x32_bf16 v[224:227], v[84:87], a[112:115], v[224:227]
ds_read_b64_tr_b16 v[90:91], v34 offset:61952
v_mfma_f32_16x16x32_bf16 v[228:231], v[84:87], a[116:119], v[228:231]
ds_read_b64_tr_b16 v[92:93], v35 offset:61440
v_mfma_f32_16x16x32_bf16 v[196:199], v[80:83], a[116:119], v[196:199]
ds_read_b64_tr_b16 v[94:95], v35 offset:61952
v_mfma_f32_16x16x32_bf16 v[208:211], v[80:83], a[120:123], v[208:211]
v_mfma_f32_16x16x32_bf16 v[240:243], v[84:87], a[120:123], v[240:243]
v_mfma_f32_16x16x32_bf16 v[244:247], v[84:87], a[124:127], v[244:247]
v_mfma_f32_16x16x32_bf16 v[212:215], v[80:83], a[124:127], v[212:215]
s_waitcnt vmcnt(18) lgkmcnt(0)
s_barrier
v_mfma_f32_16x16x32_bf16 v[200:203], v[88:91], a[112:115], v[200:203]
ds_read_b64_tr_b16 v[80:81], v32 offset:0
v_mfma_f32_16x16x32_bf16 v[232:235], v[92:95], a[112:115], v[232:235]
ds_read_b64_tr_b16 v[82:83], v32 offset:512
v_mfma_f32_16x16x32_bf16 v[236:239], v[92:95], a[116:119], v[236:239]
ds_read_b64_tr_b16 v[84:85], v33 offset:0
v_mfma_f32_16x16x32_bf16 v[204:207], v[88:91], a[116:119], v[204:207]
ds_read_b64_tr_b16 v[86:87], v33 offset:512
v_mfma_f32_16x16x32_bf16 v[216:219], v[88:91], a[120:123], v[216:219]
v_mfma_f32_16x16x32_bf16 v[248:251], v[92:95], a[120:123], v[248:251]
v_mfma_f32_16x16x32_bf16 v[252:255], v[92:95], a[124:127], v[252:255]
v_mfma_f32_16x16x32_bf16 v[220:223], v[88:91], a[124:127], v[220:223]
s_waitcnt lgkmcnt(2)
v_mfma_f32_16x16x32_bf16 v[192:195], v[80:83], a[128:131], v[192:195]
ds_read_b64_tr_b16 v[88:89], v32 offset:8192
s_waitcnt lgkmcnt(1)
v_mfma_f32_16x16x32_bf16 v[224:227], v[84:87], a[128:131], v[224:227]
ds_read_b64_tr_b16 v[90:91], v32 offset:8704
v_mfma_f32_16x16x32_bf16 v[228:231], v[84:87], a[132:135], v[228:231]
ds_read_b64_tr_b16 v[92:93], v33 offset:8192
v_mfma_f32_16x16x32_bf16 v[196:199], v[80:83], a[132:135], v[196:199]
ds_read_b64_tr_b16 v[94:95], v33 offset:8704
v_mfma_f32_16x16x32_bf16 v[208:211], v[80:83], a[136:139], v[208:211]
v_mfma_f32_16x16x32_bf16 v[240:243], v[84:87], a[136:139], v[240:243]
v_mfma_f32_16x16x32_bf16 v[244:247], v[84:87], a[140:143], v[244:247]
v_mfma_f32_16x16x32_bf16 v[212:215], v[80:83], a[140:143], v[212:215]
s_waitcnt lgkmcnt(2)
v_mfma_f32_16x16x32_bf16 v[200:203], v[88:91], a[128:131], v[200:203]
ds_read_b64_tr_b16 v[80:81], v32 offset:4096
s_waitcnt lgkmcnt(1)
v_mfma_f32_16x16x32_bf16 v[232:235], v[92:95], a[128:131], v[232:235]
ds_read_b64_tr_b16 v[82:83], v32 offset:4608
v_mfma_f32_16x16x32_bf16 v[236:239], v[92:95], a[132:135], v[236:239]
ds_read_b64_tr_b16 v[84:85], v33 offset:4096
v_mfma_f32_16x16x32_bf16 v[204:207], v[88:91], a[132:135], v[204:207]
ds_read_b64_tr_b16 v[86:87], v33 offset:4608
v_mfma_f32_16x16x32_bf16 v[216:219], v[88:91], a[136:139], v[216:219]
v_mfma_f32_16x16x32_bf16 v[248:251], v[92:95], a[136:139], v[248:251]
v_mfma_f32_16x16x32_bf16 v[252:255], v[92:95], a[140:143], v[252:255]
v_mfma_f32_16x16x32_bf16 v[220:223], v[88:91], a[140:143], v[220:223]
s_waitcnt lgkmcnt(2)
v_mfma_f32_16x16x32_bf16 v[192:195], v[80:83], a[144:147], v[192:195]
ds_read_b64_tr_b16 v[88:89], v32 offset:12288
s_waitcnt lgkmcnt(1)
v_mfma_f32_16x16x32_bf16 v[224:227], v[84:87], a[144:147], v[224:227]
ds_read_b64_tr_b16 v[90:91], v32 offset:12800
v_mfma_f32_16x16x32_bf16 v[228:231], v[84:87], a[148:151], v[228:231]
ds_read_b64_tr_b16 v[92:93], v33 offset:12288
v_mfma_f32_16x16x32_bf16 v[196:199], v[80:83], a[148:151], v[196:199]
ds_read_b64_tr_b16 v[94:95], v33 offset:12800
v_mfma_f32_16x16x32_bf16 v[208:211], v[80:83], a[152:155], v[208:211]
v_mfma_f32_16x16x32_bf16 v[240:243], v[84:87], a[152:155], v[240:243]
v_mfma_f32_16x16x32_bf16 v[244:247], v[84:87], a[156:159], v[244:247]
v_mfma_f32_16x16x32_bf16 v[212:215], v[80:83], a[156:159], v[212:215]
s_waitcnt lgkmcnt(2)
v_mfma_f32_16x16x32_bf16 v[200:203], v[88:91], a[144:147], v[200:203]
ds_read_b64_tr_b16 v[80:81], v32 offset:16384
s_waitcnt lgkmcnt(1)
v_mfma_f32_16x16x32_bf16 v[232:235], v[92:95], a[144:147], v[232:235]
ds_read_b64_tr_b16 v[82:83], v32 offset:16896
s_add_u32 m0, s78, 49152
s_nop 0
buffer_load_dwordx4 v44, s[40:43], s81 offen offset:0 lds
v_mfma_f32_16x16x32_bf16 v[236:239], v[92:95], a[148:151], v[236:239]
ds_read_b64_tr_b16 v[84:85], v33 offset:16384
v_mfma_f32_16x16x32_bf16 v[204:207], v[88:91], a[148:151], v[204:207]
ds_read_b64_tr_b16 v[86:87], v33 offset:16896
v_mfma_f32_16x16x32_bf16 v[216:219], v[88:91], a[152:155], v[216:219]
v_mfma_f32_16x16x32_bf16 v[248:251], v[92:95], a[152:155], v[248:251]
buffer_load_dwordx4 v45, s[40:43], s81 offen offset:1024 lds
v_mfma_f32_16x16x32_bf16 v[252:255], v[92:95], a[156:159], v[252:255]
v_mfma_f32_16x16x32_bf16 v[220:223], v[88:91], a[156:159], v[220:223]
s_waitcnt lgkmcnt(2)
v_mfma_f32_16x16x32_bf16 v[192:195], v[80:83], a[160:163], v[192:195]
ds_read_b64_tr_b16 v[88:89], v32 offset:24576
s_waitcnt lgkmcnt(1)
v_mfma_f32_16x16x32_bf16 v[224:227], v[84:87], a[160:163], v[224:227]
ds_read_b64_tr_b16 v[90:91], v32 offset:25088
buffer_load_dwordx4 v46, s[40:43], s81 offen offset:2048 lds
v_mfma_f32_16x16x32_bf16 v[228:231], v[84:87], a[164:167], v[228:231]
ds_read_b64_tr_b16 v[92:93], v33 offset:24576
v_mfma_f32_16x16x32_bf16 v[196:199], v[80:83], a[164:167], v[196:199]
ds_read_b64_tr_b16 v[94:95], v33 offset:25088
v_mfma_f32_16x16x32_bf16 v[208:211], v[80:83], a[168:171], v[208:211]
v_mfma_f32_16x16x32_bf16 v[240:243], v[84:87], a[168:171], v[240:243]
buffer_load_dwordx4 v47, s[40:43], s81 offen offset:3072 lds
v_mfma_f32_16x16x32_bf16 v[244:247], v[84:87], a[172:175], v[244:247]
v_mfma_f32_16x16x32_bf16 v[212:215], v[80:83], a[172:175], v[212:215]
s_waitcnt lgkmcnt(2)
v_mfma_f32_16x16x32_bf16 v[200:203], v[88:91], a[160:163], v[200:203]
ds_read_b64_tr_b16 v[80:81], v32 offset:20480
s_waitcnt lgkmcnt(1)
v_mfma_f32_16x16x32_bf16 v[232:235], v[92:95], a[160:163], v[232:235]
ds_read_b64_tr_b16 v[82:83], v32 offset:20992
s_add_u32 m0, s78, 65536
s_add_u32 s81, s81, 131072
buffer_load_dwordx4 v44, s[40:43], s81 offen offset:0 lds
v_mfma_f32_16x16x32_bf16 v[236:239], v[92:95], a[164:167], v[236:239]
ds_read_b64_tr_b16 v[84:85], v33 offset:20480
v_mfma_f32_16x16x32_bf16 v[204:207], v[88:91], a[164:167], v[204:207]
ds_read_b64_tr_b16 v[86:87], v33 offset:20992
v_mfma_f32_16x16x32_bf16 v[216:219], v[88:91], a[168:171], v[216:219]
v_mfma_f32_16x16x32_bf16 v[248:251], v[92:95], a[168:171], v[248:251]
buffer_load_dwordx4 v45, s[40:43], s81 offen offset:1024 lds
v_mfma_f32_16x16x32_bf16 v[252:255], v[92:95], a[172:175], v[252:255]
v_mfma_f32_16x16x32_bf16 v[220:223], v[88:91], a[172:175], v[220:223]
s_waitcnt lgkmcnt(2)
v_mfma_f32_16x16x32_bf16 v[192:195], v[80:83], a[176:179], v[192:195]
ds_read_b64_tr_b16 v[88:89], v32 offset:28672
s_waitcnt lgkmcnt(1)
v_mfma_f32_16x16x32_bf16 v[224:227], v[84:87], a[176:179], v[224:227]
ds_read_b64_tr_b16 v[90:91], v32 offset:29184
buffer_load_dwordx4 v46, s[40:43], s81 offen offset:2048 lds
v_mfma_f32_16x16x32_bf16 v[228:231], v[84:87], a[180:183], v[228:231]
ds_read_b64_tr_b16 v[92:93], v33 offset:28672
v_mfma_f32_16x16x32_bf16 v[196:199], v[80:83], a[180:183], v[196:199]
ds_read_b64_tr_b16 v[94:95], v33 offset:29184
v_mfma_f32_16x16x32_bf16 v[208:211], v[80:83], a[184:187], v[208:211]
v_mfma_f32_16x16x32_bf16 v[240:243], v[84:87], a[184:187], v[240:243]
buffer_load_dwordx4 v47, s[40:43], s81 offen offset:3072 lds
v_mfma_f32_16x16x32_bf16 v[244:247], v[84:87], a[188:191], v[244:247]
v_mfma_f32_16x16x32_bf16 v[212:215], v[80:83], a[188:191], v[212:215]
s_waitcnt vmcnt(9) lgkmcnt(0)
s_barrier
s_cmp_lg_u32 s68, 0
s_cbranch_scc1 Lfl1
s_atomic_add s85, s[48:49], s61
Lfl1:
v_mfma_f32_16x16x32_bf16 v[200:203], v[88:91], a[176:179], v[200:203]
ds_read_b64_tr_b16 v[80:81], v32 offset:32768
v_mfma_f32_16x16x32_bf16 v[232:235], v[92:95], a[176:179], v[232:235]
ds_read_b64_tr_b16 v[82:83], v32 offset:33280
LhopA2:
s_cbranch_execz LbackA
s_add_u32 m0, s78, 81920
s_add_u32 s81, s81, 131072
buffer_load_dwordx4 v44, s[40:43], s81 offen offset:0 lds
v_mfma_f32_16x16x32_bf16 v[236:239], v[92:95], a[180:183], v[236:239]
ds_read_b64_tr_b16 v[84:85], v33 offset:32768
v_mfma_f32_16x16x32_bf16 v[204:207], v[88:91], a[180:183], v[204:207]
ds_read_b64_tr_b16 v[86:87], v33 offset:33280
v_mfma_f32_16x16x32_bf16 v[216:219], v[88:91], a[184:187], v[216:219]
v_mfma_f32_16x16x32_bf16 v[248:251], v[92:95], a[184:187], v[248:251]
buffer_load_dwordx4 v45, s[40:43], s81 offen offset:1024 lds
v_mfma_f32_16x16x32_bf16 v[252:255], v[92:95], a[188:191], v[252:255]
v_mfma_f32_16x16x32_bf16 v[220:223], v[88:91], a[188:191], v[220:223]
s_waitcnt lgkmcnt(2)
v_mfma_f32_16x16x32_bf16 v[192:195], v[80:83], a[192:195], v[192:195]
ds_read_b64_tr_b16 v[88:89], v32 offset:40960
s_waitcnt lgkmcnt(1)
v_mfma_f32_16x16x32_bf16 v[224:227], v[84:87], a[192:195], v[224:227]
ds_read_b64_tr_b16 v[90:91], v32 offset:41472
buffer_load_dwordx4 v46, s[40:43], s81 offen offset:2048 lds
v_mfma_f32_16x16x32_bf16 v[228:231], v[84:87], a[196:199], v[228:231]
ds_read_b64_tr_b16 v[92:93], v33 offset:40960
v_mfma_f32_16x16x32_bf16 v[196:199], v[80:83], a[196:199], v[196:199]
ds_read_b64_tr_b16 v[94:95], v33 offset:41472
v_mfma_f32_16x16x32_bf16 v[208:211], v[80:83], a[200:203], v[208:211]
v_mfma_f32_16x16x32_bf16 v[240:243], v[84:87], a[200:203], v[240:243]
buffer_load_dwordx4 v47, s[40:43], s81 offen offset:3072 lds
v_mfma_f32_16x16x32_bf16 v[244:247], v[84:87], a[204:207], v[244:247]
v_mfma_f32_16x16x32_bf16 v[212:215], v[80:83], a[204:207], v[212:215]
s_waitcnt lgkmcnt(2)
v_mfma_f32_16x16x32_bf16 v[200:203], v[88:91], a[192:195], v[200:203]
ds_read_b64_tr_b16 v[80:81], v32 offset:36864
s_waitcnt lgkmcnt(1)
v_mfma_f32_16x16x32_bf16 v[232:235], v[92:95], a[192:195], v[232:235]
ds_read_b64_tr_b16 v[82:83], v32 offset:37376
s_add_u32 m0, s78, 114688
s_add_u32 s81, s81, 131072
buffer_load_dwordx4 v44, s[40:43], s81 offen offset:0 lds
v_mfma_f32_16x16x32_bf16 v[236:239], v[92:95], a[196:199], v[236:239]
ds_read_b64_tr_b16 v[84:85], v33 offset:36864
v_mfma_f32_16x16x32_bf16 v[204:207], v[88:91], a[196:199], v[204:207]
ds_read_b64_tr_b16 v[86:87], v33 offset:37376
v_mfma_f32_16x16x32_bf16 v[216:219], v[88:91], a[200:203], v[216:219]
v_mfma_f32_16x16x32_bf16 v[248:251], v[92:95], a[200:203], v[248:251]
buffer_load_dwordx4 v45, s[40:43], s81 offen offset:1024 lds
v_mfma_f32_16x16x32_bf16 v[252:255], v[92:95], a[204:207], v[252:255]
v_mfma_f32_16x16x32_bf16 v[220:223], v[88:91], a[204:207], v[220:223]
s_waitcnt lgkmcnt(2)
v_mfma_f32_16x16x32_bf16 v[192:195], v[80:83], a[208:211], v[192:195]
ds_read_b64_tr_b16 v[88:89], v32 offset:45056
s_waitcnt lgkmcnt(1)
v_mfma_f32_16x16x32_bf16 v[224:227], v[84:87], a[208:211], v[224:227]
ds_read_b64_tr_b16 v[90:91], v32 offset:45568
buffer_load_dwordx4 v46, s[40:43], s81 offen offset:2048 lds
v_mfma_f32_16x16x32_bf16 v[228:231], v[84:87], a[212:215], v[228:231]
ds_read_b64_tr_b16 v[92:93], v33 offset:45056
v_mfma_f32_16x16x32_bf16 v[196:199], v[80:83], a[212:215], v[196:199]
ds_read_b64_tr_b16 v[94:95], v33 offset:45568
v_mfma_f32_16x16x32_bf16 v[208:211], v[80:83], a[216:219], v[208:211]
v_mfma_f32_16x16x32_bf16 v[240:243], v[84:87], a[216:219], v[240:243]
buffer_load_dwordx4 v47, s[40:43], s81 offen offset:3072 lds
v_mfma_f32_16x16x32_bf16 v[244:247], v[84:87], a[220:223], v[244:247]
v_mfma_f32_16x16x32_bf16 v[212:215], v[80:83], a[220:223], v[212:215]
s_waitcnt lgkmcnt(2)
v_mfma_f32_16x16x32_bf16 v[200:203], v[88:91], a[208:211], v[200:203]
ds_read_b64_tr_b16 v[80:81], v34 offset:0
s_waitcnt lgkmcnt(1)
v_mfma_f32_16x16x32_bf16 v[232:235], v[92:95], a[208:211], v[232:235]
ds_read_b64_tr_b16 v[82:83], v34 offset:512
s_add_u32 m0, s78, 131072
s_add_u32 s81, s81, 131072
buffer_load_dwordx4 v44, s[40:43], s81 offen offset:0 lds
v_mfma_f32_16x16x32_bf16 v[236:239], v[92:95], a[212:215], v[236:239]
ds_read_b64_tr_b16 v[84:85], v35 offset:0
v_mfma_f32_16x16x32_bf16 v[204:207], v[88:91], a[212:215], v[204:207]
ds_read_b64_tr_b16 v[86:87], v35 offset:512
v_mfma_f32_16x16x32_bf16 v[216:219], v[88:91], a[216:219], v[216:219]
v_mfma_f32_16x16x32_bf16 v[248:251], v[92:95], a[216:219], v[248:251]
buffer_load_dwordx4 v45, s[40:43], s81 offen offset:1024 lds
v_mfma_f32_16x16x32_bf16 v[252:255], v[92:95], a[220:223], v[252:255]
v_mfma_f32_16x16x32_bf16 v[220:223], v[88:91], a[220:223], v[220:223]
s_waitcnt lgkmcnt(2)
v_mfma_f32_16x16x32_bf16 v[192:195], v[80:83], a[224:227], v[192:195]
ds_read_b64_tr_b16 v[88:89], v34 offset:8192
s_waitcnt lgkmcnt(1)
v_mfma_f32_16x16x32_bf16 v[224:227], v[84:87], a[224:227], v[224:227]
ds_read_b64_tr_b16 v[90:91], v34 offset:8704
buffer_load_dwordx4 v46, s[40:43], s81 offen offset:2048 lds
v_mfma_f32_16x16x32_bf16 v[228:231], v[84:87], a[228:231], v[228:231]
ds_read_b64_tr_b16 v[92:93], v35 offset:8192
v_mfma_f32_16x16x32_bf16 v[196:199], v[80:83], a[228:231], v[196:199]
ds_read_b64_tr_b16 v[94:95], v35 offset:8704
v_mfma_f32_16x16x32_bf16 v[208:211], v[80:83], a[232:235], v[208:211]
v_mfma_f32_16x16x32_bf16 v[240:243], v[84:87], a[232:235], v[240:243]
buffer_load_dwordx4 v47, s[40:43], s81 offen offset:3072 lds
v_mfma_f32_16x16x32_bf16 v[244:247], v[84:87], a[236:239], v[244:247]
v_mfma_f32_16x16x32_bf16 v[212:215], v[80:83], a[236:239], v[212:215]
s_waitcnt lgkmcnt(2)
v_mfma_f32_16x16x32_bf16 v[200:203], v[88:91], a[224:227], v[200:203]
ds_read_b64_tr_b16 v[80:81], v34 offset:4096
s_waitcnt lgkmcnt(1)
v_mfma_f32_16x16x32_bf16 v[232:235], v[92:95], a[224:227], v[232:235]
ds_read_b64_tr_b16 v[82:83], v34 offset:4608
s_add_u32 m0, s78, 147456
s_add_u32 s81, s81, 131072
buffer_load_dwordx4 v44, s[40:43], s81 offen offset:0 lds
v_mfma_f32_16x16x32_bf16 v[236:239], v[92:95], a[228:231], v[236:239]
ds_read_b64_tr_b16 v[84:85], v35 offset:4096
v_mfma_f32_16x16x32_bf16 v[204:207], v[88:91], a[228:231], v[204:207]
ds_read_b64_tr_b16 v[86:87], v35 offset:4608
v_mfma_f32_16x16x32_bf16 v[216:219], v[88:91], a[232:235], v[216:219]
v_mfma_f32_16x16x32_bf16 v[248:251], v[92:95], a[232:235], v[248:251]
buffer_load_dwordx4 v45, s[40:43], s81 offen offset:1024 lds
v_mfma_f32_16x16x32_bf16 v[252:255], v[92:95], a[236:239], v[252:255]
v_mfma_f32_16x16x32_bf16 v[220:223], v[88:91], a[236:239], v[220:223]
s_waitcnt lgkmcnt(2)
v_mfma_f32_16x16x32_bf16 v[192:195], v[80:83], a[240:243], v[192:195]
ds_read_b64_tr_b16 v[88:89], v34 offset:12288
s_waitcnt lgkmcnt(1)
v_mfma_f32_16x16x32_bf16 v[224:227], v[84:87], a[240:243], v[224:227]
ds_read_b64_tr_b16 v[90:91], v34 offset:12800
buffer_load_dwordx4 v46, s[40:43], s81 offen offset:2048 lds
v_mfma_f32_16x16x32_bf16 v[228:231], v[84:87], a[244:247], v[228:231]
ds_read_b64_tr_b16 v[92:93], v35 offset:12288
v_mfma_f32_16x16x32_bf16 v[196:199], v[80:83], a[244:247], v[196:199]
ds_read_b64_tr_b16 v[94:95], v35 offset:12800
v_mfma_f32_16x16x32_bf16 v[208:211], v[80:83], a[248:251], v[208:211]
v_mfma_f32_16x16x32_bf16 v[240:243], v[84:87], a[248:251], v[240:243]
buffer_load_dwordx4 v47, s[40:43], s81 offen offset:3072 lds
v_mfma_f32_16x16x32_bf16 v[244:247], v[84:87], a[252:255], v[244:247]
v_mfma_f32_16x16x32_bf16 v[212:215], v[80:83], a[252:255], v[212:215]
ds_read_b32 v12, v14
s_waitcnt lgkmcnt(1)
s_barrier
v_mfma_f32_16x16x32_bf16 v[200:203], v[88:91], a[240:243], v[200:203]
s_add_u32 m0, s78, 0
s_add_u32 s81, s81, 131072
buffer_load_dwordx4 v44, s[40:43], s81 offen offset:0 lds
v_mfma_f32_16x16x32_bf16 v[232:235], v[92:95], a[240:243], v[232:235]
v_mfma_f32_16x16x32_bf16 v[236:239], v[92:95], a[244:247], v[236:239]
buffer_load_dwordx4 v45, s[40:43], s81 offen offset:1024 lds
v_mfma_f32_16x16x32_bf16 v[204:207], v[88:91], a[244:247], v[204:207]
v_mfma_f32_16x16x32_bf16 v[216:219], v[88:91], a[248:251], v[216:219]
buffer_load_dwordx4 v46, s[40:43], s81 offen offset:2048 lds
v_mfma_f32_16x16x32_bf16 v[248:251], v[92:95], a[248:251], v[248:251]
v_mfma_f32_16x16x32_bf16 v[252:255], v[92:95], a[252:255], v[252:255]
buffer_load_dwordx4 v47, s[40:43], s81 offen offset:3072 lds
v_mfma_f32_16x16x32_bf16 v[220:223], v[88:91], a[252:255], v[220:223]
v_pk_mul_f32 v[2:3], v[192:193], v[192:193]
v_pk_mul_f32 v[4:5], v[194:195], v[194:195]
v_pk_mul_f32 v[6:7], v[196:197], v[196:197]
v_pk_mul_f32 v[8:9], v[198:199], v[198:199]
v_pk_fma_f32 v[2:3], v[2:3], s[90:91], v[54:55] op_sel_hi:[1,0,0]
v_pk_fma_f32 v[4:5], v[4:5], s[90:91], v[54:55] op_sel_hi:[1,0,0]
v_pk_fma_f32 v[6:7], v[6:7], s[90:91], v[54:55] op_sel_hi:[1,0,0]
v_pk_fma_f32 v[8:9], v[8:9], s[90:91], v[54:55] op_sel_hi:[1,0,0]
v_pk_mul_f32 v[2:3], v[2:3], v[192:193]
v_pk_mul_f32 v[4:5], v[4:5], v[194:195]
v_pk_mul_f32 v[6:7], v[6:7], v[196:197]
v_pk_mul_f32 v[8:9], v[8:9], v[198:199]
v_exp_f32 v2, v2
v_exp_f32 v3, v3
v_exp_f32 v4, v4
v_exp_f32 v5, v5
v_exp_f32 v6, v6
v_exp_f32 v7, v7
v_exp_f32 v8, v8
v_exp_f32 v9, v9
v_pk_mul_f32 v[192:193], v[192:193], v[200:201]
v_pk_mul_f32 v[194:195], v[194:195], v[202:203]
v_pk_mul_f32 v[196:197], v[196:197], v[204:205]
v_pk_mul_f32 v[198:199], v[198:199], v[206:207]
v_pk_add_f32 v[2:3], v[2:3], 1.0 op_sel_hi:[1,0]
v_pk_add_f32 v[4:5], v[4:5], 1.0 op_sel_hi:[1,0]
v_pk_add_f32 v[6:7], v[6:7], 1.0 op_sel_hi:[1,0]
v_pk_add_f32 v[8:9], v[8:9], 1.0 op_sel_hi:[1,0]
v_rcp_f32 v2, v2
v_rcp_f32 v3, v3
v_rcp_f32 v4, v4
v_rcp_f32 v5, v5
v_rcp_f32 v6, v6
v_rcp_f32 v7, v7
v_rcp_f32 v8, v8
v_rcp_f32 v9, v9
v_pk_mul_f32 v[192:193], v[192:193], v[2:3] neg_lo:[1,0] neg_hi:[1,0]
v_pk_mul_f32 v[194:195], v[194:195], v[4:5] neg_lo:[1,0] neg_hi:[1,0]
v_pk_mul_f32 v[196:197], v[196:197], v[6:7] neg_lo:[1,0] neg_hi:[1,0]
v_pk_mul_f32 v[198:199], v[198:199], v[8:9] neg_lo:[1,0] neg_hi:[1,0]
v_cvt_pk_bf16_f32 v200, v192, v193
v_cvt_pk_bf16_f32 v202, v196, v197
v_cvt_pk_bf16_f32 v201, v194, v195
v_cvt_pk_bf16_f32 v203, v198, v199
v_pk_mul_f32 v[2:3], v[208:209], v[208:209]
v_pk_mul_f32 v[4:5], v[210:211], v[210:211]
v_permlane16_swap_b32 v200, v202
v_permlane16_swap_b32 v201, v203
v_pk_mul_f32 v[6:7], v[212:213], v[212:213]
v_pk_mul_f32 v[8:9], v[214:215], v[214:215]
buffer_store_dwordx4 v[200:203], v14, s[48:51], s6 offen offset:0 sc1
v_pk_fma_f32 v[2:3], v[2:3], s[90:91], v[54:55] op_sel_hi:[1,0,0]
v_pk_fma_f32 v[4:5], v[4:5], s[90:91], v[54:55] op_sel_hi:[1,0,0]
v_pk_fma_f32 v[6:7], v[6:7], s[90:91], v[54:55] op_sel_hi:[1,0,0]
v_pk_fma_f32 v[8:9], v[8:9], s[90:91], v[54:55] op_sel_hi:[1,0,0]
v_pk_mul_f32 v[2:3], v[2:3], v[208:209]
v_pk_mul_f32 v[4:5], v[4:5], v[210:211]
v_pk_mul_f32 v[6:7], v[6:7], v[212:213]
v_pk_mul_f32 v[8:9], v[8:9], v[214:215]
v_exp_f32 v2, v2
v_exp_f32 v3, v3
v_exp_f32 v4, v4
v_exp_f32 v5, v5
v_exp_f32 v6, v6
v_exp_f32 v7, v7
v_exp_f32 v8, v8
v_exp_f32 v9, v9
v_pk_mul_f32 v[208:209], v[208:209], v[216:217]
v_pk_mul_f32 v[210:211], v[210:211], v[218:219]
v_pk_mul_f32 v[212:213], v[212:213], v[220:221]
v_pk_mul_f32 v[214:215], v[214:215], v[222:223]
v_pk_add_f32 v[2:3], v[2:3], 1.0 op_sel_hi:[1,0]
v_pk_add_f32 v[4:5], v[4:5], 1.0 op_sel_hi:[1,0]
v_pk_add_f32 v[6:7], v[6:7], 1.0 op_sel_hi:[1,0]
v_pk_add_f32 v[8:9], v[8:9], 1.0 op_sel_hi:[1,0]
v_rcp_f32 v2, v2
v_rcp_f32 v3, v3
v_rcp_f32 v4, v4
v_rcp_f32 v5, v5
v_rcp_f32 v6, v6
v_rcp_f32 v7, v7
v_rcp_f32 v8, v8
v_rcp_f32 v9, v9
v_pk_mul_f32 v[208:209], v[208:209], v[2:3] neg_lo:[1,0] neg_hi:[1,0]
v_pk_mul_f32 v[210:211], v[210:211], v[4:5] neg_lo:[1,0] neg_hi:[1,0]
v_pk_mul_f32 v[212:213], v[212:213], v[6:7] neg_lo:[1,0] neg_hi:[1,0]
v_pk_mul_f32 v[214:215], v[214:215], v[8:9] neg_lo:[1,0] neg_hi:[1,0]
v_cvt_pk_bf16_f32 v216, v208, v209
v_cvt_pk_bf16_f32 v218, v212, v213
v_cvt_pk_bf16_f32 v217, v210, v211
v_cvt_pk_bf16_f32 v219, v214, v215
v_pk_mul_f32 v[2:3], v[224:225], v[224:225]
v_pk_mul_f32 v[4:5], v[226:227], v[226:227]
v_permlane16_swap_b32 v216, v218
v_permlane16_swap_b32 v217, v219
v_pk_mul_f32 v[6:7], v[228:229], v[228:229]
v_pk_mul_f32 v[8:9], v[230:231], v[230:231]
buffer_store_dwordx4 v[216:219], v14, s[48:51], s6 offen offset:2048 sc1
v_pk_fma_f32 v[2:3], v[2:3], s[90:91], v[54:55] op_sel_hi:[1,0,0]
v_pk_fma_f32 v[4:5], v[4:5], s[90:91], v[54:55] op_sel_hi:[1,0,0]
s_cmp_lg_u32 s68, 0
s_cbranch_scc1 Lpi2
s_mov_b32 s84, 0
s_atomic_add s84, s[48:49], s63 glc
Lpi2:
s_nop 0
v_pk_fma_f32 v[6:7], v[6:7], s[90:91], v[54:55] op_sel_hi:[1,0,0]
v_pk_fma_f32 v[8:9], v[8:9], s[90:91], v[54:55] op_sel_hi:[1,0,0]
v_pk_mul_f32 v[2:3], v[2:3], v[224:225]
v_pk_mul_f32 v[4:5], v[4:5], v[226:227]
v_pk_mul_f32 v[6:7], v[6:7], v[228:229]
v_pk_mul_f32 v[8:9], v[8:9], v[230:231]
v_exp_f32 v2, v2
v_exp_f32 v3, v3
v_exp_f32 v4, v4
v_exp_f32 v5, v5
v_exp_f32 v6, v6
v_exp_f32 v7, v7
v_exp_f32 v8, v8
v_exp_f32 v9, v9
v_pk_mul_f32 v[224:225], v[224:225], v[232:233]
v_pk_mul_f32 v[226:227], v[226:227], v[234:235]
v_pk_mul_f32 v[228:229], v[228:229], v[236:237]
v_pk_mul_f32 v[230:231], v[230:231], v[238:239]
v_pk_add_f32 v[2:3], v[2:3], 1.0 op_sel_hi:[1,0]
v_pk_add_f32 v[4:5], v[4:5], 1.0 op_sel_hi:[1,0]
v_pk_add_f32 v[6:7], v[6:7], 1.0 op_sel_hi:[1,0]
v_pk_add_f32 v[8:9], v[8:9], 1.0 op_sel_hi:[1,0]
v_rcp_f32 v2, v2
v_rcp_f32 v3, v3
v_rcp_f32 v4, v4
v_rcp_f32 v5, v5
v_rcp_f32 v6, v6
v_rcp_f32 v7, v7
v_rcp_f32 v8, v8
v_rcp_f32 v9, v9
v_pk_mul_f32 v[224:225], v[224:225], v[2:3] neg_lo:[1,0] neg_hi:[1,0]
v_pk_mul_f32 v[226:227], v[226:227], v[4:5] neg_lo:[1,0] neg_hi:[1,0]
v_pk_mul_f32 v[228:229], v[228:229], v[6:7] neg_lo:[1,0] neg_hi:[1,0]
v_pk_mul_f32 v[230:231], v[230:231], v[8:9] neg_lo:[1,0] neg_hi:[1,0]
v_cvt_pk_bf16_f32 v232, v224, v225
v_cvt_pk_bf16_f32 v234, v228, v229
v_cvt_pk_bf16_f32 v233, v226, v227
v_cvt_pk_bf16_f32 v235, v230, v231
v_pk_mul_f32 v[2:3], v[240:241], v[240:241]
v_pk_mul_f32 v[4:5], v[242:243], v[242:243]
v_permlane16_swap_b32 v232, v234
v_permlane16_swap_b32 v233, v235
v_pk_mul_f32 v[6:7], v[244:245], v[244:245]
v_pk_mul_f32 v[8:9], v[246:247], v[246:247]
buffer_store_dwordx4 v[232:235], v14, s[48:51], s7 offen offset:0 sc1
v_pk_fma_f32 v[2:3], v[2:3], s[90:91], v[54:55] op_sel_hi:[1,0,0]
v_pk_fma_f32 v[4:5], v[4:5], s[90:91], v[54:55] op_sel_hi:[1,0,0]
v_pk_fma_f32 v[6:7], v[6:7], s[90:91], v[54:55] op_sel_hi:[1,0,0]
v_pk_fma_f32 v[8:9], v[8:9], s[90:91], v[54:55] op_sel_hi:[1,0,0]
v_pk_mul_f32 v[2:3], v[2:3], v[240:241]
v_pk_mul_f32 v[4:5], v[4:5], v[242:243]
v_pk_mul_f32 v[6:7], v[6:7], v[244:245]
v_pk_mul_f32 v[8:9], v[8:9], v[246:247]
v_exp_f32 v2, v2
v_exp_f32 v3, v3
v_exp_f32 v4, v4
v_exp_f32 v5, v5
v_exp_f32 v6, v6
v_exp_f32 v7, v7
v_exp_f32 v8, v8
v_exp_f32 v9, v9
v_pk_mul_f32 v[240:241], v[240:241], v[248:249]
v_pk_mul_f32 v[242:243], v[242:243], v[250:251]
v_pk_mul_f32 v[244:245], v[244:245], v[252:253]
v_pk_mul_f32 v[246:247], v[246:247], v[254:255]
v_pk_add_f32 v[2:3], v[2:3], 1.0 op_sel_hi:[1,0]
v_pk_add_f32 v[4:5], v[4:5], 1.0 op_sel_hi:[1,0]
v_pk_add_f32 v[6:7], v[6:7], 1.0 op_sel_hi:[1,0]
v_pk_add_f32 v[8:9], v[8:9], 1.0 op_sel_hi:[1,0]
v_rcp_f32 v2, v2
v_rcp_f32 v3, v3
v_rcp_f32 v4, v4
v_rcp_f32 v5, v5
v_rcp_f32 v6, v6
v_rcp_f32 v7, v7
v_rcp_f32 v8, v8
v_rcp_f32 v9, v9
v_pk_mul_f32 v[240:241], v[240:241], v[2:3] neg_lo:[1,0] neg_hi:[1,0]
v_pk_mul_f32 v[242:243], v[242:243], v[4:5] neg_lo:[1,0] neg_hi:[1,0]
v_pk_mul_f32 v[244:245], v[244:245], v[6:7] neg_lo:[1,0] neg_hi:[1,0]
v_pk_mul_f32 v[246:247], v[246:247], v[8:9] neg_lo:[1,0] neg_hi:[1,0]
v_cvt_pk_bf16_f32 v248, v240, v241
v_cvt_pk_bf16_f32 v250, v244, v245
v_cvt_pk_bf16_f32 v249, v242, v243
v_cvt_pk_bf16_f32 v251, v246, v247
v_permlane16_swap_b32 v248, v250
v_nop_e64
v_permlane16_swap_b32 v249, v251
buffer_store_dwordx4 v[248:251], v14, s[48:51], s7 offen offset:2048 sc1
v_and_b32 v31, 7, v1
v_lshlrev_b32 v31, 4, v31
v_bfe_u32 v29, v1, 3, 1
v_lshl_add_u32 v31, v29, 8, v31
v_bfe_u32 v29, v1, 4, 1
v_lshl_add_u32 v31, v29, 10, v31
v_lshrrev_b32_e64 v29, 5, v1
v_lshl_add_u32 v31, v29, 12, v31
s_lshr_b32 s3, s68, 1
v_and_b32 v29, s3, v29
v_lshl_or_b32 v29, v29, 30, v31
v_and_b32_e64 v30, 15, v1
v_lshlrev_b32 v30, 2, v30
s_waitcnt vmcnt(28)
ds_read_b64_tr_b16 a[0:1], v48 offset:49152
ds_read_b64_tr_b16 a[2:3], v48 offset:50176
ds_read_b64_tr_b16 a[4:5], v49 offset:49152
ds_read_b64_tr_b16 a[6:7], v49 offset:50176
ds_read_b64_tr_b16 a[8:9], v50 offset:49152
ds_read_b64_tr_b16 a[10:11], v50 offset:50176
ds_read_b64_tr_b16 a[12:13], v51 offset:49152
ds_read_b64_tr_b16 a[14:15], v51 offset:50176
s_waitcnt lgkmcnt(0)
s_cmp_lg_u32 s68, 0
s_cbranch_scc1 Lok3
s_cmp_ge_u32 s84, 8
s_cbranch_scc1 Lok3
s_mov_b32 s93, 0
Lsp3:
s_mov_b32 s84, 0
s_atomic_add s84, s[48:49], s63 glc
s_add_u32 s93, s93, 1
s_waitcnt lgkmcnt(0)
s_cmp_ge_u32 s84, 8
s_cbranch_scc1 Lok3
s_cmp_lt_u32 s93, 0x8000
s_cbranch_scc1 Lsp3
Lok3:
s_barrier
s_nop 0
buffer_load_dwordx4 v[56:59], v31, s[48:51], s86 offen offset:0 sc1
buffer_load_dwordx4 v[60:63], v31, s[48:51], s86 offen offset:512 sc1
buffer_load_dwordx4 v[64:67], v31, s[48:51], s86 offen offset:2048 sc1
buffer_load_dwordx4 v[68:71], v31, s[48:51], s86 offen offset:2560 sc1
s_add_u32 s86, s86, 8192
buffer_load_dwordx4 v[72:75], v31, s[48:51], s86 offen offset:0 sc1
buffer_load_dwordx4 v[76:79], v31, s[48:51], s86 offen offset:512 sc1
buffer_load_dwordx4 v[80:83], v31, s[48:51], s86 offen offset:2048 sc1
buffer_load_dwordx4 v[84:87], v31, s[48:51], s86 offen offset:2560 sc1
s_add_u32 s86, s86, 8192
buffer_load_dwordx4 v[88:91], v31, s[48:51], s86 offen offset:0 sc1
buffer_load_dwordx4 v[92:95], v31, s[48:51], s86 offen offset:512 sc1
s_waitcnt vmcnt(10)
s_barrier
s_cmp_lg_u32 s68, 0
s_cbranch_scc1 Lfl4
s_atomic_add s85, s[48:49], s60
Lfl4:
s_waitcnt vmcnt(9)
v_mfma_f32_16x16x32_bf16 v[128:131], a[0:3], v[56:59], 0
buffer_load_dwordx4 v[96:99], v31, s[48:51], s86 offen offset:2048 sc1
s_add_u32 m0, s78, 16384
s_add_u32 s81, s81, 131072
s_waitcnt vmcnt(9)
v_mfma_f32_16x16x32_bf16 v[144:147], a[0:3], v[60:63], 0
buffer_load_dwordx4 v44, s[40:43], s81 offen offset:0 lds
buffer_load_dwordx4 v45, s[40:43], s81 offen offset:1024 lds
buffer_load_dwordx4 v46, s[40:43], s81 offen offset:2048 lds
v_mfma_f32_16x16x32_bf16 v[132:135], a[4:7], v[56:59], 0
buffer_load_dwordx4 v47, s[40:43], s81 offen offset:3072 lds
v_mfma_f32_16x16x32_bf16 v[148:151], a[4:7], v[60:63], 0
v_add_u32 v48, 65536, v48
ds_read_b64_tr_b16 a[16:17], v48 offset:0
ds_read_b64_tr_b16 a[18:19], v48 offset:1024
v_mfma_f32_16x16x32_bf16 v[136:139], a[8:11], v[56:59], 0
buffer_load_dwordx4 v[100:103], v31, s[48:51], s86 offen offset:2560 sc1
s_add_u32 s86, s86, 8192
v_add_u32 v49, 65536, v49
v_mfma_f32_16x16x32_bf16 v[152:155], a[8:11], v[60:63], 0
ds_read_b64_tr_b16 a[20:21], v49 offset:0
ds_read_b64_tr_b16 a[22:23], v49 offset:1024
v_add_u32 v50, 65536, v50
ds_read_b64_tr_b16 a[24:25], v50 offset:0
v_mfma_f32_16x16x32_bf16 v[140:143], a[12:15], v[56:59], 0
ds_read_b64_tr_b16 a[26:27], v50 offset:1024
v_add_u32 v51, 65536, v51
v_mfma_f32_16x16x32_bf16 v[156:159], a[12:15], v[60:63], 0
ds_read_b64_tr_b16 a[28:29], v51 offset:0
ds_read_b64_tr_b16 a[30:31], v51 offset:1024
s_waitcnt vmcnt(13)
v_mfma_f32_16x16x32_bf16 v[160:163], a[0:3], v[64:67], 0
buffer_load_dwordx4 v[104:107], v31, s[48:51], s86 offen offset:0 sc1
s_add_u32 m0, s78, 32768
s_waitcnt vmcnt(13)
v_mfma_f32_16x16x32_bf16 v[176:179], a[0:3], v[68:71], 0
s_add_u32 s81, s81, 131072
buffer_load_dwordx4 v44, s[40:43], s81 offen offset:0 lds
buffer_load_dwordx4 v45, s[40:43], s81 offen offset:1024 lds
v_mfma_f32_16x16x32_bf16 v[164:167], a[4:7], v[64:67], 0
s_cmp_ge_u32 s68, 2
s_cselect_b32 s0, 0x40000000, s81
v_mfma_f32_16x16x32_bf16 v[180:183], a[4:7], v[68:71], 0
buffer_load_dwordx4 v46, s[40:43], s0 offen offset:2048 lds
buffer_load_dwordx4 v47, s[40:43], s0 offen offset:3072 lds
v_mfma_f32_16x16x32_bf16 v[168:171], a[8:11], v[64:67], 0
buffer_load_dwordx4 v[108:111], v31, s[48:51], s86 offen offset:512 sc1
s_add_u32 m0, s78, 98304
v_mfma_f32_16x16x32_bf16 v[184:187], a[8:11], v[68:71], 0
s_add_u32 s81, s81, 98304
buffer_load_dwordx4 v44, s[40:43], s81 offen offset:0 lds
buffer_load_dwordx4 v45, s[40:43], s81 offen offset:1024 lds
v_mfma_f32_16x16x32_bf16 v[172:175], a[12:15], v[64:67], 0
buffer_load_dwordx4 v46, s[40:43], s81 offen offset:2048 lds
v_mfma_f32_16x16x32_bf16 v[188:191], a[12:15], v[68:71], 0
buffer_load_dwordx4 v47, s[40:43], s81 offen offset:3072 lds
s_waitcnt vmcnt(21) lgkmcnt(6)
v_mfma_f32_16x16x32_bf16 v[128:131], a[16:19], v[72:75], v[128:131]
buffer_load_dwordx4 v[112:115], v31, s[48:51], s86 offen offset:2048 sc1
s_add_u32 m0, s78, 49152
s_add_u32 s81, s81, 131072
buffer_load_dwordx4 v44, s[40:43], s81 offen offset:0 lds
s_waitcnt vmcnt(22)
v_mfma_f32_16x16x32_bf16 v[144:147], a[16:19], v[76:79], v[144:147]
buffer_load_dwordx4 v45, s[40:43], s81 offen offset:1024 lds
buffer_load_dwordx4 v46, s[40:43], s81 offen offset:2048 lds
buffer_load_dwordx4 v47, s[40:43], s81 offen offset:3072 lds
ds_read_b64_tr_b16 a[32:33], v48 offset:16384
s_waitcnt lgkmcnt(5)
v_mfma_f32_16x16x32_bf16 v[132:135], a[20:23], v[72:75], v[132:135]
ds_read_b64_tr_b16 a[34:35], v48 offset:17408
ds_read_b64_tr_b16 a[36:37], v49 offset:16384
v_mfma_f32_16x16x32_bf16 v[148:151], a[20:23], v[76:79], v[148:151]
ds_read_b64_tr_b16 a[38:39], v49 offset:17408
ds_read_b64_tr_b16 a[40:41], v50 offset:16384
ds_read_b64_tr_b16 a[42:43], v50 offset:17408
s_waitcnt lgkmcnt(8)
v_mfma_f32_16x16x32_bf16 v[136:139], a[24:27], v[72:75], v[136:139]
buffer_load_dwordx4 v[116:119], v31, s[48:51], s86 offen offset:2560 sc1
s_add_u32 s86, s86, 8192
ds_read_b64_tr_b16 a[44:45], v51 offset:16384
ds_read_b64_tr_b16 a[46:47], v51 offset:17408
v_mfma_f32_16x16x32_bf16 v[152:155], a[24:27], v[76:79], v[152:155]
ds_read_b64_tr_b16 a[48:49], v48 offset:49152
ds_read_b64_tr_b16 a[50:51], v48 offset:50176
ds_read_b64_tr_b16 a[52:53], v49 offset:49152
s_waitcnt lgkmcnt(11)
v_mfma_f32_16x16x32_bf16 v[140:143], a[28:31], v[72:75], v[140:143]
ds_read_b64_tr_b16 a[54:55], v49 offset:50176
ds_read_b64_tr_b16 a[56:57], v50 offset:49152
v_mfma_f32_16x16x32_bf16 v[156:159], a[28:31], v[76:79], v[156:159]
ds_read_b64_tr_b16 a[58:59], v50 offset:50176
ds_read_b64_tr_b16 a[60:61], v51 offset:49152
ds_read_b64_tr_b16 a[62:63], v51 offset:50176
s_waitcnt vmcnt(25)
v_mfma_f32_16x16x32_bf16 v[160:163], a[16:19], v[80:83], v[160:163]
buffer_load_dwordx4 v[120:123], v31, s[48:51], s86 offen offset:0 sc1
v_add_u32 v48, 65536, v48
ds_read_b64_tr_b16 a[64:65], v48 offset:0
ds_read_b64_tr_b16 a[66:67], v48 offset:1024
s_waitcnt vmcnt(25)
v_mfma_f32_16x16x32_bf16 v[176:179], a[16:19], v[84:87], v[176:179]
s_nop 0
v_add_u32 v49, 65536, v49
ds_read_b64_tr_b16 a[68:69], v49 offset:0
ds_read_b64_tr_b16 a[70:71], v49 offset:1024
v_add_u32 v50, 65536, v50
ds_read_b64_tr_b16 a[72:73], v50 offset:0
ds_read_b64_tr_b16 a[74:75], v50 offset:1024
v_mfma_f32_16x16x32_bf16 v[164:167], a[20:23], v[80:83], v[164:167]
v_add_u32 v51, 65536, v51
ds_read_b64_tr_b16 a[76:77], v51 offset:0
ds_read_b64_tr_b16 a[78:79], v51 offset:1024
v_mfma_f32_16x16x32_bf16 v[180:183], a[20:23], v[84:87], v[180:183]
ds_read_b64_tr_b16 a[80:81], v48 offset:16384
ds_read_b64_tr_b16 a[82:83], v48 offset:17408
ds_read_b64_tr_b16 a[84:85], v49 offset:16384
ds_read_b64_tr_b16 a[86:87], v49 offset:17408
v_mfma_f32_16x16x32_bf16 v[168:171], a[24:27], v[80:83], v[168:171]
buffer_load_dwordx4 v[124:127], v31, s[48:51], s86 offen offset:512 sc1
ds_read_b64_tr_b16 a[88:89], v50 offset:16384
ds_read_b64_tr_b16 a[90:91], v50 offset:17408
ds_read_b64_tr_b16 a[92:93], v51 offset:16384
v_mfma_f32_16x16x32_bf16 v[184:187], a[24:27], v[84:87], v[184:187]
ds_read_b64_tr_b16 a[94:95], v51 offset:17408
v_subrev_u32 v48, 131072, v48
ds_read_b64_tr_b16 a[96:97], v48 offset:0
ds_read_b64_tr_b16 a[98:99], v48 offset:1024
v_mfma_f32_16x16x32_bf16 v[172:175], a[28:31], v[80:83], v[172:175]
v_subrev_u32 v49, 131072, v49
ds_read_b64_tr_b16 a[100:101], v49 offset:0
ds_read_b64_tr_b16 a[102:103], v49 offset:1024
v_subrev_u32 v50, 131072, v50
v_mfma_f32_16x16x32_bf16 v[188:191], a[28:31], v[84:87], v[188:191]
ds_read_b64_tr_b16 a[104:105], v50 offset:0
ds_read_b64_tr_b16 a[106:107], v50 offset:1024
v_subrev_u32 v51, 131072, v51
ds_read_b64_tr_b16 a[108:109], v51 offset:0
ds_read_b64_tr_b16 a[110:111], v51 offset:1024
s_waitcnt vmcnt(25) lgkmcnt(14)
v_mfma_f32_16x16x32_bf16 v[128:131], a[32:35], v[88:91], v[128:131]
buffer_load_dwordx4 v[56:59], v31, s[48:51], s86 offen offset:2048 sc1
s_waitcnt vmcnt(20)
v_mfma_f32_16x16x32_bf16 v[144:147], a[32:35], v[92:95], v[144:147]
ds_read_b64_tr_b16 a[112:113], v48 offset:16384
ds_read_b64_tr_b16 a[114:115], v48 offset:17408
v_mfma_f32_16x16x32_bf16 v[132:135], a[36:39], v[88:91], v[132:135]
ds_read_b64_tr_b16 a[116:117], v49 offset:16384
v_mfma_f32_16x16x32_bf16 v[148:151], a[36:39], v[92:95], v[148:151]
ds_read_b64_tr_b16 a[118:119], v49 offset:17408
v_mfma_f32_16x16x32_bf16 v[136:139], a[40:43], v[88:91], v[136:139]
buffer_load_dwordx4 v[60:63], v31, s[48:51], s86 offen offset:2560 sc1
s_add_u32 s86, s86, 8192
v_mfma_f32_16x16x32_bf16 v[152:155], a[40:43], v[92:95], v[152:155]
ds_read_b64_tr_b16 a[120:121], v50 offset:16384
ds_read_b64_tr_b16 a[122:123], v50 offset:17408
v_mfma_f32_16x16x32_bf16 v[140:143], a[44:47], v[88:91], v[140:143]
ds_read_b64_tr_b16 a[124:125], v51 offset:16384
v_mfma_f32_16x16x32_bf16 v[156:159], a[44:47], v[92:95], v[156:159]
ds_read_b64_tr_b16 a[126:127], v51 offset:17408
v_mfma_f32_16x16x32_bf16 v[160:163], a[32:35], v[96:99], v[160:163]
s_waitcnt vmcnt(20)
v_mfma_f32_16x16x32_bf16 v[176:179], a[32:35], v[100:103], v[176:179]
buffer_load_dwordx4 v[64:67], v31, s[48:51], s86 offen offset:0 sc1
v_mfma_f32_16x16x32_bf16 v[164:167], a[36:39], v[96:99], v[164:167]
v_mfma_f32_16x16x32_bf16 v[180:183], a[36:39], v[100:103], v[180:183]
v_mfma_f32_16x16x32_bf16 v[168:171], a[40:43], v[96:99], v[168:171]
v_mfma_f32_16x16x32_bf16 v[184:187], a[40:43], v[100:103], v[184:187]
buffer_load_dwordx4 v[68:71], v31, s[48:51], s86 offen offset:512 sc1
v_mfma_f32_16x16x32_bf16 v[172:175], a[44:47], v[96:99], v[172:175]
v_mfma_f32_16x16x32_bf16 v[188:191], a[44:47], v[100:103], v[188:191]
s_waitcnt vmcnt(21)
v_mfma_f32_16x16x32_bf16 v[128:131], a[48:51], v[104:107], v[128:131]
buffer_load_dwordx4 v[72:75], v31, s[48:51], s86 offen offset:2048 sc1
s_waitcnt vmcnt(18)
s_waitcnt vmcnt(17)
v_mfma_f32_16x16x32_bf16 v[144:147], a[48:51], v[108:111], v[144:147]
ds_read_b64_tr_b16 a[128:129], v48 offset:32768
ds_read_b64_tr_b16 a[130:131], v48 offset:33792
v_mfma_f32_16x16x32_bf16 v[132:135], a[52:55], v[104:107], v[132:135]
ds_read_b64_tr_b16 a[132:133], v49 offset:32768
v_mfma_f32_16x16x32_bf16 v[148:151], a[52:55], v[108:111], v[148:151]
ds_read_b64_tr_b16 a[134:135], v49 offset:33792
LhopA3:
s_cbranch_execz LbackA
v_mfma_f32_16x16x32_bf16 v[136:139], a[56:59], v[104:107], v[136:139]
buffer_load_dwordx4 v[76:79], v31, s[48:51], s86 offen offset:2560 sc1
s_add_u32 s86, s86, 8192
v_mfma_f32_16x16x32_bf16 v[152:155], a[56:59], v[108:111], v[152:155]
ds_read_b64_tr_b16 a[136:137], v50 offset:32768
ds_read_b64_tr_b16 a[138:139], v50 offset:33792
v_mfma_f32_16x16x32_bf16 v[140:143], a[60:63], v[104:107], v[140:143]
ds_read_b64_tr_b16 a[140:141], v51 offset:32768
v_mfma_f32_16x16x32_bf16 v[156:159], a[60:63], v[108:111], v[156:159]
ds_read_b64_tr_b16 a[142:143], v51 offset:33792
s_waitcnt vmcnt(13)
v_mfma_f32_16x16x32_bf16 v[160:163], a[48:51], v[112:115], v[160:163]
buffer_load_dwordx4 v[80:83], v31, s[48:51], s86 offen offset:0 sc1
s_add_u32 s63, s63, 4096
s_cmp_lg_u32 s68, 0
s_cbranch_scc1 Lpi5
s_mov_b32 s84, 0
s_atomic_add s84, s[48:49], s63 glc
Lpi5:
s_waitcnt vmcnt(9)
v_mfma_f32_16x16x32_bf16 v[176:179], a[48:51], v[116:119], v[176:179]
s_add_u32 m0, s78, 65536
s_sub_u32 s81, s81, 1277952
buffer_load_dwordx4 v44, s[44:47], s81 offen offset:0 lds
buffer_load_dwordx4 v45, s[44:47], s81 offen offset:1024 lds
buffer_load_dwordx4 v46, s[44:47], s81 offen offset:2048 lds
v_mfma_f32_16x16x32_bf16 v[164:167], a[52:55], v[112:115], v[164:167]
buffer_load_dwordx4 v47, s[44:47], s81 offen offset:3072 lds
v_mfma_f32_16x16x32_bf16 v[180:183], a[52:55], v[116:119], v[180:183]
v_add_u32 v48, 65536, v48
ds_read_b64_tr_b16 a[144:145], v48 offset:32768
ds_read_b64_tr_b16 a[146:147], v48 offset:33792
v_mfma_f32_16x16x32_bf16 v[168:171], a[56:59], v[112:115], v[168:171]
buffer_load_dwordx4 v[84:87], v31, s[48:51], s86 offen offset:512 sc1
v_add_u32 v49, 65536, v49
ds_read_b64_tr_b16 a[148:149], v49 offset:32768
v_mfma_f32_16x16x32_bf16 v[184:187], a[56:59], v[116:119], v[184:187]
ds_read_b64_tr_b16 a[150:151], v49 offset:33792
v_add_u32 v50, 65536, v50
ds_read_b64_tr_b16 a[152:153], v50 offset:32768
v_mfma_f32_16x16x32_bf16 v[172:175], a[60:63], v[112:115], v[172:175]
ds_read_b64_tr_b16 a[154:155], v50 offset:33792
v_add_u32 v51, 65536, v51
v_mfma_f32_16x16x32_bf16 v[188:191], a[60:63], v[116:119], v[188:191]
ds_read_b64_tr_b16 a[156:157], v51 offset:32768
ds_read_b64_tr_b16 a[158:159], v51 offset:33792
s_waitcnt vmcnt(13)
v_mfma_f32_16x16x32_bf16 v[128:131], a[64:67], v[120:123], v[128:131]
buffer_load_dwordx4 v[88:91], v31, s[48:51], s86 offen offset:2048 sc1
s_waitcnt vmcnt(13)
v_mfma_f32_16x16x32_bf16 v[144:147], a[64:67], v[124:127], v[144:147]
s_add_u32 m0, s78, 81920
s_add_u32 s81, s81, 131072
buffer_load_dwordx4 v44, s[44:47], s81 offen offset:0 lds
v_mfma_f32_16x16x32_bf16 v[132:135], a[68:71], v[120:123], v[132:135]
v_mfma_f32_16x16x32_bf16 v[148:151], a[68:71], v[124:127], v[148:151]
buffer_load_dwordx4 v45, s[44:47], s81 offen offset:1024 lds
v_mfma_f32_16x16x32_bf16 v[136:139], a[72:75], v[120:123], v[136:139]
buffer_load_dwordx4 v[92:95], v31, s[48:51], s86 offen offset:2560 sc1
v_mfma_f32_16x16x32_bf16 v[152:155], a[72:75], v[124:127], v[152:155]
s_add_u32 s86, s86, 8192
buffer_load_dwordx4 v46, s[44:47], s81 offen offset:2048 lds
v_mfma_f32_16x16x32_bf16 v[140:143], a[76:79], v[120:123], v[140:143]
v_mfma_f32_16x16x32_bf16 v[156:159], a[76:79], v[124:127], v[156:159]
buffer_load_dwordx4 v47, s[44:47], s81 offen offset:3072 lds
s_waitcnt lgkmcnt(0)
s_cmp_lg_u32 s68, 0
s_cbranch_scc1 Lok6
s_cmp_ge_u32 s84, 8
s_cbranch_scc1 Lok6
s_mov_b32 s93, 0
Lsp6:
s_mov_b32 s84, 0
s_atomic_add s84, s[48:49], s63 glc
s_add_u32 s93, s93, 1
s_waitcnt lgkmcnt(0)
s_cmp_ge_u32 s84, 8
s_cbranch_scc1 Lok6
s_cmp_lt_u32 s93, 0x8000
s_cbranch_scc1 Lsp6
Lok6:
s_barrier
s_waitcnt vmcnt(17)
v_mfma_f32_16x16x32_bf16 v[160:163], a[64:67], v[56:59], v[160:163]
buffer_load_dwordx4 v[96:99], v31, s[48:51], s86 offen offset:0 sc1
s_waitcnt vmcnt(17)
v_mfma_f32_16x16x32_bf16 v[176:179], a[64:67], v[60:63], v[176:179]
v_subrev_u32 v48, 65536, v48
ds_read_b64_tr_b16 a[160:161], v48 offset:49152
ds_read_b64_tr_b16 a[162:163], v48 offset:50176
v_mfma_f32_16x16x32_bf16 v[164:167], a[68:71], v[56:59], v[164:167]
v_subrev_u32 v49, 65536, v49
v_mfma_f32_16x16x32_bf16 v[180:183], a[68:71], v[60:63], v[180:183]
ds_read_b64_tr_b16 a[164:165], v49 offset:49152
ds_read_b64_tr_b16 a[166:167], v49 offset:50176
v_mfma_f32_16x16x32_bf16 v[168:171], a[72:75], v[56:59], v[168:171]
buffer_load_dwordx4 v[100:103], v31, s[48:51], s86 offen offset:512 sc1
v_subrev_u32 v50, 65536, v50
v_mfma_f32_16x16x32_bf16 v[184:187], a[72:75], v[60:63], v[184:187]
ds_read_b64_tr_b16 a[168:169], v50 offset:49152
ds_read_b64_tr_b16 a[170:171], v50 offset:50176
v_mfma_f32_16x16x32_bf16 v[172:175], a[76:79], v[56:59], v[172:175]
v_subrev_u32 v51, 65536, v51
v_mfma_f32_16x16x32_bf16 v[188:191], a[76:79], v[60:63], v[188:191]
ds_read_b64_tr_b16 a[172:173], v51 offset:49152
ds_read_b64_tr_b16 a[174:175], v51 offset:50176
s_waitcnt vmcnt(17)
v_mfma_f32_16x16x32_bf16 v[128:131], a[80:83], v[64:67], v[128:131]
s_waitcnt vmcnt(16)
v_mfma_f32_16x16x32_bf16 v[144:147], a[80:83], v[68:71], v[144:147]
buffer_load_dwordx4 v[104:107], v31, s[48:51], s86 offen offset:2048 sc1
v_mfma_f32_16x16x32_bf16 v[132:135], a[84:87], v[64:67], v[132:135]
v_mfma_f32_16x16x32_bf16 v[148:151], a[84:87], v[68:71], v[148:151]
v_mfma_f32_16x16x32_bf16 v[136:139], a[88:91], v[64:67], v[136:139]
buffer_load_dwordx4 v[108:111], v31, s[48:51], s86 offen offset:2560 sc1
v_mfma_f32_16x16x32_bf16 v[152:155], a[88:91], v[68:71], v[152:155]
s_add_u32 s86, s86, 8192
v_mfma_f32_16x16x32_bf16 v[140:143], a[92:95], v[64:67], v[140:143]
v_mfma_f32_16x16x32_bf16 v[156:159], a[92:95], v[68:71], v[156:159]
s_waitcnt vmcnt(17)
v_mfma_f32_16x16x32_bf16 v[160:163], a[80:83], v[72:75], v[160:163]
s_waitcnt vmcnt(16)
v_mfma_f32_16x16x32_bf16 v[176:179], a[80:83], v[76:79], v[176:179]
buffer_load_dwordx4 v[112:115], v29, s[48:51], s86 offen offset:0 sc1
v_mfma_f32_16x16x32_bf16 v[164:167], a[84:87], v[72:75], v[164:167]
v_mfma_f32_16x16x32_bf16 v[180:183], a[84:87], v[76:79], v[180:183]
v_mfma_f32_16x16x32_bf16 v[168:171], a[88:91], v[72:75], v[168:171]
v_mfma_f32_16x16x32_bf16 v[184:187], a[88:91], v[76:79], v[184:187]
buffer_load_dwordx4 v[116:119], v29, s[48:51], s86 offen offset:512 sc1
v_mfma_f32_16x16x32_bf16 v[172:175], a[92:95], v[72:75], v[172:175]
v_mfma_f32_16x16x32_bf16 v[188:191], a[92:95], v[76:79], v[188:191]
s_waitcnt vmcnt(17)
v_mfma_f32_16x16x32_bf16 v[128:131], a[96:99], v[80:83], v[128:131]
s_waitcnt vmcnt(12)
v_mfma_f32_16x16x32_bf16 v[144:147], a[96:99], v[84:87], v[144:147]
buffer_load_dwordx4 v[120:123], v29, s[48:51], s86 offen offset:2048 sc1
v_mfma_f32_16x16x32_bf16 v[132:135], a[100:103], v[80:83], v[132:135]
v_mfma_f32_16x16x32_bf16 v[148:151], a[100:103], v[84:87], v[148:151]
v_mfma_f32_16x16x32_bf16 v[136:139], a[104:107], v[80:83], v[136:139]
buffer_load_dwordx4 v[124:127], v29, s[48:51], s86 offen offset:2560 sc1
v_mfma_f32_16x16x32_bf16 v[152:155], a[104:107], v[84:87], v[152:155]
s_add_u32 s86, s86, 8192
v_mfma_f32_16x16x32_bf16 v[140:143], a[108:111], v[80:83], v[140:143]
v_mfma_f32_16x16x32_bf16 v[156:159], a[108:111], v[84:87], v[156:159]
s_waitcnt vmcnt(13)
v_mfma_f32_16x16x32_bf16 v[160:163], a[96:99], v[88:91], v[160:163]
buffer_load_dwordx4 v[56:59], v31, s[48:51], s86 offen offset:0 sc1
s_waitcnt vmcnt(11)
v_mfma_f32_16x16x32_bf16 v[176:179], a[96:99], v[92:95], v[176:179]
v_add_u32 v48, 65536, v48
ds_read_b64_tr_b16 a[176:177], v48 offset:0
ds_read_b64_tr_b16 a[178:179], v48 offset:1024
v_mfma_f32_16x16x32_bf16 v[164:167], a[100:103], v[88:91], v[164:167]
v_add_u32 v49, 65536, v49
v_mfma_f32_16x16x32_bf16 v[180:183], a[100:103], v[92:95], v[180:183]
ds_read_b64_tr_b16 a[180:181], v49 offset:0
ds_read_b64_tr_b16 a[182:183], v49 offset:1024
v_mfma_f32_16x16x32_bf16 v[168:171], a[104:107], v[88:91], v[168:171]
buffer_load_dwordx4 v[60:63], v31, s[48:51], s86 offen offset:512 sc1
v_add_u32 v50, 65536, v50
v_mfma_f32_16x16x32_bf16 v[184:187], a[104:107], v[92:95], v[184:187]
ds_read_b64_tr_b16 a[184:185], v50 offset:0
ds_read_b64_tr_b16 a[186:187], v50 offset:1024
v_mfma_f32_16x16x32_bf16 v[172:175], a[108:111], v[88:91], v[172:175]
v_add_u32 v51, 65536, v51
v_mfma_f32_16x16x32_bf16 v[188:191], a[108:111], v[92:95], v[188:191]
ds_read_b64_tr_b16 a[188:189], v51 offset:0
ds_read_b64_tr_b16 a[190:191], v51 offset:1024
s_waitcnt vmcnt(9)
v_mfma_f32_16x16x32_bf16 v[128:131], a[112:115], v[96:99], v[128:131]
buffer_load_dwordx4 v[64:67], v31, s[48:51], s86 offen offset:2048 sc1
s_waitcnt vmcnt(9)
v_mfma_f32_16x16x32_bf16 v[144:147], a[112:115], v[100:103], v[144:147]
ds_read_b64_tr_b16 a[192:193], v48 offset:16384
ds_read_b64_tr_b16 a[194:195], v48 offset:17408
v_mfma_f32_16x16x32_bf16 v[132:135], a[116:119], v[96:99], v[132:135]
ds_read_b64_tr_b16 a[196:197], v49 offset:16384
v_mfma_f32_16x16x32_bf16 v[148:151], a[116:119], v[100:103], v[148:151]
ds_read_b64_tr_b16 a[198:199], v49 offset:17408
v_mfma_f32_16x16x32_bf16 v[136:139], a[120:123], v[96:99], v[136:139]
buffer_load_dwordx4 v[68:71], v31, s[48:51], s86 offen offset:2560 sc1
s_add_u32 s86, s86, 8192
v_mfma_f32_16x16x32_bf16 v[152:155], a[120:123], v[100:103], v[152:155]
ds_read_b64_tr_b16 a[200:201], v50 offset:16384
ds_read_b64_tr_b16 a[202:203], v50 offset:17408
v_mfma_f32_16x16x32_bf16 v[140:143], a[124:127], v[96:99], v[140:143]
ds_read_b64_tr_b16 a[204:205], v51 offset:16384
v_mfma_f32_16x16x32_bf16 v[156:159], a[124:127], v[100:103], v[156:159]
ds_read_b64_tr_b16 a[206:207], v51 offset:17408
s_waitcnt vmcnt(9)
v_mfma_f32_16x16x32_bf16 v[160:163], a[112:115], v[104:107], v[160:163]
buffer_load_dwordx4 v[72:75], v31, s[48:51], s86 offen offset:0 sc1
s_waitcnt vmcnt(9)
v_mfma_f32_16x16x32_bf16 v[176:179], a[112:115], v[108:111], v[176:179]
s_cmp_lg_u32 s68, 0
s_cbranch_scc1 Lpi7
s_mov_b32 s84, 0
s_atomic_add s84, s[48:49], s64 glc
Lpi7:
s_add_u32 m0, s78, 114688
s_add_u32 s81, s81, 131072
buffer_load_dwordx4 v44, s[44:47], s81 offen offset:0 lds
v_mfma_f32_16x16x32_bf16 v[164:167], a[116:119], v[104:107], v[164:167]
v_mfma_f32_16x16x32_bf16 v[180:183], a[116:119], v[108:111], v[180:183]
buffer_load_dwordx4 v45, s[44:47], s81 offen offset:1024 lds
v_mfma_f32_16x16x32_bf16 v[168:171], a[120:123], v[104:107], v[168:171]
buffer_load_dwordx4 v[76:79], v31, s[48:51], s86 offen offset:512 sc1
v_mfma_f32_16x16x32_bf16 v[184:187], a[120:123], v[108:111], v[184:187]
buffer_load_dwordx4 v46, s[44:47], s81 offen offset:2048 lds
v_mfma_f32_16x16x32_bf16 v[172:175], a[124:127], v[104:107], v[172:175]
v_mfma_f32_16x16x32_bf16 v[188:191], a[124:127], v[108:111], v[188:191]
buffer_load_dwordx4 v47, s[44:47], s81 offen offset:3072 lds
s_waitcnt vmcnt(13)
v_mfma_f32_16x16x32_bf16 v[128:131], a[128:131], v[112:115], v[128:131]
buffer_load_dwordx4 v[80:83], v31, s[48:51], s86 offen offset:2048 sc1
s_waitcnt vmcnt(13)
v_mfma_f32_16x16x32_bf16 v[144:147], a[128:131], v[116:119], v[144:147]
s_add_u32 m0, s78, 131072
s_add_u32 s81, s81, 131072
buffer_load_dwordx4 v44, s[44:47], s81 offen offset:0 lds
v_mfma_f32_16x16x32_bf16 v[132:135], a[132:135], v[112:115], v[132:135]
v_mfma_f32_16x16x32_bf16 v[148:151], a[132:135], v[116:119], v[148:151]
buffer_load_dwordx4 v45, s[44:47], s81 offen offset:1024 lds
v_mfma_f32_16x16x32_bf16 v[136:139], a[136:139], v[112:115], v[136:139]
buffer_load_dwordx4 v[84:87], v31, s[48:51], s86 offen offset:2560 sc1
v_mfma_f32_16x16x32_bf16 v[152:155], a[136:139], v[116:119], v[152:155]
s_add_u32 s86, s86, 8192
buffer_load_dwordx4 v46, s[44:47], s81 offen offset:2048 lds
v_mfma_f32_16x16x32_bf16 v[140:143], a[140:143], v[112:115], v[140:143]
v_mfma_f32_16x16x32_bf16 v[156:159], a[140:143], v[116:119], v[156:159]
buffer_load_dwordx4 v47, s[44:47], s81 offen offset:3072 lds
s_waitcnt lgkmcnt(0)
s_cmp_lg_u32 s68, 0
s_cbranch_scc1 Lok8
s_cmp_ge_u32 s84, 8
s_cbranch_scc1 Lok8
s_mov_b32 s93, 0
Lsp8:
s_mov_b32 s84, 0
s_atomic_add s84, s[48:49], s64 glc
s_add_u32 s93, s93, 1
s_waitcnt lgkmcnt(0)
s_cmp_ge_u32 s84, 8
s_cbranch_scc1 Lok8
s_cmp_lt_u32 s93, 0x8000
s_cbranch_scc1 Lsp8
Lok8:
s_barrier
buffer_load_dword v24, v30, s[48:51], s65 offen offset:0 sc1
buffer_load_dword v26, v30, s[48:51], s65 offen offset:64 sc1
buffer_load_dword v36, v30, s[48:51], s65 offen offset:128 sc1
buffer_load_dword v38, v30, s[48:51], s65 offen offset:192 sc1
s_waitcnt vmcnt(21)
v_mfma_f32_16x16x32_bf16 v[160:163], a[128:131], v[120:123], v[160:163]
s_waitcnt vmcnt(20)
v_mfma_f32_16x16x32_bf16 v[176:179], a[128:131], v[124:127], v[176:179]
buffer_load_dwordx4 v[88:91], v31, s[48:51], s86 offen offset:0 sc1
v_mfma_f32_16x16x32_bf16 v[164:167], a[132:135], v[120:123], v[164:167]
v_mfma_f32_16x16x32_bf16 v[180:183], a[132:135], v[124:127], v[180:183]
v_mfma_f32_16x16x32_bf16 v[168:171], a[136:139], v[120:123], v[168:171]
v_add_u32 v29, 8192, v31
v_mfma_f32_16x16x32_bf16 v[184:187], a[136:139], v[124:127], v[184:187]
buffer_load_dwordx4 v[92:95], v29, s[48:51], s86 offen offset:0 sc1
s_add_u32 s86, s86, 16384
v_mfma_f32_16x16x32_bf16 v[172:175], a[140:143], v[120:123], v[172:175]
v_mfma_f32_16x16x32_bf16 v[188:191], a[140:143], v[124:127], v[188:191]
s_waitcnt vmcnt(21)
v_mfma_f32_16x16x32_bf16 v[128:131], a[144:147], v[56:59], v[128:131]
buffer_load_dwordx4 v[96:99], v31, s[48:51], s86 offen offset:0 sc1
v_and_b32 v2, 15, v1
s_waitcnt vmcnt(21)
v_mfma_f32_16x16x32_bf16 v[144:147], a[144:147], v[60:63], v[144:147]
v_lshrrev_b32 v3, 4, v1
v_and_b32 v8, 7, v1
v_xor_b32_e64 v3, v3, v8
v_mfma_f32_16x16x32_bf16 v[132:135], a[148:151], v[56:59], v[132:135]
v_lshlrev_b32_e64 v3, 4, v3
v_lshl_add_u32 v3, v2, 8, v3
v_mfma_f32_16x16x32_bf16 v[148:151], a[148:151], v[60:63], v[148:151]
v_add_u32 v16, s78, v3
v_xor_b32 v17, 64, v16
v_mfma_f32_16x16x32_bf16 v[136:139], a[152:155], v[56:59], v[136:139]
buffer_load_dwordx4 v[100:103], v29, s[48:51], s86 offen offset:0 sc1
s_sub_u32 s86, s86, 16384
v_lshrrev_b32_e64 v2, 3, v0
v_mfma_f32_16x16x32_bf16 v[152:155], a[152:155], v[60:63], v[152:155]
v_and_b32 v3, 7, v2
v_lshlrev_b32 v9, 1, v8
v_xor_b32_e64 v3, v3, v9
v_mfma_f32_16x16x32_bf16 v[140:143], a[156:159], v[56:59], v[140:143]
v_lshlrev_b32 v3, 4, v3
v_and_b32 v9, 15, v2
v_mfma_f32_16x16x32_bf16 v[156:159], a[156:159], v[60:63], v[156:159]
v_lshl_add_u32 v3, v9, 8, v3
v_lshrrev_b32 v9, 7, v0
s_waitcnt vmcnt(21)
v_mfma_f32_16x16x32_bf16 v[160:163], a[144:147], v[64:67], v[160:163]
buffer_load_dwordx4 v[104:107], v31, s[48:51], s86 offen offset:512 sc1
v_lshl_add_u32 v20, v9, 14, v3
s_waitcnt vmcnt(21)
v_mfma_f32_16x16x32_bf16 v[176:179], a[144:147], v[68:71], v[176:179]
v_xor_b32 v21, 16, v20
v_lshlrev_b32_e64 v8, 4, v8
v_lshl_add_u32 v22, v2, 10, v8
v_mfma_f32_16x16x32_bf16 v[164:167], a[148:151], v[64:67], v[164:167]
v_mfma_f32_16x16x32_bf16 v[180:183], a[148:151], v[68:71], v[180:183]
v_mfma_f32_16x16x32_bf16 v[168:171], a[152:155], v[64:67], v[168:171]
buffer_load_dwordx4 v[108:111], v29, s[48:51], s86 offen offset:512 sc1
v_mfma_f32_16x16x32_bf16 v[184:187], a[152:155], v[68:71], v[184:187]
s_add_u32 s86, s86, 16384
v_mfma_f32_16x16x32_bf16 v[172:175], a[156:159], v[64:67], v[172:175]
v_mfma_f32_16x16x32_bf16 v[188:191], a[156:159], v[68:71], v[188:191]
s_waitcnt vmcnt(21)
v_mfma_f32_16x16x32_bf16 v[128:131], a[160:163], v[72:75], v[128:131]
buffer_load_dwordx4 v[112:115], v31, s[48:51], s86 offen offset:512 sc1
s_waitcnt vmcnt(17)
v_mfma_f32_16x16x32_bf16 v[144:147], a[160:163], v[76:79], v[144:147]
ds_read_b64_tr_b16 a[208:209], v48 offset:49152
ds_read_b64_tr_b16 a[210:211], v48 offset:50176
v_mfma_f32_16x16x32_bf16 v[132:135], a[164:167], v[72:75], v[132:135]
ds_read_b64_tr_b16 a[212:213], v49 offset:49152
v_mfma_f32_16x16x32_bf16 v[148:151], a[164:167], v[76:79], v[148:151]
ds_read_b64_tr_b16 a[214:215], v49 offset:50176
v_mfma_f32_16x16x32_bf16 v[136:139], a[168:171], v[72:75], v[136:139]
buffer_load_dwordx4 v[116:119], v29, s[48:51], s86 offen offset:512 sc1
s_sub_u32 s86, s86, 16384
v_mfma_f32_16x16x32_bf16 v[152:155], a[168:171], v[76:79], v[152:155]
ds_read_b64_tr_b16 a[216:217], v50 offset:49152
ds_read_b64_tr_b16 a[218:219], v50 offset:50176
v_mfma_f32_16x16x32_bf16 v[140:143], a[172:175], v[72:75], v[140:143]
ds_read_b64_tr_b16 a[220:221], v51 offset:49152
v_mfma_f32_16x16x32_bf16 v[156:159], a[172:175], v[76:79], v[156:159]
ds_read_b64_tr_b16 a[222:223], v51 offset:50176
s_waitcnt vmcnt(17)
v_mfma_f32_16x16x32_bf16 v[160:163], a[160:163], v[80:83], v[160:163]
buffer_load_dwordx4 v[120:123], v31, s[48:51], s86 offen offset:2048 sc1
s_waitcnt vmcnt(13)
v_mfma_f32_16x16x32_bf16 v[176:179], a[160:163], v[84:87], v[176:179]
v_add_u32 v48, 65536, v48
ds_read_b64_tr_b16 a[224:225], v48 offset:0
ds_read_b64_tr_b16 a[226:227], v48 offset:1024
v_mfma_f32_16x16x32_bf16 v[164:167], a[164:167], v[80:83], v[164:167]
v_add_u32 v49, 65536, v49
v_mfma_f32_16x16x32_bf16 v[180:183], a[164:167], v[84:87], v[180:183]
ds_read_b64_tr_b16 a[228:229], v49 offset:0
ds_read_b64_tr_b16 a[230:231], v49 offset:1024
v_mfma_f32_16x16x32_bf16 v[168:171], a[168:171], v[80:83], v[168:171]
buffer_load_dwordx4 v[124:127], v29, s[48:51], s86 offen offset:2048 sc1
s_add_u32 s86, s86, 16384
v_mfma_f32_16x16x32_bf16 v[184:187], a[168:171], v[84:87], v[184:187]
v_add_u32 v50, 65536, v50
ds_read_b64_tr_b16 a[232:233], v50 offset:0
ds_read_b64_tr_b16 a[234:235], v50 offset:1024
v_mfma_f32_16x16x32_bf16 v[172:175], a[172:175], v[80:83], v[172:175]
v_add_u32 v51, 65536, v51
v_mfma_f32_16x16x32_bf16 v[188:191], a[172:175], v[84:87], v[188:191]
ds_read_b64_tr_b16 a[236:237], v51 offset:0
ds_read_b64_tr_b16 a[238:239], v51 offset:1024
s_waitcnt vmcnt(9)
v_mfma_f32_16x16x32_bf16 v[192:195], a[176:179], v[88:91], v[128:131]
v_mfma_f32_16x16x32_bf16 v[196:199], a[180:183], v[88:91], v[132:135]
buffer_load_dwordx4 v[56:59], v31, s[48:51], s86 offen offset:2048 sc1
v_mfma_f32_16x16x32_bf16 v[200:203], a[184:187], v[88:91], v[136:139]
v_mfma_f32_16x16x32_bf16 v[204:207], a[188:191], v[88:91], v[140:143]
s_waitcnt vmcnt(9)
v_mfma_f32_16x16x32_bf16 v[192:195], a[192:195], v[92:95], v[192:195]
buffer_load_dwordx4 v[60:63], v29, s[48:51], s86 offen offset:2048 sc1
v_mfma_f32_16x16x32_bf16 v[196:199], a[196:199], v[92:95], v[196:199]
s_sub_u32 s86, s86, 16384
v_mfma_f32_16x16x32_bf16 v[200:203], a[200:203], v[92:95], v[200:203]
v_mfma_f32_16x16x32_bf16 v[204:207], a[204:207], v[92:95], v[204:207]
s_waitcnt vmcnt(9) lgkmcnt(14)
v_mfma_f32_16x16x32_bf16 v[192:195], a[208:211], v[96:99], v[192:195]
s_waitcnt lgkmcnt(12)
v_mfma_f32_16x16x32_bf16 v[196:199], a[212:215], v[96:99], v[196:199]
buffer_load_dwordx4 v[64:67], v31, s[48:51], s86 offen offset:2560 sc1
s_waitcnt lgkmcnt(10)
v_mfma_f32_16x16x32_bf16 v[200:203], a[216:219], v[96:99], v[200:203]
s_waitcnt lgkmcnt(8)
v_mfma_f32_16x16x32_bf16 v[204:207], a[220:223], v[96:99], v[204:207]
s_waitcnt vmcnt(9) lgkmcnt(6)
v_mfma_f32_16x16x32_bf16 v[192:195], a[224:227], v[100:103], v[192:195]
buffer_load_dwordx4 v[68:71], v29, s[48:51], s86 offen offset:2560 sc1
s_waitcnt lgkmcnt(4)
v_mfma_f32_16x16x32_bf16 v[196:199], a[228:231], v[100:103], v[196:199]
s_add_u32 s86, s86, 16384
s_waitcnt lgkmcnt(2)
v_mfma_f32_16x16x32_bf16 v[200:203], a[232:235], v[100:103], v[200:203]
s_waitcnt lgkmcnt(0)
v_mfma_f32_16x16x32_bf16 v[204:207], a[236:239], v[100:103], v[204:207]
s_waitcnt vmcnt(9)
v_mfma_f32_16x16x32_bf16 v[208:211], a[176:179], v[104:107], v[144:147]
buffer_load_dwordx4 v[72:75], v31, s[48:51], s86 offen offset:2560 sc1
v_fma_f32 v128, v192, v24, -v128
v_mfma_f32_16x16x32_bf16 v[212:215], a[180:183], v[104:107], v[148:151]
v_fma_f32 v129, v193, v24, -v129
v_fma_f32 v130, v194, v24, -v130
v_mfma_f32_16x16x32_bf16 v[216:219], a[184:187], v[104:107], v[152:155]
v_fma_f32 v131, v195, v24, -v131
v_mfma_f32_16x16x32_bf16 v[220:223], a[188:191], v[104:107], v[156:159]
ds_write_b128 v16, v[128:131] offset:0
v_fma_f32 v132, v196, v24, -v132
s_waitcnt vmcnt(9)
v_mfma_f32_16x16x32_bf16 v[208:211], a[192:195], v[108:111], v[208:211]
buffer_load_dwordx4 v[76:79], v29, s[48:51], s86 offen offset:2560 sc1
v_fma_f32 v133, v197, v24, -v133
v_mfma_f32_16x16x32_bf16 v[212:215], a[196:199], v[108:111], v[212:215]
v_fma_f32 v134, v198, v24, -v134
v_fma_f32 v135, v199, v24, -v135
v_mfma_f32_16x16x32_bf16 v[216:219], a[200:203], v[108:111], v[216:219]
ds_write_b128 v17, v[132:135] offset:0
v_mfma_f32_16x16x32_bf16 v[220:223], a[204:207], v[108:111], v[220:223]
v_fma_f32 v136, v200, v24, -v136
v_fma_f32 v137, v201, v24, -v137
s_waitcnt vmcnt(9)
v_mfma_f32_16x16x32_bf16 v[208:211], a[208:211], v[112:115], v[208:211]
v_fma_f32 v138, v202, v24, -v138
v_mfma_f32_16x16x32_bf16 v[212:215], a[212:215], v[112:115], v[212:215]
v_fma_f32 v139, v203, v24, -v139
ds_write_b128 v16, v[136:139] offset:128
v_mfma_f32_16x16x32_bf16 v[216:219], a[216:219], v[112:115], v[216:219]
v_fma_f32 v140, v204, v24, -v140
v_mfma_f32_16x16x32_bf16 v[220:223], a[220:223], v[112:115], v[220:223]
v_fma_f32 v141, v205, v24, -v141
v_fma_f32 v142, v206, v24, -v142
s_waitcnt vmcnt(8)
v_mfma_f32_16x16x32_bf16 v[208:211], a[224:227], v[116:119], v[208:211]
v_fma_f32 v143, v207, v24, -v143
v_mfma_f32_16x16x32_bf16 v[212:215], a[228:231], v[116:119], v[212:215]
ds_write_b128 v17, v[140:143] offset:128
v_mfma_f32_16x16x32_bf16 v[216:219], a[232:235], v[116:119], v[216:219]
v_mfma_f32_16x16x32_bf16 v[220:223], a[236:239], v[116:119], v[220:223]
s_waitcnt vmcnt(7)
v_mfma_f32_16x16x32_bf16 v[224:227], a[176:179], v[120:123], v[160:163]
s_nop 0
v_fma_f32 v144, v208, v26, -v144
v_mfma_f32_16x16x32_bf16 v[228:231], a[180:183], v[120:123], v[164:167]
v_fma_f32 v145, v209, v26, -v145
v_fma_f32 v146, v210, v26, -v146
v_mfma_f32_16x16x32_bf16 v[232:235], a[184:187], v[120:123], v[168:171]
v_fma_f32 v147, v211, v26, -v147
v_mfma_f32_16x16x32_bf16 v[236:239], a[188:191], v[120:123], v[172:175]
ds_write_b128 v16, v[144:147] offset:16384
v_fma_f32 v148, v212, v26, -v148
s_waitcnt vmcnt(6)
v_mfma_f32_16x16x32_bf16 v[224:227], a[192:195], v[124:127], v[224:227]
v_fma_f32 v149, v213, v26, -v149
v_mfma_f32_16x16x32_bf16 v[228:231], a[196:199], v[124:127], v[228:231]
v_fma_f32 v150, v214, v26, -v150
v_fma_f32 v151, v215, v26, -v151
v_mfma_f32_16x16x32_bf16 v[232:235], a[200:203], v[124:127], v[232:235]
ds_write_b128 v17, v[148:151] offset:16384
v_mfma_f32_16x16x32_bf16 v[236:239], a[204:207], v[124:127], v[236:239]
v_fma_f32 v152, v216, v26, -v152
v_fma_f32 v153, v217, v26, -v153
s_waitcnt vmcnt(5)
v_mfma_f32_16x16x32_bf16 v[224:227], a[208:211], v[56:59], v[224:227]
v_fma_f32 v154, v218, v26, -v154
v_mfma_f32_16x16x32_bf16 v[228:231], a[212:215], v[56:59], v[228:231]
v_fma_f32 v155, v219, v26, -v155
ds_write_b128 v16, v[152:155] offset:16512
v_mfma_f32_16x16x32_bf16 v[232:235], a[216:219], v[56:59], v[232:235]
v_fma_f32 v156, v220, v26, -v156
v_mfma_f32_16x16x32_bf16 v[236:239], a[220:223], v[56:59], v[236:239]
v_fma_f32 v157, v221, v26, -v157
v_fma_f32 v158, v222, v26, -v158
s_waitcnt vmcnt(4)
v_mfma_f32_16x16x32_bf16 v[224:227], a[224:227], v[60:63], v[224:227]
v_fma_f32 v159, v223, v26, -v159
v_mfma_f32_16x16x32_bf16 v[228:231], a[228:231], v[60:63], v[228:231]
ds_write_b128 v17, v[156:159] offset:16512
v_mfma_f32_16x16x32_bf16 v[232:235], a[232:235], v[60:63], v[232:235]
v_mfma_f32_16x16x32_bf16 v[236:239], a[236:239], v[60:63], v[236:239]
s_waitcnt lgkmcnt(0)
s_barrier
s_waitcnt vmcnt(3)
v_mfma_f32_16x16x32_bf16 v[240:243], a[176:179], v[64:67], v[176:179]
ds_read_b128 v[88:91], v20 offset:0
ds_read_b128 v[92:95], v21 offset:0
v_mfma_f32_16x16x32_bf16 v[244:247], a[180:183], v[64:67], v[180:183]
ds_read_b128 v[96:99], v20 offset:4096
ds_read_b128 v[100:103], v21 offset:4096
ds_read_b128 v[104:107], v20 offset:8192
v_mfma_f32_16x16x32_bf16 v[248:251], a[184:187], v[64:67], v[184:187]
ds_read_b128 v[108:111], v21 offset:8192
ds_read_b128 v[112:115], v20 offset:12288
v_mfma_f32_16x16x32_bf16 v[252:255], a[188:191], v[64:67], v[188:191]
ds_read_b128 v[116:119], v21 offset:12288
v_fma_f32 v160, v224, v36, -v160
v_fma_f32 v161, v225, v36, -v161
s_waitcnt vmcnt(2)
v_mfma_f32_16x16x32_bf16 v[240:243], a[192:195], v[68:71], v[240:243]
v_fma_f32 v162, v226, v36, -v162
v_fma_f32 v163, v227, v36, -v163
v_mfma_f32_16x16x32_bf16 v[244:247], a[196:199], v[68:71], v[244:247]
ds_write_b128 v16, v[160:163] offset:32768
v_fma_f32 v164, v228, v36, -v164
v_fma_f32 v165, v229, v36, -v165
v_mfma_f32_16x16x32_bf16 v[248:251], a[200:203], v[68:71], v[248:251]
v_fma_f32 v166, v230, v36, -v166
v_fma_f32 v167, v231, v36, -v167
v_mfma_f32_16x16x32_bf16 v[252:255], a[204:207], v[68:71], v[252:255]
ds_write_b128 v17, v[164:167] offset:32768
v_fma_f32 v168, v232, v36, -v168
v_fma_f32 v169, v233, v36, -v169
s_waitcnt vmcnt(1)
v_mfma_f32_16x16x32_bf16 v[240:243], a[208:211], v[72:75], v[240:243]
v_fma_f32 v170, v234, v36, -v170
v_fma_f32 v171, v235, v36, -v171
v_mfma_f32_16x16x32_bf16 v[244:247], a[212:215], v[72:75], v[244:247]
ds_write_b128 v16, v[168:171] offset:32896
v_fma_f32 v172, v236, v36, -v172
v_fma_f32 v173, v237, v36, -v173
v_mfma_f32_16x16x32_bf16 v[248:251], a[216:219], v[72:75], v[248:251]
v_fma_f32 v174, v238, v36, -v174
v_mfma_f32_16x16x32_bf16 v[252:255], a[220:223], v[72:75], v[252:255]
v_fma_f32 v175, v239, v36, -v175
ds_write_b128 v17, v[172:175] offset:32896
s_waitcnt vmcnt(0)
v_mfma_f32_16x16x32_bf16 v[240:243], a[224:227], v[76:79], v[240:243]
v_mfma_f32_16x16x32_bf16 v[244:247], a[228:231], v[76:79], v[244:247]
v_mfma_f32_16x16x32_bf16 v[248:251], a[232:235], v[76:79], v[248:251]
v_mfma_f32_16x16x32_bf16 v[252:255], a[236:239], v[76:79], v[252:255]
s_nop 4
v_pk_fma_f32 v[176:177], v[240:241], v[38:39], v[176:177] op_sel_hi:[1,0,1] neg_lo:[0,0,1] neg_hi:[0,0,1]
v_pk_fma_f32 v[178:179], v[242:243], v[38:39], v[178:179] op_sel_hi:[1,0,1] neg_lo:[0,0,1] neg_hi:[0,0,1]
ds_write_b128 v16, v[176:179] offset:49152
v_pk_fma_f32 v[180:181], v[244:245], v[38:39], v[180:181] op_sel_hi:[1,0,1] neg_lo:[0,0,1] neg_hi:[0,0,1]
v_pk_fma_f32 v[182:183], v[246:247], v[38:39], v[182:183] op_sel_hi:[1,0,1] neg_lo:[0,0,1] neg_hi:[0,0,1]
ds_write_b128 v17, v[180:183] offset:49152
v_pk_fma_f32 v[184:185], v[248:249], v[38:39], v[184:185] op_sel_hi:[1,0,1] neg_lo:[0,0,1] neg_hi:[0,0,1]
v_pk_fma_f32 v[186:187], v[250:251], v[38:39], v[186:187] op_sel_hi:[1,0,1] neg_lo:[0,0,1] neg_hi:[0,0,1]
ds_write_b128 v16, v[184:187] offset:49280
v_pk_fma_f32 v[188:189], v[252:253], v[38:39], v[188:189] op_sel_hi:[1,0,1] neg_lo:[0,0,1] neg_hi:[0,0,1]
v_pk_fma_f32 v[190:191], v[254:255], v[38:39], v[190:191] op_sel_hi:[1,0,1] neg_lo:[0,0,1] neg_hi:[0,0,1]
ds_write_b128 v17, v[188:191] offset:49280
s_waitcnt lgkmcnt(13)
v_pk_add_f32 v[88:89], v[88:89], v[96:97]
v_pk_add_f32 v[90:91], v[90:91], v[98:99]
s_waitcnt lgkmcnt(12)
v_pk_add_f32 v[92:93], v[92:93], v[100:101]
v_pk_add_f32 v[94:95], v[94:95], v[102:103]
s_waitcnt lgkmcnt(9)
v_pk_add_f32 v[104:105], v[104:105], v[112:113]
v_pk_add_f32 v[106:107], v[106:107], v[114:115]
s_waitcnt lgkmcnt(8)
v_pk_add_f32 v[108:109], v[108:109], v[116:117]
v_pk_add_f32 v[110:111], v[110:111], v[118:119]
s_waitcnt lgkmcnt(0)
s_barrier
ds_read_b128 v[56:59], v20 offset:32768
ds_read_b128 v[60:63], v21 offset:32768
ds_read_b128 v[64:67], v20 offset:36864
ds_read_b128 v[68:71], v21 offset:36864
ds_read_b128 v[72:75], v20 offset:40960
ds_read_b128 v[76:79], v21 offset:40960
ds_read_b128 v[80:83], v20 offset:45056
ds_read_b128 v[84:87], v21 offset:45056
v_pk_add_f32 v[88:89], v[88:89], v[104:105]
v_pk_add_f32 v[90:91], v[90:91], v[106:107]
v_pk_add_f32 v[92:93], v[92:93], v[108:109]
v_pk_add_f32 v[94:95], v[94:95], v[110:111]
v_cvt_pk_bf16_f32 v96, v88, v89
v_cvt_pk_bf16_f32 v97, v90, v91
v_cvt_pk_bf16_f32 v98, v92, v93
v_cvt_pk_bf16_f32 v99, v94, v95
buffer_store_dwordx4 v[96:99], v22, s[56:59], s66 offen sc1
s_waitcnt lgkmcnt(5)
v_pk_add_f32 v[56:57], v[56:57], v[64:65]
v_pk_add_f32 v[58:59], v[58:59], v[66:67]
s_waitcnt lgkmcnt(4)
LhopA4:
s_cbranch_execz LbackA
v_pk_add_f32 v[60:61], v[60:61], v[68:69]
v_pk_add_f32 v[62:63], v[62:63], v[70:71]
s_waitcnt lgkmcnt(1)
v_pk_add_f32 v[72:73], v[72:73], v[80:81]
v_pk_add_f32 v[74:75], v[74:75], v[82:83]
s_waitcnt lgkmcnt(0)
s_nop 0
v_pk_add_f32 v[76:77], v[76:77], v[84:85]
v_pk_add_f32 v[78:79], v[78:79], v[86:87]
v_pk_add_f32 v[56:57], v[56:57], v[72:73]
v_pk_add_f32 v[58:59], v[58:59], v[74:75]
v_pk_add_f32 v[60:61], v[60:61], v[76:77]
v_pk_add_f32 v[62:63], v[62:63], v[78:79]
v_cvt_pk_bf16_f32 v64, v56, v57
v_cvt_pk_bf16_f32 v65, v58, v59
v_cvt_pk_bf16_f32 v66, v60, v61
v_cvt_pk_bf16_f32 v67, v62, v63
buffer_store_dwordx4 v[64:67], v22, s[56:59], s67 offen sc1
s_endpgm
LbodyB:
s_mul_i32 s76, s68, 49152
s_lshl_b32 s3, s70, 7
s_add_u32 s76, s76, s3
s_lshl_b32 s80, s68, 11
s_and_b32 s83, s2, 7
s_lshr_b32 s84, s2, 3
s_lshl_b32 s72, s83, 2
s_lshr_b32 s3, s84, 3
s_add_u32 s72, s72, s3
s_and_b32 s3, s3, 1
s_xor_b32 s3, s3, s84
s_and_b32 s73, s3, 7
s_mov_b32 s36, s6
s_mov_b32 s37, s7
s_mov_b32 s38, 0x180000
s_mov_b32 s39, 0x20000
s_lshr_b32 s100, s2, 4
s_cmp_ge_u32 s68, 2
s_cbranch_scc1 LtGb
s_lshr_b32 s101, s83, 2
s_and_b32 s3, s2, 3
s_cmp_eq_u32 s68, 0
s_cbranch_scc1 LtXb
s_lshl1_add_u32 s100, s100, s101
s_mulk_i32 s100, 24
s_add_u32 s100, s100, s3
s_add_u32 s100, s100, 4
s_lshl_b32 s100, s100, 8
s_add_u32 s101, s100, 786432
v_and_b32 v6, 1, v1
v_lshlrev_b32 v6, 7, v6
v_bfe_u32 v7, v1, 1, 1
v_lshl_or_b32 v6, v7, 10, v6
v_bfe_u32 v7, v1, 2, 1
v_lshl_or_b32 v7, v4, 6, v7
v_mul_u32_u24 v7, 3072, v7
v_bfe_u32 v8, v1, 3, 1
v_lshl_or_b32 v6, v8, 30, v6
v_add_u32_e64 v57, v6, v7
s_mov_b32 s98, 0x180000
s_mov_b64 s[96:97], s[6:7]
s_branch LtTb
LtXb:
s_lshl4_add_u32 s100, s101, s100
s_lshl2_add_u32 s100, s100, s3
s_lshl_b32 s100, s100, 14
s_add_u32 s101, s100, 512
v_and_b32 v6, 15, v1
v_lshlrev_b32_e64 v6, 10, v6
v_lshl_or_b32 v57, v4, 7, v6
s_mov_b32 s98, 0x200000
s_mov_b64 s[96:97], s[28:29]
s_branch LtTb
LtGb:
s_mulk_i32 s100, 11008
s_and_b32 s3, s2, 3
s_mulk_i32 s3, 448
s_add_u32 s100, s100, s3
s_add_u32 s101, s100, 704512
v_and_b32 v6, 3, v1
v_lshlrev_b32 v6, 7, v6
v_bfe_u32 v7, v1, 2, 2
v_lshl_or_b32 v7, v4, 6, v7
v_mul_u32_u24 v7, 2752, v7
v_add_u32_e64 v57, v6, v7
s_mov_b32 s98, 0x158000
s_cmp_eq_u32 s68, 2
s_cselect_b64 s[96:97], s[14:15], s[16:17]
LtTb:
s_lshr_b32 s3, s2, 4
s_bfe_u32 s83, s2, 0x10002
s_lshl1_add_u32 s3, s3, s83
s_lshr_b32 s83, s98, 9
s_mul_i32 s3, s3, s83
s_lshl_b32 s3, s3, 4
s_and_b32 s0, s2, 3
s_lshl_b32 s0, s0, 8
s_add_u32 s3, s3, s0
s_movk_i32 s0, 1792
s_bitcmp1_b32 s2, 1
s_cselect_b32 s0, 1728, s0
s_cmp_ge_u32 s68, 2
s_cselect_b32 s0, s0, 0
s_add_u32 s3, s3, s0
s_cmp_eq_u32 s68, 0
s_cselect_b32 s3, 0x40000000, s3
v_lshrrev_b32 v8, 2, v1
v_and_b32 v9, 3, v1
v_lshlrev_b32 v9, 7, v9
v_min_u32 v9, 252, v9
v_mad_u32_u24 v8, v8, s83, v9
v_add_u32 v52, s3, v8
v_lshlrev_b32 v6, 2, v5
v_xor_b32 v6, v3, v6
v_lshlrev_b32 v7, 4, v6
v_and_b32 v6, 6, v2
v_xor_b32 v6, v3, v6
v_lshlrev_b32_e64 v6, 4, v6
v_lshl_add_u32 v44, v2, 10, v6
v_add_u32 v45, 7168, v44
v_add_u32 v46, 63488, v44
v_add_u32 v47, 63488, v45
v_lshlrev_b32 v6, 1, v5
v_xor_b32 v6, v3, v6
v_lshlrev_b32_e64 v7, 4, v6
v_mul_u32_u24 v6, 3072, v2
v_add_u32 v27, v6, v7
v_xor_b32 v6, 64, v27
v_add_u32 v28, 23552, v6
s_mov_b32 s40, s18
s_mov_b32 s41, s19
s_mov_b32 s42, 0x158000
s_mov_b32 s43, 0x20000
s_mov_b32 s44, s10
s_mov_b32 s45, s11
s_mov_b32 s46, 0x80000
s_mov_b32 s47, 0x20000
s_mov_b32 s48, s26
s_mov_b32 s49, s27
s_mov_b32 s50, 0x2000000
s_mov_b32 s51, 0x20000
s_mov_b32 s52, s24
s_mov_b32 s53, s25
s_mov_b32 s54, 0x100
s_mov_b32 s55, 0x20000
s_mov_b32 s56, s22
s_mov_b32 s57, s23
s_mov_b32 s58, 0x200000
s_mov_b32 s59, 0x20000
s_mov_b32 s60, s8
s_mov_b32 s61, s9
s_mov_b32 s62, 0x4000
s_mov_b32 s63, 0x20000
s_mov_b32 s64, s20
s_mov_b32 s65, s21
s_mov_b32 s66, 0x400
s_mov_b32 s67, 0x20000
v_lshlrev_b32 v14, 4, v1
v_lshrrev_b32 v6, 3, v0
v_lshlrev_b32_e64 v7, 7, v0
v_lshl_or_b32 v15, v6, 24, v7
s_mov_b32 s88, 0x3fb8aa3b
s_mov_b32 s89, 0x3fb8aa3b
s_mov_b32 s90, 0xbdd2d3e8
s_mov_b32 s91, 0xbdd2d3e8
v_mov_b32 v54, 0xc0135761
s_cmp_eq_u32 s68, 0
s_cselect_b32 s85, 0xffff, 0
s_cselect_b32 s87, 0xff, 0
s_mov_b32 s85, 1
s_lshl_b32 s81, s68, 14
s_lshl_b32 s3, s73, 7
s_add_u32 s81, s81, s3
s_lshl2_add_u32 s3, s70, s68
s_mul_i32 s3, s3, 4352
s_add_u32 s82, s3, 0x1f00000
v_and_b32 v2, 15, v1
v_lshrrev_b32 v3, 4, v1
v_lshrrev_b32 v6, 1, v2
v_xor_b32 v6, v3, v6
v_lshlrev_b32_e64 v6, 4, v6
v_lshl_add_u32 v6, v2, 7, v6
v_bfe_u32 v4, v1, 2, 2
v_lshrrev_b32_e64 v9, 1, v4
v_lshl_or_b32 v9, v5, 1, v9
v_and_b32 v7, 1, v1
v_lshlrev_b32 v7, 4, v7
v_and_b32_e64 v8, 2, v1
v_lshl_or_b32 v7, v8, 2, v7
v_lshl_add_u32 v8, v3, 3, v4
v_add_u32 v29, s78, v6
v_xor_b32 v30, 64, v29
v_xor_b32 v31, 0x1000, v29
v_xor_b32 v32, 0x1000, v30
s_lshl_b32 s3, s77, 1
v_xor_b32 v9, s3, v9
v_lshl_add_u32 v9, v9, 5, v7
v_lshl_add_u32 v9, v8, 7, v9
v_add_u32 v33, 110592, v9
v_xor_b32_e64 v34, 32, v33
v_add_u32 v35, 32768, v9
v_xor_b32_e64 v36, 32, v35
v_mul_u32_u24 v9, 224, v8
v_add_u32_e64 v9, v9, v7
v_lshl_add_u32 v9, v3, 7, v9
s_mul_i32 s3, s77, 96
v_add_u32 v38, 49152, v9
v_add_u32_e64 v37, s3, v38
v_add_u32 v38, 192, v38
v_add_u32 v40, 110592, v9
v_add_u32_e64 v39, s3, v40
v_add_u32 v40, 192, v40
s_add_u32 m0, s78, 16384
s_add_u32 s74, s74, 128
buffer_load_dwordx4 v16, s[28:31], s74 offen offset:0 lds
buffer_load_dwordx4 v17, s[28:31], s74 offen offset:1024 lds
buffer_load_dwordx4 v18, s[28:31], s74 offen offset:2048 lds
buffer_load_dwordx4 v19, s[28:31], s74 offen offset:3072 lds
s_add_u32 m0, s79, 79872
s_add_u32 s75, s75, 132096
buffer_load_dwordx4 v20, s[32:35], s75 offen offset:0 lds
buffer_load_dwordx4 v21, s[32:35], s75 offen offset:896 lds
buffer_load_dwordx4 v22, s[32:35], s75 offen offset:1920 lds
buffer_load_dwordx4 v23, s[32:35], s75 offen offset:2816 lds
s_add_u32 m0, s79, 83712
s_add_u32 s75, s75, 44032
buffer_load_dwordx4 v20, s[32:35], s75 offen offset:0 lds
buffer_load_dwordx4 v21, s[32:35], s75 offen offset:896 lds
buffer_load_dwordx4 v22, s[32:35], s75 offen offset:1920 lds
buffer_load_dwordx4 v23, s[32:35], s75 offen offset:2816 lds
s_waitcnt vmcnt(12)
s_barrier
ds_read_b128 a[0:3], v29 offset:0
ds_read_b64_tr_b16 v[80:81], v37 offset:0
ds_read_b64_tr_b16 v[82:83], v37 offset:896
ds_read_b128 a[4:7], v29 offset:2048
ds_read_b128 a[8:11], v31 offset:0
ds_read_b128 a[12:15], v31 offset:2048
ds_read_b64_tr_b16 v[84:85], v37 offset:32
ds_read_b64_tr_b16 v[86:87], v37 offset:928
ds_read_b64_tr_b16 v[88:89], v37 offset:64
ds_read_b64_tr_b16 v[90:91], v37 offset:960
ds_read_b64_tr_b16 v[92:93], v38 offset:0
ds_read_b64_tr_b16 v[94:95], v38 offset:896
s_waitcnt lgkmcnt(0)
v_mfma_f32_16x16x32_bf16 v[144:147], v[80:83], a[0:3], 0
ds_read_b128 a[16:19], v30 offset:0
v_mfma_f32_16x16x32_bf16 v[176:179], v[84:87], a[0:3], 0
ds_read_b64_tr_b16 v[96:97], v37 offset:15360
v_mfma_f32_16x16x32_bf16 v[208:211], v[88:91], a[0:3], 0
ds_read_b64_tr_b16 v[98:99], v37 offset:16256
v_mfma_f32_16x16x32_bf16 v[240:243], v[92:95], a[0:3], 0
ds_read_b128 a[20:23], v30 offset:2048
s_add_u32 m0, s78, 32768
s_add_u32 s74, s74, 128
buffer_load_dwordx4 v16, s[28:31], s74 offen offset:0 lds
v_mfma_f32_16x16x32_bf16 v[244:247], v[92:95], a[4:7], 0
ds_read_b64_tr_b16 v[100:101], v37 offset:15392
v_mfma_f32_16x16x32_bf16 v[212:215], v[88:91], a[4:7], 0
ds_read_b64_tr_b16 v[102:103], v37 offset:16288
v_mfma_f32_16x16x32_bf16 v[180:183], v[84:87], a[4:7], 0
ds_read_b64_tr_b16 v[104:105], v37 offset:15424
buffer_load_dwordx4 v17, s[28:31], s74 offen offset:1024 lds
v_mfma_f32_16x16x32_bf16 v[148:151], v[80:83], a[4:7], 0
ds_read_b64_tr_b16 v[106:107], v37 offset:16320
v_mfma_f32_16x16x32_bf16 v[160:163], v[80:83], a[8:11], 0
ds_read_b64_tr_b16 v[108:109], v38 offset:15360
v_mfma_f32_16x16x32_bf16 v[192:195], v[84:87], a[8:11], 0
ds_read_b64_tr_b16 v[110:111], v38 offset:16256
v_mfma_f32_16x16x32_bf16 v[224:227], v[88:91], a[8:11], 0
buffer_load_dwordx4 v18, s[28:31], s74 offen offset:2048 lds
v_mfma_f32_16x16x32_bf16 v[228:231], v[88:91], a[12:15], 0
v_mfma_f32_16x16x32_bf16 v[196:199], v[84:87], a[12:15], 0
v_mfma_f32_16x16x32_bf16 v[164:167], v[80:83], a[12:15], 0
buffer_load_dwordx4 v19, s[28:31], s74 offen offset:3072 lds
s_waitcnt lgkmcnt(0)
v_mfma_f32_16x16x32_bf16 v[152:155], v[96:99], a[0:3], 0
ds_read_b128 a[24:27], v32 offset:0
v_mfma_f32_16x16x32_bf16 v[184:187], v[100:103], a[0:3], 0
ds_read_b64_tr_b16 v[80:81], v37 offset:7680
v_mfma_f32_16x16x32_bf16 v[216:219], v[104:107], a[0:3], 0
ds_read_b64_tr_b16 v[82:83], v37 offset:8576
v_mfma_f32_16x16x32_bf16 v[248:251], v[108:111], a[0:3], 0
ds_read_b128 a[28:31], v32 offset:2048
s_add_u32 m0, s79, 110592
s_add_u32 s75, s75, 132096
buffer_load_dwordx4 v20, s[32:35], s75 offen offset:0 lds
v_mfma_f32_16x16x32_bf16 v[252:255], v[108:111], a[4:7], 0
ds_read_b64_tr_b16 v[84:85], v37 offset:7712
v_mfma_f32_16x16x32_bf16 v[220:223], v[104:107], a[4:7], 0
ds_read_b64_tr_b16 v[86:87], v37 offset:8608
v_mfma_f32_16x16x32_bf16 v[188:191], v[100:103], a[4:7], 0
ds_read_b64_tr_b16 v[88:89], v37 offset:7744
buffer_load_dwordx4 v21, s[32:35], s75 offen offset:896 lds
v_mfma_f32_16x16x32_bf16 v[156:159], v[96:99], a[4:7], 0
ds_read_b64_tr_b16 v[90:91], v37 offset:8640
v_mfma_f32_16x16x32_bf16 v[168:171], v[96:99], a[8:11], 0
ds_read_b64_tr_b16 v[92:93], v38 offset:7680
v_mfma_f32_16x16x32_bf16 v[200:203], v[100:103], a[8:11], 0
ds_read_b64_tr_b16 v[94:95], v38 offset:8576
v_mfma_f32_16x16x32_bf16 v[232:235], v[104:107], a[8:11], 0
buffer_load_dwordx4 v22, s[32:35], s75 offen offset:1920 lds
v_mfma_f32_16x16x32_bf16 v[236:239], v[104:107], a[12:15], 0
v_mfma_f32_16x16x32_bf16 v[204:207], v[100:103], a[12:15], 0
v_mfma_f32_16x16x32_bf16 v[172:175], v[96:99], a[12:15], 0
buffer_load_dwordx4 v23, s[32:35], s75 offen offset:2816 lds
s_waitcnt lgkmcnt(0)
v_mfma_f32_16x16x32_bf16 v[144:147], v[80:83], a[16:19], v[144:147]
ds_read_b64_tr_b16 v[96:97], v37 offset:23040
v_mfma_f32_16x16x32_bf16 v[176:179], v[84:87], a[16:19], v[176:179]
ds_read_b64_tr_b16 v[98:99], v37 offset:23936
v_mfma_f32_16x16x32_bf16 v[208:211], v[88:91], a[16:19], v[208:211]
ds_read_b64_tr_b16 v[100:101], v37 offset:23072
v_mfma_f32_16x16x32_bf16 v[240:243], v[92:95], a[16:19], v[240:243]
ds_read_b64_tr_b16 v[102:103], v37 offset:23968
s_add_u32 m0, s79, 114432
s_add_u32 s75, s75, 44032
buffer_load_dwordx4 v20, s[32:35], s75 offen offset:0 lds
v_mfma_f32_16x16x32_bf16 v[244:247], v[92:95], a[20:23], v[244:247]
ds_read_b64_tr_b16 v[104:105], v37 offset:23104
v_mfma_f32_16x16x32_bf16 v[212:215], v[88:91], a[20:23], v[212:215]
ds_read_b64_tr_b16 v[106:107], v37 offset:24000
v_mfma_f32_16x16x32_bf16 v[180:183], v[84:87], a[20:23], v[180:183]
ds_read_b64_tr_b16 v[108:109], v38 offset:23040
buffer_load_dwordx4 v21, s[32:35], s75 offen offset:896 lds
v_mfma_f32_16x16x32_bf16 v[148:151], v[80:83], a[20:23], v[148:151]
ds_read_b64_tr_b16 v[110:111], v38 offset:23936
v_mfma_f32_16x16x32_bf16 v[160:163], v[80:83], a[24:27], v[160:163]
v_mfma_f32_16x16x32_bf16 v[192:195], v[84:87], a[24:27], v[192:195]
v_mfma_f32_16x16x32_bf16 v[224:227], v[88:91], a[24:27], v[224:227]
buffer_load_dwordx4 v22, s[32:35], s75 offen offset:1920 lds
v_mfma_f32_16x16x32_bf16 v[228:231], v[88:91], a[28:31], v[228:231]
v_mfma_f32_16x16x32_bf16 v[196:199], v[84:87], a[28:31], v[196:199]
v_mfma_f32_16x16x32_bf16 v[164:167], v[80:83], a[28:31], v[164:167]
buffer_load_dwordx4 v23, s[32:35], s75 offen offset:2816 lds
s_waitcnt vmcnt(12) lgkmcnt(0)
s_barrier
v_mfma_f32_16x16x32_bf16 v[152:155], v[96:99], a[16:19], v[152:155]
ds_read_b128 a[32:35], v29 offset:16384
v_mfma_f32_16x16x32_bf16 v[184:187], v[100:103], a[16:19], v[184:187]
ds_read_b64_tr_b16 v[80:81], v37 offset:30720
v_mfma_f32_16x16x32_bf16 v[216:219], v[104:107], a[16:19], v[216:219]
ds_read_b64_tr_b16 v[82:83], v37 offset:31616
v_mfma_f32_16x16x32_bf16 v[248:251], v[108:111], a[16:19], v[248:251]
ds_read_b128 a[36:39], v29 offset:18432
s_add_u32 m0, s78, 0
s_add_u32 s74, s74, 128
buffer_load_dwordx4 v16, s[28:31], s74 offen offset:0 lds
v_mfma_f32_16x16x32_bf16 v[252:255], v[108:111], a[20:23], v[252:255]
ds_read_b128 a[40:43], v31 offset:16384
v_mfma_f32_16x16x32_bf16 v[220:223], v[104:107], a[20:23], v[220:223]
ds_read_b128 a[44:47], v31 offset:18432
v_mfma_f32_16x16x32_bf16 v[188:191], v[100:103], a[20:23], v[188:191]
ds_read_b64_tr_b16 v[84:85], v37 offset:30752
buffer_load_dwordx4 v17, s[28:31], s74 offen offset:1024 lds
v_mfma_f32_16x16x32_bf16 v[156:159], v[96:99], a[20:23], v[156:159]
ds_read_b64_tr_b16 v[86:87], v37 offset:31648
v_mfma_f32_16x16x32_bf16 v[168:171], v[96:99], a[24:27], v[168:171]
ds_read_b64_tr_b16 v[88:89], v37 offset:30784
v_mfma_f32_16x16x32_bf16 v[200:203], v[100:103], a[24:27], v[200:203]
ds_read_b64_tr_b16 v[90:91], v37 offset:31680
v_mfma_f32_16x16x32_bf16 v[232:235], v[104:107], a[24:27], v[232:235]
ds_read_b64_tr_b16 v[92:93], v38 offset:30720
buffer_load_dwordx4 v18, s[28:31], s74 offen offset:2048 lds
v_mfma_f32_16x16x32_bf16 v[236:239], v[104:107], a[28:31], v[236:239]
ds_read_b64_tr_b16 v[94:95], v38 offset:31616
v_mfma_f32_16x16x32_bf16 v[204:207], v[100:103], a[28:31], v[204:207]
v_mfma_f32_16x16x32_bf16 v[172:175], v[96:99], a[28:31], v[172:175]
buffer_load_dwordx4 v19, s[28:31], s74 offen offset:3072 lds
s_waitcnt lgkmcnt(0)
v_mfma_f32_16x16x32_bf16 v[144:147], v[80:83], a[32:35], v[144:147]
ds_read_b128 a[48:51], v30 offset:16384
v_mfma_f32_16x16x32_bf16 v[176:179], v[84:87], a[32:35], v[176:179]
ds_read_b64_tr_b16 v[96:97], v37 offset:46080
v_mfma_f32_16x16x32_bf16 v[208:211], v[88:91], a[32:35], v[208:211]
ds_read_b64_tr_b16 v[98:99], v37 offset:46976
v_mfma_f32_16x16x32_bf16 v[240:243], v[92:95], a[32:35], v[240:243]
ds_read_b128 a[52:55], v30 offset:18432
s_add_u32 m0, s79, 49152
s_add_u32 s75, s75, 132096
buffer_load_dwordx4 v20, s[32:35], s75 offen offset:0 lds
v_mfma_f32_16x16x32_bf16 v[244:247], v[92:95], a[36:39], v[244:247]
ds_read_b64_tr_b16 v[100:101], v37 offset:46112
v_mfma_f32_16x16x32_bf16 v[212:215], v[88:91], a[36:39], v[212:215]
ds_read_b64_tr_b16 v[102:103], v37 offset:47008
v_mfma_f32_16x16x32_bf16 v[180:183], v[84:87], a[36:39], v[180:183]
ds_read_b64_tr_b16 v[104:105], v37 offset:46144
buffer_load_dwordx4 v21, s[32:35], s75 offen offset:896 lds
v_mfma_f32_16x16x32_bf16 v[148:151], v[80:83], a[36:39], v[148:151]
ds_read_b64_tr_b16 v[106:107], v37 offset:47040
v_mfma_f32_16x16x32_bf16 v[160:163], v[80:83], a[40:43], v[160:163]
ds_read_b64_tr_b16 v[108:109], v38 offset:46080
v_mfma_f32_16x16x32_bf16 v[192:195], v[84:87], a[40:43], v[192:195]
ds_read_b64_tr_b16 v[110:111], v38 offset:46976
v_mfma_f32_16x16x32_bf16 v[224:227], v[88:91], a[40:43], v[224:227]
buffer_load_dwordx4 v22, s[32:35], s75 offen offset:1920 lds
v_mfma_f32_16x16x32_bf16 v[228:231], v[88:91], a[44:47], v[228:231]
v_mfma_f32_16x16x32_bf16 v[196:199], v[84:87], a[44:47], v[196:199]
v_mfma_f32_16x16x32_bf16 v[164:167], v[80:83], a[44:47], v[164:167]
buffer_load_dwordx4 v23, s[32:35], s75 offen offset:2816 lds
s_waitcnt lgkmcnt(0)
v_mfma_f32_16x16x32_bf16 v[152:155], v[96:99], a[32:35], v[152:155]
ds_read_b128 a[56:59], v32 offset:16384
v_mfma_f32_16x16x32_bf16 v[184:187], v[100:103], a[32:35], v[184:187]
ds_read_b64_tr_b16 v[80:81], v37 offset:38400
v_mfma_f32_16x16x32_bf16 v[216:219], v[104:107], a[32:35], v[216:219]
ds_read_b64_tr_b16 v[82:83], v37 offset:39296
v_mfma_f32_16x16x32_bf16 v[248:251], v[108:111], a[32:35], v[248:251]
ds_read_b128 a[60:63], v32 offset:18432
v_mfma_f32_16x16x32_bf16 v[252:255], v[108:111], a[36:39], v[252:255]
ds_read_b64_tr_b16 v[84:85], v37 offset:38432
s_add_u32 m0, s79, 52992
s_add_u32 s75, s75, 44032
buffer_load_dwordx4 v20, s[32:35], s75 offen offset:0 lds
v_mfma_f32_16x16x32_bf16 v[220:223], v[104:107], a[36:39], v[220:223]
ds_read_b64_tr_b16 v[86:87], v37 offset:39328
v_mfma_f32_16x16x32_bf16 v[188:191], v[100:103], a[36:39], v[188:191]
ds_read_b64_tr_b16 v[88:89], v37 offset:38464
v_mfma_f32_16x16x32_bf16 v[156:159], v[96:99], a[36:39], v[156:159]
ds_read_b64_tr_b16 v[90:91], v37 offset:39360
v_mfma_f32_16x16x32_bf16 v[168:171], v[96:99], a[40:43], v[168:171]
ds_read_b64_tr_b16 v[92:93], v38 offset:38400
v_mfma_f32_16x16x32_bf16 v[200:203], v[100:103], a[40:43], v[200:203]
ds_read_b64_tr_b16 v[94:95], v38 offset:39296
buffer_load_dwordx4 v21, s[32:35], s75 offen offset:896 lds
v_mfma_f32_16x16x32_bf16 v[232:235], v[104:107], a[40:43], v[232:235]
v_mfma_f32_16x16x32_bf16 v[236:239], v[104:107], a[44:47], v[236:239]
v_mfma_f32_16x16x32_bf16 v[204:207], v[100:103], a[44:47], v[204:207]
v_mfma_f32_16x16x32_bf16 v[172:175], v[96:99], a[44:47], v[172:175]
buffer_load_dwordx4 v22, s[32:35], s75 offen offset:1920 lds
s_waitcnt lgkmcnt(0)
v_mfma_f32_16x16x32_bf16 v[144:147], v[80:83], a[48:51], v[144:147]
ds_read_b64_tr_b16 v[96:97], v37 offset:53760
v_mfma_f32_16x16x32_bf16 v[176:179], v[84:87], a[48:51], v[176:179]
ds_read_b64_tr_b16 v[98:99], v37 offset:54656
v_mfma_f32_16x16x32_bf16 v[208:211], v[88:91], a[48:51], v[208:211]
ds_read_b64_tr_b16 v[100:101], v37 offset:53792
v_mfma_f32_16x16x32_bf16 v[240:243], v[92:95], a[48:51], v[240:243]
ds_read_b64_tr_b16 v[102:103], v37 offset:54688
v_mfma_f32_16x16x32_bf16 v[244:247], v[92:95], a[52:55], v[244:247]
ds_read_b64_tr_b16 v[104:105], v37 offset:53824
buffer_load_dwordx4 v23, s[32:35], s75 offen offset:2816 lds
v_mfma_f32_16x16x32_bf16 v[212:215], v[88:91], a[52:55], v[212:215]
ds_read_b64_tr_b16 v[106:107], v37 offset:54720
v_mfma_f32_16x16x32_bf16 v[180:183], v[84:87], a[52:55], v[180:183]
ds_read_b64_tr_b16 v[108:109], v38 offset:53760
v_mfma_f32_16x16x32_bf16 v[148:151], v[80:83], a[52:55], v[148:151]
ds_read_b64_tr_b16 v[110:111], v38 offset:54656
v_mfma_f32_16x16x32_bf16 v[160:163], v[80:83], a[56:59], v[160:163]
v_mfma_f32_16x16x32_bf16 v[192:195], v[84:87], a[56:59], v[192:195]
s_cmp_ge_u32 s68, 2
s_cselect_b32 s93, s101, 0x20000000
buffer_load_dword v75, v57, s[96:99], s93 offen
v_mfma_f32_16x16x32_bf16 v[224:227], v[88:91], a[56:59], v[224:227]
v_mfma_f32_16x16x32_bf16 v[228:231], v[88:91], a[60:63], v[228:231]
v_mfma_f32_16x16x32_bf16 v[196:199], v[84:87], a[60:63], v[196:199]
v_mfma_f32_16x16x32_bf16 v[164:167], v[80:83], a[60:63], v[164:167]
s_lshl_b32 s0, s68, 9
s_add_u32 m0, s0, 160512
s_lshl_b32 s1, s70, 11
s_add_u32 s0, s0, s1
s_mov_b32 exec_hi, 0
buffer_load_dwordx4 v14, s[60:63], s0 offen lds
s_mov_b32 exec_hi, -1
s_waitcnt vmcnt(14) lgkmcnt(0)
s_barrier
v_mfma_f32_16x16x32_bf16 v[152:155], v[96:99], a[48:51], v[152:155]
ds_read_b128 a[64:67], v29 offset:32768
v_mfma_f32_16x16x32_bf16 v[184:187], v[100:103], a[48:51], v[184:187]
ds_read_b64_tr_b16 v[80:81], v39 offset:0
v_mfma_f32_16x16x32_bf16 v[216:219], v[104:107], a[48:51], v[216:219]
ds_read_b64_tr_b16 v[82:83], v39 offset:896
v_mfma_f32_16x16x32_bf16 v[248:251], v[108:111], a[48:51], v[248:251]
ds_read_b128 a[68:71], v29 offset:34816
v_mfma_f32_16x16x32_bf16 v[252:255], v[108:111], a[52:55], v[252:255]
ds_read_b128 a[72:75], v31 offset:32768
s_add_u32 m0, s78, 16384
s_add_u32 s74, s74, 128
buffer_load_dwordx4 v16, s[28:31], s74 offen offset:0 lds
v_mfma_f32_16x16x32_bf16 v[220:223], v[104:107], a[52:55], v[220:223]
ds_read_b128 a[76:79], v31 offset:34816
v_mfma_f32_16x16x32_bf16 v[188:191], v[100:103], a[52:55], v[188:191]
ds_read_b64_tr_b16 v[84:85], v39 offset:32
v_mfma_f32_16x16x32_bf16 v[156:159], v[96:99], a[52:55], v[156:159]
ds_read_b64_tr_b16 v[86:87], v39 offset:928
v_mfma_f32_16x16x32_bf16 v[168:171], v[96:99], a[56:59], v[168:171]
ds_read_b64_tr_b16 v[88:89], v39 offset:64
v_mfma_f32_16x16x32_bf16 v[200:203], v[100:103], a[56:59], v[200:203]
ds_read_b64_tr_b16 v[90:91], v39 offset:960
buffer_load_dwordx4 v17, s[28:31], s74 offen offset:1024 lds
v_mfma_f32_16x16x32_bf16 v[232:235], v[104:107], a[56:59], v[232:235]
ds_read_b64_tr_b16 v[92:93], v40 offset:0
v_mfma_f32_16x16x32_bf16 v[236:239], v[104:107], a[60:63], v[236:239]
ds_read_b64_tr_b16 v[94:95], v40 offset:896
v_mfma_f32_16x16x32_bf16 v[204:207], v[100:103], a[60:63], v[204:207]
v_mfma_f32_16x16x32_bf16 v[172:175], v[96:99], a[60:63], v[172:175]
buffer_load_dwordx4 v18, s[28:31], s74 offen offset:2048 lds
s_waitcnt lgkmcnt(0)
v_mfma_f32_16x16x32_bf16 v[144:147], v[80:83], a[64:67], v[144:147]
ds_read_b128 a[80:83], v30 offset:32768
v_mfma_f32_16x16x32_bf16 v[176:179], v[84:87], a[64:67], v[176:179]
ds_read_b64_tr_b16 v[96:97], v39 offset:15360
v_mfma_f32_16x16x32_bf16 v[208:211], v[88:91], a[64:67], v[208:211]
ds_read_b64_tr_b16 v[98:99], v39 offset:16256
v_mfma_f32_16x16x32_bf16 v[240:243], v[92:95], a[64:67], v[240:243]
ds_read_b128 a[84:87], v30 offset:34816
v_mfma_f32_16x16x32_bf16 v[244:247], v[92:95], a[68:71], v[244:247]
ds_read_b64_tr_b16 v[100:101], v39 offset:15392
buffer_load_dwordx4 v19, s[28:31], s74 offen offset:3072 lds
v_mfma_f32_16x16x32_bf16 v[212:215], v[88:91], a[68:71], v[212:215]
ds_read_b64_tr_b16 v[102:103], v39 offset:16288
v_mfma_f32_16x16x32_bf16 v[180:183], v[84:87], a[68:71], v[180:183]
ds_read_b64_tr_b16 v[104:105], v39 offset:15424
v_mfma_f32_16x16x32_bf16 v[148:151], v[80:83], a[68:71], v[148:151]
ds_read_b64_tr_b16 v[106:107], v39 offset:16320
v_mfma_f32_16x16x32_bf16 v[160:163], v[80:83], a[72:75], v[160:163]
ds_read_b64_tr_b16 v[108:109], v40 offset:15360
v_mfma_f32_16x16x32_bf16 v[192:195], v[84:87], a[72:75], v[192:195]
ds_read_b64_tr_b16 v[110:111], v40 offset:16256
s_add_u32 m0, s79, 79872
s_add_u32 s75, s75, 132096
buffer_load_dwordx4 v20, s[32:35], s75 offen offset:0 lds
v_mfma_f32_16x16x32_bf16 v[224:227], v[88:91], a[72:75], v[224:227]
v_mfma_f32_16x16x32_bf16 v[228:231], v[88:91], a[76:79], v[228:231]
v_mfma_f32_16x16x32_bf16 v[196:199], v[84:87], a[76:79], v[196:199]
v_mfma_f32_16x16x32_bf16 v[164:167], v[80:83], a[76:79], v[164:167]
buffer_load_dwordx4 v21, s[32:35], s75 offen offset:896 lds
s_waitcnt lgkmcnt(0)
v_mfma_f32_16x16x32_bf16 v[152:155], v[96:99], a[64:67], v[152:155]
ds_read_b128 a[88:91], v32 offset:32768
v_mfma_f32_16x16x32_bf16 v[184:187], v[100:103], a[64:67], v[184:187]
ds_read_b64_tr_b16 v[80:81], v39 offset:7680
v_mfma_f32_16x16x32_bf16 v[216:219], v[104:107], a[64:67], v[216:219]
ds_read_b64_tr_b16 v[82:83], v39 offset:8576
v_mfma_f32_16x16x32_bf16 v[248:251], v[108:111], a[64:67], v[248:251]
ds_read_b128 a[92:95], v32 offset:34816
v_mfma_f32_16x16x32_bf16 v[252:255], v[108:111], a[68:71], v[252:255]
ds_read_b64_tr_b16 v[84:85], v39 offset:7712
buffer_load_dwordx4 v22, s[32:35], s75 offen offset:1920 lds
v_mfma_f32_16x16x32_bf16 v[220:223], v[104:107], a[68:71], v[220:223]
ds_read_b64_tr_b16 v[86:87], v39 offset:8608
v_mfma_f32_16x16x32_bf16 v[188:191], v[100:103], a[68:71], v[188:191]
ds_read_b64_tr_b16 v[88:89], v39 offset:7744
v_mfma_f32_16x16x32_bf16 v[156:159], v[96:99], a[68:71], v[156:159]
ds_read_b64_tr_b16 v[90:91], v39 offset:8640
v_mfma_f32_16x16x32_bf16 v[168:171], v[96:99], a[72:75], v[168:171]
ds_read_b64_tr_b16 v[92:93], v40 offset:7680
v_mfma_f32_16x16x32_bf16 v[200:203], v[100:103], a[72:75], v[200:203]
ds_read_b64_tr_b16 v[94:95], v40 offset:8576
buffer_load_dwordx4 v23, s[32:35], s75 offen offset:2816 lds
v_mfma_f32_16x16x32_bf16 v[232:235], v[104:107], a[72:75], v[232:235]
v_mfma_f32_16x16x32_bf16 v[236:239], v[104:107], a[76:79], v[236:239]
v_mfma_f32_16x16x32_bf16 v[204:207], v[100:103], a[76:79], v[204:207]
v_mfma_f32_16x16x32_bf16 v[172:175], v[96:99], a[76:79], v[172:175]
s_add_u32 m0, s79, 83712
s_add_u32 s75, s75, 44032
buffer_load_dwordx4 v20, s[32:35], s75 offen offset:0 lds
s_waitcnt lgkmcnt(0)
v_mfma_f32_16x16x32_bf16 v[144:147], v[80:83], a[80:83], v[144:147]
ds_read_b64_tr_b16 v[96:97], v39 offset:23040
v_mfma_f32_16x16x32_bf16 v[176:179], v[84:87], a[80:83], v[176:179]
ds_read_b64_tr_b16 v[98:99], v39 offset:23936
v_mfma_f32_16x16x32_bf16 v[208:211], v[88:91], a[80:83], v[208:211]
ds_read_b64_tr_b16 v[100:101], v39 offset:23072
v_mfma_f32_16x16x32_bf16 v[240:243], v[92:95], a[80:83], v[240:243]
ds_read_b64_tr_b16 v[102:103], v39 offset:23968
v_mfma_f32_16x16x32_bf16 v[244:247], v[92:95], a[84:87], v[244:247]
ds_read_b64_tr_b16 v[104:105], v39 offset:23104
buffer_load_dwordx4 v21, s[32:35], s75 offen offset:896 lds
v_mfma_f32_16x16x32_bf16 v[212:215], v[88:91], a[84:87], v[212:215]
ds_read_b64_tr_b16 v[106:107], v39 offset:24000
v_mfma_f32_16x16x32_bf16 v[180:183], v[84:87], a[84:87], v[180:183]
ds_read_b64_tr_b16 v[108:109], v40 offset:23040
v_mfma_f32_16x16x32_bf16 v[148:151], v[80:83], a[84:87], v[148:151]
ds_read_b64_tr_b16 v[110:111], v40 offset:23936
v_mfma_f32_16x16x32_bf16 v[160:163], v[80:83], a[88:91], v[160:163]
v_mfma_f32_16x16x32_bf16 v[192:195], v[84:87], a[88:91], v[192:195]
buffer_load_dwordx4 v22, s[32:35], s75 offen offset:1920 lds
v_mfma_f32_16x16x32_bf16 v[224:227], v[88:91], a[88:91], v[224:227]
v_mfma_f32_16x16x32_bf16 v[228:231], v[88:91], a[92:95], v[228:231]
LhopB0:
s_cbranch_execz LhopB4
v_mfma_f32_16x16x32_bf16 v[196:199], v[84:87], a[92:95], v[196:199]
v_mfma_f32_16x16x32_bf16 v[164:167], v[80:83], a[92:95], v[164:167]
buffer_load_dwordx4 v23, s[32:35], s75 offen offset:2816 lds
s_waitcnt vmcnt(14) lgkmcnt(0)
s_barrier
v_mfma_f32_16x16x32_bf16 v[152:155], v[96:99], a[80:83], v[152:155]
ds_read_b128 a[96:99], v29 offset:0
v_mfma_f32_16x16x32_bf16 v[184:187], v[100:103], a[80:83], v[184:187]
ds_read_b64_tr_b16 v[80:81], v37 offset:0
v_mfma_f32_16x16x32_bf16 v[216:219], v[104:107], a[80:83], v[216:219]
ds_read_b64_tr_b16 v[82:83], v37 offset:896
v_mfma_f32_16x16x32_bf16 v[248:251], v[108:111], a[80:83], v[248:251]
ds_read_b128 a[100:103], v29 offset:2048
v_mfma_f32_16x16x32_bf16 v[252:255], v[108:111], a[84:87], v[252:255]
ds_read_b128 a[104:107], v31 offset:0
s_add_u32 m0, s78, 32768
s_add_u32 s74, s74, 128
buffer_load_dwordx4 v16, s[28:31], s74 offen offset:0 lds
v_mfma_f32_16x16x32_bf16 v[220:223], v[104:107], a[84:87], v[220:223]
ds_read_b128 a[108:111], v31 offset:2048
v_mfma_f32_16x16x32_bf16 v[188:191], v[100:103], a[84:87], v[188:191]
ds_read_b64_tr_b16 v[84:85], v37 offset:32
v_mfma_f32_16x16x32_bf16 v[156:159], v[96:99], a[84:87], v[156:159]
ds_read_b64_tr_b16 v[86:87], v37 offset:928
v_mfma_f32_16x16x32_bf16 v[168:171], v[96:99], a[88:91], v[168:171]
ds_read_b64_tr_b16 v[88:89], v37 offset:64
v_mfma_f32_16x16x32_bf16 v[200:203], v[100:103], a[88:91], v[200:203]
ds_read_b64_tr_b16 v[90:91], v37 offset:960
buffer_load_dwordx4 v17, s[28:31], s74 offen offset:1024 lds
v_mfma_f32_16x16x32_bf16 v[232:235], v[104:107], a[88:91], v[232:235]
ds_read_b64_tr_b16 v[92:93], v38 offset:0
v_mfma_f32_16x16x32_bf16 v[236:239], v[104:107], a[92:95], v[236:239]
ds_read_b64_tr_b16 v[94:95], v38 offset:896
v_mfma_f32_16x16x32_bf16 v[204:207], v[100:103], a[92:95], v[204:207]
v_mfma_f32_16x16x32_bf16 v[172:175], v[96:99], a[92:95], v[172:175]
buffer_load_dwordx4 v18, s[28:31], s74 offen offset:2048 lds
s_waitcnt lgkmcnt(0)
v_mfma_f32_16x16x32_bf16 v[144:147], v[80:83], a[96:99], v[144:147]
ds_read_b128 a[112:115], v30 offset:0
s_lshr_b32 s83, s2, 4
v_mfma_f32_16x16x32_bf16 v[176:179], v[84:87], a[96:99], v[176:179]
ds_read_b64_tr_b16 v[96:97], v37 offset:15360
s_lshl_b32 s3, s83, 3
v_mfma_f32_16x16x32_bf16 v[208:211], v[88:91], a[96:99], v[208:211]
ds_read_b64_tr_b16 v[98:99], v37 offset:16256
s_and_b32 s84, s2, 7
v_mfma_f32_16x16x32_bf16 v[240:243], v[92:95], a[96:99], v[240:243]
ds_read_b128 a[116:119], v30 offset:2048
s_add_u32 s3, s3, s84
v_mfma_f32_16x16x32_bf16 v[244:247], v[92:95], a[100:103], v[244:247]
ds_read_b64_tr_b16 v[100:101], v37 offset:15392
buffer_load_dwordx4 v19, s[28:31], s74 offen offset:3072 lds
v_mov_b32_e64 v2, s3
v_mfma_f32_16x16x32_bf16 v[212:215], v[88:91], a[100:103], v[212:215]
ds_read_b64_tr_b16 v[102:103], v37 offset:16288
v_mov_b32_e64 v3, s83
v_mfma_f32_16x16x32_bf16 v[180:183], v[84:87], a[100:103], v[180:183]
ds_read_b64_tr_b16 v[104:105], v37 offset:15424
v_cmp_gt_u32 vcc, 128, v0
v_mfma_f32_16x16x32_bf16 v[148:151], v[80:83], a[100:103], v[148:151]
ds_read_b64_tr_b16 v[106:107], v37 offset:16320
v_cndmask_b32 v2, v3, v2, vcc
v_mfma_f32_16x16x32_bf16 v[160:163], v[80:83], a[104:107], v[160:163]
ds_read_b64_tr_b16 v[108:109], v38 offset:15360
v_mfma_f32_16x16x32_bf16 v[192:195], v[84:87], a[104:107], v[192:195]
ds_read_b64_tr_b16 v[110:111], v38 offset:16256
s_add_u32 m0, s79, 110592
s_add_u32 s75, s75, 132096
buffer_load_dwordx4 v20, s[32:35], s75 offen offset:0 lds
v_mfma_f32_16x16x32_bf16 v[224:227], v[88:91], a[104:107], v[224:227]
v_mfma_f32_16x16x32_bf16 v[228:231], v[88:91], a[108:111], v[228:231]
v_mfma_f32_16x16x32_bf16 v[196:199], v[84:87], a[108:111], v[196:199]
v_mfma_f32_16x16x32_bf16 v[164:167], v[80:83], a[108:111], v[164:167]
buffer_load_dwordx4 v21, s[32:35], s75 offen offset:896 lds
s_waitcnt lgkmcnt(0)
v_mfma_f32_16x16x32_bf16 v[152:155], v[96:99], a[96:99], v[152:155]
ds_read_b128 a[120:123], v32 offset:0
v_cndmask_b32 v3, 10, 7, vcc
v_mfma_f32_16x16x32_bf16 v[184:187], v[100:103], a[96:99], v[184:187]
ds_read_b64_tr_b16 v[80:81], v37 offset:7680
v_and_b32 v4, 127, v0
v_mfma_f32_16x16x32_bf16 v[216:219], v[104:107], a[96:99], v[216:219]
ds_read_b64_tr_b16 v[82:83], v37 offset:8576
v_lshrrev_b32_e64 v5, 7, v0
v_mfma_f32_16x16x32_bf16 v[248:251], v[108:111], a[96:99], v[248:251]
ds_read_b128 a[124:127], v32 offset:2048
v_mul_u32_u24 v5, 384, v5
v_mfma_f32_16x16x32_bf16 v[252:255], v[108:111], a[100:103], v[252:255]
ds_read_b64_tr_b16 v[84:85], v37 offset:7712
buffer_load_dwordx4 v22, s[32:35], s75 offen offset:1920 lds
v_mov_b32_e64 v6, 0x40000000
v_mfma_f32_16x16x32_bf16 v[220:223], v[104:107], a[100:103], v[220:223]
ds_read_b64_tr_b16 v[86:87], v37 offset:8608
v_mul_u32_u24 v7, 86, v2
v_mfma_f32_16x16x32_bf16 v[188:191], v[100:103], a[100:103], v[188:191]
ds_read_b64_tr_b16 v[88:89], v37 offset:7744
v_add_u32_e64 v7, v7, v4
v_mfma_f32_16x16x32_bf16 v[156:159], v[96:99], a[100:103], v[156:159]
ds_read_b64_tr_b16 v[90:91], v37 offset:8640
v_lshlrev_b32_e64 v7, v3, v7
v_mfma_f32_16x16x32_bf16 v[168:171], v[96:99], a[104:107], v[168:171]
ds_read_b64_tr_b16 v[92:93], v38 offset:7680
v_bfe_u32 v8, v7, 7, 3
v_mfma_f32_16x16x32_bf16 v[200:203], v[100:103], a[104:107], v[200:203]
ds_read_b64_tr_b16 v[94:95], v38 offset:8576
buffer_load_dwordx4 v23, s[32:35], s75 offen offset:2816 lds
v_mfma_f32_16x16x32_bf16 v[232:235], v[104:107], a[104:107], v[232:235]
v_mfma_f32_16x16x32_bf16 v[236:239], v[104:107], a[108:111], v[236:239]
v_mfma_f32_16x16x32_bf16 v[204:207], v[100:103], a[108:111], v[204:207]
v_mfma_f32_16x16x32_bf16 v[172:175], v[96:99], a[108:111], v[172:175]
s_add_u32 m0, s79, 114432
s_add_u32 s75, s75, 44032
buffer_load_dwordx4 v20, s[32:35], s75 offen offset:0 lds
s_waitcnt lgkmcnt(0)
v_mfma_f32_16x16x32_bf16 v[144:147], v[80:83], a[112:115], v[144:147]
ds_read_b64_tr_b16 v[96:97], v37 offset:23040
v_cmp_ne_u32 vcc, 3, v8
v_mfma_f32_16x16x32_bf16 v[176:179], v[84:87], a[112:115], v[176:179]
ds_read_b64_tr_b16 v[98:99], v37 offset:23936
v_add_u32_e64 v7, v7, v5
v_mfma_f32_16x16x32_bf16 v[208:211], v[88:91], a[112:115], v[208:211]
ds_read_b64_tr_b16 v[100:101], v37 offset:23072
v_cndmask_b32 v7, v6, v7, vcc
v_mfma_f32_16x16x32_bf16 v[240:243], v[92:95], a[112:115], v[240:243]
ds_read_b64_tr_b16 v[102:103], v37 offset:23968
v_cmp_gt_u32 vcc, 86, v4
v_mfma_f32_16x16x32_bf16 v[244:247], v[92:95], a[116:119], v[244:247]
ds_read_b64_tr_b16 v[104:105], v37 offset:23104
buffer_load_dwordx4 v21, s[32:35], s75 offen offset:896 lds
v_cndmask_b32 v72, v6, v7, vcc
v_mfma_f32_16x16x32_bf16 v[212:215], v[88:91], a[116:119], v[212:215]
ds_read_b64_tr_b16 v[106:107], v37 offset:24000
v_mul_u32_u24_e64 v7, 32, v2
v_mfma_f32_16x16x32_bf16 v[180:183], v[84:87], a[116:119], v[180:183]
ds_read_b64_tr_b16 v[108:109], v38 offset:23040
v_add_u32_e64 v7, v7, v4
v_mfma_f32_16x16x32_bf16 v[148:151], v[80:83], a[116:119], v[148:151]
ds_read_b64_tr_b16 v[110:111], v38 offset:23936
v_lshlrev_b32_e64 v7, v3, v7
v_mfma_f32_16x16x32_bf16 v[160:163], v[80:83], a[120:123], v[160:163]
v_bfe_u32 v8, v7, 7, 3
v_mfma_f32_16x16x32_bf16 v[192:195], v[84:87], a[120:123], v[192:195]
buffer_load_dwordx4 v22, s[32:35], s75 offen offset:1920 lds
v_mfma_f32_16x16x32_bf16 v[224:227], v[88:91], a[120:123], v[224:227]
v_mfma_f32_16x16x32_bf16 v[228:231], v[88:91], a[124:127], v[228:231]
v_mfma_f32_16x16x32_bf16 v[196:199], v[84:87], a[124:127], v[196:199]
v_mfma_f32_16x16x32_bf16 v[164:167], v[80:83], a[124:127], v[164:167]
buffer_load_dwordx4 v23, s[32:35], s75 offen offset:2816 lds
s_waitcnt vmcnt(12) lgkmcnt(0)
s_barrier
v_mfma_f32_16x16x32_bf16 v[152:155], v[96:99], a[112:115], v[152:155]
ds_read_b128 a[128:131], v29 offset:16384
v_cmp_ne_u32 vcc, 3, v8
v_mfma_f32_16x16x32_bf16 v[184:187], v[100:103], a[112:115], v[184:187]
ds_read_b64_tr_b16 v[80:81], v37 offset:30720
v_add_u32 v7, v7, v5
v_mfma_f32_16x16x32_bf16 v[216:219], v[104:107], a[112:115], v[216:219]
ds_read_b64_tr_b16 v[82:83], v37 offset:31616
v_cndmask_b32 v7, v6, v7, vcc
v_mfma_f32_16x16x32_bf16 v[248:251], v[108:111], a[112:115], v[248:251]
ds_read_b128 a[132:135], v29 offset:18432
v_cmp_gt_u32 vcc, 32, v4
v_mfma_f32_16x16x32_bf16 v[252:255], v[108:111], a[116:119], v[252:255]
ds_read_b128 a[136:139], v31 offset:16384
s_add_u32 m0, s78, 0
s_add_u32 s74, s74, 128
buffer_load_dwordx4 v16, s[28:31], s74 offen offset:0 lds
v_cndmask_b32 v73, v6, v7, vcc
v_mfma_f32_16x16x32_bf16 v[220:223], v[104:107], a[116:119], v[220:223]
ds_read_b128 a[140:143], v31 offset:18432
v_bfe_u32 v2, v1, 2, 3
v_mfma_f32_16x16x32_bf16 v[188:191], v[100:103], a[116:119], v[188:191]
ds_read_b64_tr_b16 v[84:85], v37 offset:30752
v_lshrrev_b32_e64 v3, 1, v2
v_mfma_f32_16x16x32_bf16 v[156:159], v[96:99], a[116:119], v[156:159]
ds_read_b64_tr_b16 v[86:87], v37 offset:31648
v_and_b32_e64 v4, 3, v1
v_mfma_f32_16x16x32_bf16 v[168:171], v[96:99], a[120:123], v[168:171]
ds_read_b64_tr_b16 v[88:89], v37 offset:30784
v_mfma_f32_16x16x32_bf16 v[200:203], v[100:103], a[120:123], v[200:203]
ds_read_b64_tr_b16 v[90:91], v37 offset:31680
buffer_load_dwordx4 v17, s[28:31], s74 offen offset:1024 lds
v_mfma_f32_16x16x32_bf16 v[232:235], v[104:107], a[120:123], v[232:235]
ds_read_b64_tr_b16 v[92:93], v38 offset:30720
v_mfma_f32_16x16x32_bf16 v[236:239], v[104:107], a[124:127], v[236:239]
ds_read_b64_tr_b16 v[94:95], v38 offset:31616
v_mfma_f32_16x16x32_bf16 v[204:207], v[100:103], a[124:127], v[204:207]
v_mfma_f32_16x16x32_bf16 v[172:175], v[96:99], a[124:127], v[172:175]
buffer_load_dwordx4 v18, s[28:31], s74 offen offset:2048 lds
s_waitcnt lgkmcnt(0)
v_mfma_f32_16x16x32_bf16 v[144:147], v[80:83], a[128:131], v[144:147]
ds_read_b128 a[144:147], v30 offset:16384
v_lshlrev_b32 v4, 3, v4
v_mfma_f32_16x16x32_bf16 v[176:179], v[84:87], a[128:131], v[176:179]
ds_read_b64_tr_b16 v[96:97], v37 offset:46080
v_lshl_add_u32 v4, v3, 5, v4
v_mfma_f32_16x16x32_bf16 v[208:211], v[88:91], a[128:131], v[208:211]
ds_read_b64_tr_b16 v[98:99], v37 offset:46976
v_lshl_add_u32 v4, v2, 7, v4
v_mfma_f32_16x16x32_bf16 v[240:243], v[92:95], a[128:131], v[240:243]
ds_read_b128 a[148:151], v30 offset:18432
v_lshrrev_b32_e64 v3, 5, v1
v_mfma_f32_16x16x32_bf16 v[244:247], v[92:95], a[132:135], v[244:247]
ds_read_b64_tr_b16 v[100:101], v37 offset:46112
buffer_load_dwordx4 v19, s[28:31], s74 offen offset:3072 lds
v_lshl_add_u32 v4, v3, 11, v4
v_mfma_f32_16x16x32_bf16 v[212:215], v[88:91], a[132:135], v[212:215]
ds_read_b64_tr_b16 v[102:103], v37 offset:47008
v_add_u32_e64 v48, s78, v4
v_mfma_f32_16x16x32_bf16 v[180:183], v[84:87], a[132:135], v[180:183]
ds_read_b64_tr_b16 v[104:105], v37 offset:46144
v_xor_b32_e64 v49, 32, v48
v_mfma_f32_16x16x32_bf16 v[148:151], v[80:83], a[132:135], v[148:151]
ds_read_b64_tr_b16 v[106:107], v37 offset:47040
v_xor_b32_e64 v50, 64, v48
v_mfma_f32_16x16x32_bf16 v[160:163], v[80:83], a[136:139], v[160:163]
ds_read_b64_tr_b16 v[108:109], v38 offset:46080
v_xor_b32 v51, 96, v48
v_mfma_f32_16x16x32_bf16 v[192:195], v[84:87], a[136:139], v[192:195]
ds_read_b64_tr_b16 v[110:111], v38 offset:46976
s_add_u32 m0, s79, 49152
s_add_u32 s75, s75, 132096
buffer_load_dwordx4 v20, s[32:35], s75 offen offset:0 lds
v_mfma_f32_16x16x32_bf16 v[224:227], v[88:91], a[136:139], v[224:227]
v_mfma_f32_16x16x32_bf16 v[228:231], v[88:91], a[140:143], v[228:231]
v_mfma_f32_16x16x32_bf16 v[196:199], v[84:87], a[140:143], v[196:199]
v_mfma_f32_16x16x32_bf16 v[164:167], v[80:83], a[140:143], v[164:167]
buffer_load_dwordx4 v21, s[32:35], s75 offen offset:896 lds
s_waitcnt lgkmcnt(0)
v_mfma_f32_16x16x32_bf16 v[152:155], v[96:99], a[128:131], v[152:155]
ds_read_b128 a[152:155], v32 offset:16384
v_bfe_u32 v2, v1, 2, 2
v_mfma_f32_16x16x32_bf16 v[184:187], v[100:103], a[128:131], v[184:187]
ds_read_b64_tr_b16 v[80:81], v37 offset:38400
v_lshrrev_b32 v3, 5, v1
v_mfma_f32_16x16x32_bf16 v[216:219], v[104:107], a[128:131], v[216:219]
ds_read_b64_tr_b16 v[82:83], v37 offset:39296
v_lshl_add_u32 v3, v3, 2, v2
v_mfma_f32_16x16x32_bf16 v[248:251], v[108:111], a[128:131], v[248:251]
ds_read_b128 a[156:159], v32 offset:18432
v_bfe_u32 v2, v1, 1, 1
v_mfma_f32_16x16x32_bf16 v[252:255], v[108:111], a[132:135], v[252:255]
ds_read_b64_tr_b16 v[84:85], v37 offset:38432
buffer_load_dwordx4 v22, s[32:35], s75 offen offset:1920 lds
v_and_b32_e64 v4, 16, v1
v_mfma_f32_16x16x32_bf16 v[220:223], v[104:107], a[132:135], v[220:223]
ds_read_b64_tr_b16 v[86:87], v37 offset:39328
v_lshl_add_u32 v4, v2, 3, v4
v_mfma_f32_16x16x32_bf16 v[188:191], v[100:103], a[132:135], v[188:191]
ds_read_b64_tr_b16 v[88:89], v37 offset:38464
v_lshl_add_u32 v4, v3, 5, v4
v_mfma_f32_16x16x32_bf16 v[156:159], v[96:99], a[132:135], v[156:159]
ds_read_b64_tr_b16 v[90:91], v37 offset:39360
s_lshl_b32 s3, s77, 10
v_mfma_f32_16x16x32_bf16 v[168:171], v[96:99], a[136:139], v[168:171]
ds_read_b64_tr_b16 v[92:93], v38 offset:38400
s_add_u32 s3, s3, 160512
v_mfma_f32_16x16x32_bf16 v[200:203], v[100:103], a[136:139], v[200:203]
ds_read_b64_tr_b16 v[94:95], v38 offset:39296
buffer_load_dwordx4 v23, s[32:35], s75 offen offset:2816 lds
v_mfma_f32_16x16x32_bf16 v[232:235], v[104:107], a[136:139], v[232:235]
v_mfma_f32_16x16x32_bf16 v[236:239], v[104:107], a[140:143], v[236:239]
v_mfma_f32_16x16x32_bf16 v[204:207], v[100:103], a[140:143], v[204:207]
v_mfma_f32_16x16x32_bf16 v[172:175], v[96:99], a[140:143], v[172:175]
s_add_u32 m0, s79, 52992
s_add_u32 s75, s75, 44032
buffer_load_dwordx4 v20, s[32:35], s75 offen offset:0 lds
s_waitcnt lgkmcnt(0)
v_mfma_f32_16x16x32_bf16 v[144:147], v[80:83], a[144:147], v[144:147]
ds_read_b64_tr_b16 v[96:97], v37 offset:53760
v_add_u32_e64 v4, s3, v4
v_mfma_f32_16x16x32_bf16 v[176:179], v[84:87], a[144:147], v[176:179]
ds_read_b64_tr_b16 v[98:99], v37 offset:54656
v_mfma_f32_16x16x32_bf16 v[208:211], v[88:91], a[144:147], v[208:211]
ds_read_b64_tr_b16 v[100:101], v37 offset:53792
ds_read_b64_tr_b16 v[60:61], v4 offset:0
v_mfma_f32_16x16x32_bf16 v[240:243], v[92:95], a[144:147], v[240:243]
ds_read_b64_tr_b16 v[102:103], v37 offset:54688
ds_read_b64_tr_b16 v[62:63], v4 offset:256
v_mfma_f32_16x16x32_bf16 v[244:247], v[92:95], a[148:151], v[244:247]
ds_read_b64_tr_b16 v[104:105], v37 offset:53824
buffer_load_dwordx4 v21, s[32:35], s75 offen offset:896 lds
ds_read_b64_tr_b16 v[64:65], v4 offset:512
v_mfma_f32_16x16x32_bf16 v[212:215], v[88:91], a[148:151], v[212:215]
ds_read_b64_tr_b16 v[106:107], v37 offset:54720
ds_read_b64_tr_b16 v[66:67], v4 offset:768
v_mfma_f32_16x16x32_bf16 v[180:183], v[84:87], a[148:151], v[180:183]
ds_read_b64_tr_b16 v[108:109], v38 offset:53760
v_bfe_u32 v6, v1, 2, 1
v_mfma_f32_16x16x32_bf16 v[148:151], v[80:83], a[148:151], v[148:151]
ds_read_b64_tr_b16 v[110:111], v38 offset:54656
v_mul_u32_u24 v6, 0x8000, v6
v_mfma_f32_16x16x32_bf16 v[160:163], v[80:83], a[152:155], v[160:163]
v_lshl_or_b32 v56, v6, 16, v6
v_mfma_f32_16x16x32_bf16 v[192:195], v[84:87], a[152:155], v[192:195]
buffer_load_dwordx4 v22, s[32:35], s75 offen offset:1920 lds
v_mfma_f32_16x16x32_bf16 v[224:227], v[88:91], a[152:155], v[224:227]
v_mfma_f32_16x16x32_bf16 v[228:231], v[88:91], a[156:159], v[228:231]
v_mfma_f32_16x16x32_bf16 v[196:199], v[84:87], a[156:159], v[196:199]
v_mfma_f32_16x16x32_bf16 v[164:167], v[80:83], a[156:159], v[164:167]
buffer_load_dwordx4 v23, s[32:35], s75 offen offset:2816 lds
s_waitcnt vmcnt(12) lgkmcnt(0)
s_barrier
v_mfma_f32_16x16x32_bf16 v[152:155], v[96:99], a[144:147], v[152:155]
ds_read_b128 a[160:163], v29 offset:32768
v_xor_b32_e64 v60, v60, v56
v_mfma_f32_16x16x32_bf16 v[184:187], v[100:103], a[144:147], v[184:187]
ds_read_b64_tr_b16 v[80:81], v39 offset:0
v_xor_b32_e64 v61, v61, v56
v_mfma_f32_16x16x32_bf16 v[216:219], v[104:107], a[144:147], v[216:219]
ds_read_b64_tr_b16 v[82:83], v39 offset:896
v_xor_b32_e64 v62, v62, v56
v_mfma_f32_16x16x32_bf16 v[248:251], v[108:111], a[144:147], v[248:251]
ds_read_b128 a[164:167], v29 offset:34816
s_add_u32 m0, s78, 16384
s_add_u32 s74, s74, 128
buffer_load_dwordx4 v16, s[28:31], s74 offen offset:0 lds
v_xor_b32_e64 v63, v63, v56
v_mfma_f32_16x16x32_bf16 v[252:255], v[108:111], a[148:151], v[252:255]
ds_read_b128 a[168:171], v31 offset:32768
v_xor_b32_e64 v64, v64, v56
v_mfma_f32_16x16x32_bf16 v[220:223], v[104:107], a[148:151], v[220:223]
ds_read_b128 a[172:175], v31 offset:34816
v_xor_b32_e64 v65, v65, v56
v_mfma_f32_16x16x32_bf16 v[188:191], v[100:103], a[148:151], v[188:191]
ds_read_b64_tr_b16 v[84:85], v39 offset:32
buffer_load_dwordx4 v17, s[28:31], s74 offen offset:1024 lds
v_xor_b32_e64 v66, v66, v56
v_mfma_f32_16x16x32_bf16 v[156:159], v[96:99], a[148:151], v[156:159]
ds_read_b64_tr_b16 v[86:87], v39 offset:928
v_mfma_f32_16x16x32_bf16 v[168:171], v[96:99], a[152:155], v[168:171]
ds_read_b64_tr_b16 v[88:89], v39 offset:64
v_mfma_f32_16x16x32_bf16 v[200:203], v[100:103], a[152:155], v[200:203]
ds_read_b64_tr_b16 v[90:91], v39 offset:960
v_mfma_f32_16x16x32_bf16 v[232:235], v[104:107], a[152:155], v[232:235]
ds_read_b64_tr_b16 v[92:93], v40 offset:0
buffer_load_dwordx4 v18, s[28:31], s74 offen offset:2048 lds
v_mfma_f32_16x16x32_bf16 v[236:239], v[104:107], a[156:159], v[236:239]
ds_read_b64_tr_b16 v[94:95], v40 offset:896
v_mfma_f32_16x16x32_bf16 v[204:207], v[100:103], a[156:159], v[204:207]
v_mfma_f32_16x16x32_bf16 v[172:175], v[96:99], a[156:159], v[172:175]
buffer_load_dwordx4 v19, s[28:31], s74 offen offset:3072 lds
s_waitcnt lgkmcnt(0)
v_mfma_f32_16x16x32_bf16 v[144:147], v[80:83], a[160:163], v[144:147]
ds_read_b128 a[176:179], v30 offset:32768
v_xor_b32 v67, v67, v56
v_mfma_f32_16x16x32_bf16 v[176:179], v[84:87], a[160:163], v[176:179]
ds_read_b64_tr_b16 v[96:97], v39 offset:15360
v_lshrrev_b32_e64 v2, 3, v1
v_mfma_f32_16x16x32_bf16 v[208:211], v[88:91], a[160:163], v[208:211]
ds_read_b64_tr_b16 v[98:99], v39 offset:16256
v_lshl_add_u32 v14, v2, 7, v14
v_mfma_f32_16x16x32_bf16 v[240:243], v[92:95], a[160:163], v[240:243]
ds_read_b128 a[180:183], v30 offset:34816
s_lshl_b32 s60, s69, 8
v_mfma_f32_16x16x32_bf16 v[244:247], v[92:95], a[164:167], v[244:247]
ds_read_b64_tr_b16 v[100:101], v39 offset:15392
s_add_u32 m0, s79, 79872
s_add_u32 s75, s75, 132096
buffer_load_dwordx4 v20, s[32:35], s75 offen offset:0 lds
s_add_u32 s60, s60, 0x1fc0800
v_mfma_f32_16x16x32_bf16 v[212:215], v[88:91], a[164:167], v[212:215]
ds_read_b64_tr_b16 v[102:103], v39 offset:16288
s_lshl_b32 s61, s69, 8
v_mfma_f32_16x16x32_bf16 v[180:183], v[84:87], a[164:167], v[180:183]
ds_read_b64_tr_b16 v[104:105], v39 offset:15424
s_add_u32 s61, s61, 0x1fc2800
v_mfma_f32_16x16x32_bf16 v[148:151], v[80:83], a[164:167], v[148:151]
ds_read_b64_tr_b16 v[106:107], v39 offset:16320
v_mfma_f32_16x16x32_bf16 v[160:163], v[80:83], a[168:171], v[160:163]
ds_read_b64_tr_b16 v[108:109], v40 offset:15360
v_mfma_f32_16x16x32_bf16 v[192:195], v[84:87], a[168:171], v[192:195]
ds_read_b64_tr_b16 v[110:111], v40 offset:16256
buffer_load_dwordx4 v21, s[32:35], s75 offen offset:896 lds
v_mfma_f32_16x16x32_bf16 v[224:227], v[88:91], a[168:171], v[224:227]
v_mfma_f32_16x16x32_bf16 v[228:231], v[88:91], a[172:175], v[228:231]
v_mfma_f32_16x16x32_bf16 v[196:199], v[84:87], a[172:175], v[196:199]
v_mfma_f32_16x16x32_bf16 v[164:167], v[80:83], a[172:175], v[164:167]
buffer_load_dwordx4 v22, s[32:35], s75 offen offset:1920 lds
s_waitcnt lgkmcnt(0)
v_mfma_f32_16x16x32_bf16 v[152:155], v[96:99], a[160:163], v[152:155]
ds_read_b128 a[184:187], v32 offset:32768
s_lshr_b32 s63, s72, 1
v_mfma_f32_16x16x32_bf16 v[184:187], v[100:103], a[160:163], v[184:187]
ds_read_b64_tr_b16 v[80:81], v39 offset:7680
s_lshl_b32 s63, s63, 8
v_mfma_f32_16x16x32_bf16 v[216:219], v[104:107], a[160:163], v[216:219]
ds_read_b64_tr_b16 v[82:83], v39 offset:8576
s_add_u32 s63, s63, 0x1fc0800
v_mfma_f32_16x16x32_bf16 v[248:251], v[108:111], a[160:163], v[248:251]
ds_read_b128 a[188:191], v32 offset:34816
s_lshr_b32 s64, s72, 1
v_mfma_f32_16x16x32_bf16 v[252:255], v[108:111], a[164:167], v[252:255]
ds_read_b64_tr_b16 v[84:85], v39 offset:7712
buffer_load_dwordx4 v23, s[32:35], s75 offen offset:2816 lds
s_lshl_b32 s64, s64, 8
v_mfma_f32_16x16x32_bf16 v[220:223], v[104:107], a[164:167], v[220:223]
ds_read_b64_tr_b16 v[86:87], v39 offset:8608
s_add_u32 s64, s64, 0x1fc2800
v_mfma_f32_16x16x32_bf16 v[188:191], v[100:103], a[164:167], v[188:191]
ds_read_b64_tr_b16 v[88:89], v39 offset:7744
s_lshl_b32 s62, s70, 8
v_mfma_f32_16x16x32_bf16 v[156:159], v[96:99], a[164:167], v[156:159]
ds_read_b64_tr_b16 v[90:91], v39 offset:8640
v_mfma_f32_16x16x32_bf16 v[168:171], v[96:99], a[168:171], v[168:171]
ds_read_b64_tr_b16 v[92:93], v40 offset:7680
v_mfma_f32_16x16x32_bf16 v[200:203], v[100:103], a[168:171], v[200:203]
ds_read_b64_tr_b16 v[94:95], v40 offset:8576
s_add_u32 m0, s79, 83712
s_add_u32 s75, s75, 44032
buffer_load_dwordx4 v20, s[32:35], s75 offen offset:0 lds
v_mfma_f32_16x16x32_bf16 v[232:235], v[104:107], a[168:171], v[232:235]
v_mfma_f32_16x16x32_bf16 v[236:239], v[104:107], a[172:175], v[236:239]
v_mfma_f32_16x16x32_bf16 v[204:207], v[100:103], a[172:175], v[204:207]
v_mfma_f32_16x16x32_bf16 v[172:175], v[96:99], a[172:175], v[172:175]
buffer_load_dwordx4 v21, s[32:35], s75 offen offset:896 lds
s_waitcnt lgkmcnt(0)
v_mfma_f32_16x16x32_bf16 v[144:147], v[80:83], a[176:179], v[144:147]
ds_read_b64_tr_b16 v[96:97], v39 offset:23040
s_add_u32 s62, s62, 0x1fc0000
v_mfma_f32_16x16x32_bf16 v[176:179], v[84:87], a[176:179], v[176:179]
ds_read_b64_tr_b16 v[98:99], v39 offset:23936
s_lshl_b32 s65, s72, 8
v_mfma_f32_16x16x32_bf16 v[208:211], v[88:91], a[176:179], v[208:211]
ds_read_b64_tr_b16 v[100:101], v39 offset:23072
s_add_u32 s65, s65, 0x1f80000
v_mfma_f32_16x16x32_bf16 v[240:243], v[92:95], a[176:179], v[240:243]
ds_read_b64_tr_b16 v[102:103], v39 offset:23968
s_lshl_b32 s66, s72, 16
v_mfma_f32_16x16x32_bf16 v[244:247], v[92:95], a[180:183], v[244:247]
ds_read_b64_tr_b16 v[104:105], v39 offset:23104
buffer_load_dwordx4 v22, s[32:35], s75 offen offset:1920 lds
s_lshl_b32 s3, s73, 7
v_mfma_f32_16x16x32_bf16 v[212:215], v[88:91], a[180:183], v[212:215]
ds_read_b64_tr_b16 v[106:107], v39 offset:24000
s_add_u32 s66, s66, s3
v_mfma_f32_16x16x32_bf16 v[180:183], v[84:87], a[180:183], v[180:183]
ds_read_b64_tr_b16 v[108:109], v40 offset:23040
s_add_u32 s67, s66, 32768
v_mfma_f32_16x16x32_bf16 v[148:151], v[80:83], a[180:183], v[148:151]
ds_read_b64_tr_b16 v[110:111], v40 offset:23936
v_mfma_f32_16x16x32_bf16 v[160:163], v[80:83], a[184:187], v[160:163]
v_mfma_f32_16x16x32_bf16 v[192:195], v[84:87], a[184:187], v[192:195]
buffer_load_dwordx4 v23, s[32:35], s75 offen offset:2816 lds
v_mfma_f32_16x16x32_bf16 v[224:227], v[88:91], a[184:187], v[224:227]
v_mfma_f32_16x16x32_bf16 v[228:231], v[88:91], a[188:191], v[228:231]
v_mfma_f32_16x16x32_bf16 v[196:199], v[84:87], a[188:191], v[196:199]
v_mfma_f32_16x16x32_bf16 v[164:167], v[80:83], a[188:191], v[164:167]
s_cmp_lt_u32 s68, 2
s_cselect_b32 s93, 0, 0x20000000
buffer_load_dword v76, v52, s[96:99], s93 offen
s_waitcnt vmcnt(13) lgkmcnt(0)
s_barrier
v_mfma_f32_16x16x32_bf16 v[152:155], v[96:99], a[176:179], v[152:155]
ds_read_b128 a[192:195], v29 offset:0
s_lshl_b32 s3, s69, 1
v_mfma_f32_16x16x32_bf16 v[184:187], v[100:103], a[176:179], v[184:187]
ds_read_b64_tr_b16 v[80:81], v37 offset:0
s_lshr_b32 s83, s68, 1
v_mfma_f32_16x16x32_bf16 v[216:219], v[104:107], a[176:179], v[216:219]
ds_read_b64_tr_b16 v[82:83], v37 offset:896
s_add_u32 s3, s3, s83
v_mfma_f32_16x16x32_bf16 v[248:251], v[108:111], a[176:179], v[248:251]
ds_read_b128 a[196:199], v29 offset:2048
s_mul_i32 s86, s3, 540672
v_mfma_f32_16x16x32_bf16 v[252:255], v[108:111], a[180:183], v[252:255]
ds_read_b128 a[200:203], v31 offset:0
s_lshl_b32 s3, s77, 11
v_mfma_f32_16x16x32_bf16 v[220:223], v[104:107], a[180:183], v[220:223]
ds_read_b128 a[204:207], v31 offset:2048
s_add_u32 s86, s86, s3
v_mfma_f32_16x16x32_bf16 v[188:191], v[100:103], a[180:183], v[188:191]
ds_read_b64_tr_b16 v[84:85], v37 offset:32
s_mul_i32 s83, s77, 3
v_mfma_f32_16x16x32_bf16 v[156:159], v[96:99], a[180:183], v[156:159]
ds_read_b64_tr_b16 v[86:87], v37 offset:928
s_add_u32 s83, s83, s71
v_mfma_f32_16x16x32_bf16 v[168:171], v[96:99], a[184:187], v[168:171]
ds_read_b64_tr_b16 v[88:89], v37 offset:64
s_and_b32 s3, s83, 3
v_mfma_f32_16x16x32_bf16 v[200:203], v[100:103], a[184:187], v[200:203]
ds_read_b64_tr_b16 v[90:91], v37 offset:960
v_mfma_f32_16x16x32_bf16 v[232:235], v[104:107], a[184:187], v[232:235]
ds_read_b64_tr_b16 v[92:93], v38 offset:0
v_mfma_f32_16x16x32_bf16 v[236:239], v[104:107], a[188:191], v[236:239]
ds_read_b64_tr_b16 v[94:95], v38 offset:896
v_mfma_f32_16x16x32_bf16 v[204:207], v[100:103], a[188:191], v[204:207]
v_mfma_f32_16x16x32_bf16 v[172:175], v[96:99], a[188:191], v[172:175]
buffer_load_dword v68, v72, s[40:43], 0 offen
s_waitcnt lgkmcnt(0)
v_mfma_f32_16x16x32_bf16 v[144:147], v[80:83], a[192:195], v[144:147]
ds_read_b128 a[208:211], v30 offset:0
v_lshrrev_b32 v59, 5, v15
buffer_load_dword v13, v59, s[52:55], 0 offen sc1
v_mfma_f32_16x16x32_bf16 v[176:179], v[84:87], a[192:195], v[176:179]
ds_read_b64_tr_b16 v[96:97], v37 offset:15360
s_mul_i32 s3, s3, 33
v_mfma_f32_16x16x32_bf16 v[208:211], v[88:91], a[192:195], v[208:211]
ds_read_b64_tr_b16 v[98:99], v37 offset:16256
s_lshr_b32 s32, s83, 2
v_mfma_f32_16x16x32_bf16 v[240:243], v[92:95], a[192:195], v[240:243]
ds_read_b128 a[212:215], v30 offset:2048
s_add_u32 s3, s3, s32
v_mfma_f32_16x16x32_bf16 v[244:247], v[92:95], a[196:199], v[244:247]
ds_read_b64_tr_b16 v[100:101], v37 offset:15392
s_lshl_b32 s3, s3, 12
v_mfma_f32_16x16x32_bf16 v[212:215], v[88:91], a[196:199], v[212:215]
ds_read_b64_tr_b16 v[102:103], v37 offset:16288
s_add_u32 s32, s3, s86
v_mfma_f32_16x16x32_bf16 v[180:183], v[84:87], a[196:199], v[180:183]
ds_read_b64_tr_b16 v[104:105], v37 offset:15424
s_xor_b32 s33, s32, 2048
v_mfma_f32_16x16x32_bf16 v[148:151], v[80:83], a[196:199], v[148:151]
ds_read_b64_tr_b16 v[106:107], v37 offset:16320
s_add_u32 s83, s83, 1
v_mfma_f32_16x16x32_bf16 v[160:163], v[80:83], a[200:203], v[160:163]
ds_read_b64_tr_b16 v[108:109], v38 offset:15360
s_and_b32 s3, s83, 3
v_mfma_f32_16x16x32_bf16 v[192:195], v[84:87], a[200:203], v[192:195]
ds_read_b64_tr_b16 v[110:111], v38 offset:16256
s_mul_i32 s3, s3, 33
v_mfma_f32_16x16x32_bf16 v[224:227], v[88:91], a[200:203], v[224:227]
v_mfma_f32_16x16x32_bf16 v[228:231], v[88:91], a[204:207], v[228:231]
v_mfma_f32_16x16x32_bf16 v[196:199], v[84:87], a[204:207], v[196:199]
v_mfma_f32_16x16x32_bf16 v[164:167], v[80:83], a[204:207], v[164:167]
buffer_load_dword v69, v73, s[44:47], 0 offen
s_waitcnt lgkmcnt(0)
v_mfma_f32_16x16x32_bf16 v[152:155], v[96:99], a[192:195], v[152:155]
ds_read_b128 a[216:219], v32 offset:0
s_lshr_b32 s34, s83, 2
v_mfma_f32_16x16x32_bf16 v[184:187], v[100:103], a[192:195], v[184:187]
ds_read_b64_tr_b16 v[80:81], v37 offset:7680
s_add_u32 s3, s3, s34
v_mfma_f32_16x16x32_bf16 v[216:219], v[104:107], a[192:195], v[216:219]
ds_read_b64_tr_b16 v[82:83], v37 offset:8576
s_lshl_b32 s3, s3, 12
v_mfma_f32_16x16x32_bf16 v[248:251], v[108:111], a[192:195], v[248:251]
ds_read_b128 a[220:223], v32 offset:2048
s_add_u32 s34, s3, s86
v_mfma_f32_16x16x32_bf16 v[252:255], v[108:111], a[196:199], v[252:255]
ds_read_b64_tr_b16 v[84:85], v37 offset:7712
s_xor_b32 s35, s34, 2048
v_mfma_f32_16x16x32_bf16 v[220:223], v[104:107], a[196:199], v[220:223]
ds_read_b64_tr_b16 v[86:87], v37 offset:8608
s_add_u32 s83, s83, 1
v_mfma_f32_16x16x32_bf16 v[188:191], v[100:103], a[196:199], v[188:191]
ds_read_b64_tr_b16 v[88:89], v37 offset:7744
LhopB1:
s_cbranch_execz LbackB
s_and_b32 s3, s83, 3
v_mfma_f32_16x16x32_bf16 v[156:159], v[96:99], a[196:199], v[156:159]
ds_read_b64_tr_b16 v[90:91], v37 offset:8640
s_mul_i32 s3, s3, 33
v_mfma_f32_16x16x32_bf16 v[168:171], v[96:99], a[200:203], v[168:171]
ds_read_b64_tr_b16 v[92:93], v38 offset:7680
s_lshr_b32 s79, s83, 2
v_mfma_f32_16x16x32_bf16 v[200:203], v[100:103], a[200:203], v[200:203]
ds_read_b64_tr_b16 v[94:95], v38 offset:8576
v_mfma_f32_16x16x32_bf16 v[232:235], v[104:107], a[200:203], v[232:235]
v_mfma_f32_16x16x32_bf16 v[236:239], v[104:107], a[204:207], v[236:239]
v_mfma_f32_16x16x32_bf16 v[204:207], v[100:103], a[204:207], v[204:207]
v_mfma_f32_16x16x32_bf16 v[172:175], v[96:99], a[204:207], v[172:175]
s_waitcnt lgkmcnt(0)
v_mfma_f32_16x16x32_bf16 v[144:147], v[80:83], a[208:211], v[144:147]
ds_read_b64_tr_b16 v[96:97], v37 offset:23040
s_add_u32 s3, s3, s79
v_mfma_f32_16x16x32_bf16 v[176:179], v[84:87], a[208:211], v[176:179]
ds_read_b64_tr_b16 v[98:99], v37 offset:23936
s_lshl_b32 s3, s3, 12
v_mfma_f32_16x16x32_bf16 v[208:211], v[88:91], a[208:211], v[208:211]
ds_read_b64_tr_b16 v[100:101], v37 offset:23072
s_add_u32 s79, s3, s86
v_mfma_f32_16x16x32_bf16 v[240:243], v[92:95], a[208:211], v[240:243]
ds_read_b64_tr_b16 v[102:103], v37 offset:23968
s_xor_b32 s75, s79, 2048
v_mfma_f32_16x16x32_bf16 v[244:247], v[92:95], a[212:215], v[244:247]
ds_read_b64_tr_b16 v[104:105], v37 offset:23104
s_add_u32 s83, s83, 1
v_mfma_f32_16x16x32_bf16 v[212:215], v[88:91], a[212:215], v[212:215]
ds_read_b64_tr_b16 v[106:107], v37 offset:24000
s_add_u32 s83, s71, 6
v_mfma_f32_16x16x32_bf16 v[180:183], v[84:87], a[212:215], v[180:183]
ds_read_b64_tr_b16 v[108:109], v38 offset:23040
s_and_b32 s3, s83, 3
v_mfma_f32_16x16x32_bf16 v[148:151], v[80:83], a[212:215], v[148:151]
ds_read_b64_tr_b16 v[110:111], v38 offset:23936
s_mul_i32 s3, s3, 33
v_mfma_f32_16x16x32_bf16 v[160:163], v[80:83], a[216:219], v[160:163]
s_lshr_b32 s74, s83, 2
v_mfma_f32_16x16x32_bf16 v[192:195], v[84:87], a[216:219], v[192:195]
s_add_u32 s3, s3, s74
v_mfma_f32_16x16x32_bf16 v[224:227], v[88:91], a[216:219], v[224:227]
v_mfma_f32_16x16x32_bf16 v[228:231], v[88:91], a[220:223], v[228:231]
v_mfma_f32_16x16x32_bf16 v[196:199], v[84:87], a[220:223], v[196:199]
v_mfma_f32_16x16x32_bf16 v[164:167], v[80:83], a[220:223], v[164:167]
s_waitcnt vmcnt(4) lgkmcnt(0)
s_barrier
v_mfma_f32_16x16x32_bf16 v[152:155], v[96:99], a[208:211], v[152:155]
ds_read_b128 a[224:227], v29 offset:16384
s_lshl_b32 s3, s3, 12
v_mfma_f32_16x16x32_bf16 v[184:187], v[100:103], a[208:211], v[184:187]
ds_read_b64_tr_b16 v[80:81], v37 offset:30720
s_add_u32 s74, s3, s86
v_mfma_f32_16x16x32_bf16 v[216:219], v[104:107], a[208:211], v[216:219]
ds_read_b64_tr_b16 v[82:83], v37 offset:31616
s_mul_i32 s3, s77, 66
v_mfma_f32_16x16x32_bf16 v[248:251], v[108:111], a[208:211], v[248:251]
ds_read_b128 a[228:231], v29 offset:18432
s_add_u32 s3, s3, s70
v_mfma_f32_16x16x32_bf16 v[252:255], v[108:111], a[212:215], v[252:255]
ds_read_b128 a[232:235], v31 offset:16384
s_add_u32 s3, s3, 22
v_mfma_f32_16x16x32_bf16 v[220:223], v[104:107], a[212:215], v[220:223]
ds_read_b128 a[236:239], v31 offset:18432
s_lshl_b32 s3, s3, 12
v_mfma_f32_16x16x32_bf16 v[188:191], v[100:103], a[212:215], v[188:191]
ds_read_b64_tr_b16 v[84:85], v37 offset:30752
s_add_u32 m0, s80, 143360
s_nop 0
buffer_load_dwordx4 v27, s[36:39], s76 offen offset:0 lds
s_add_u32 s96, s3, s86
v_mfma_f32_16x16x32_bf16 v[156:159], v[96:99], a[212:215], v[156:159]
ds_read_b64_tr_b16 v[86:87], v37 offset:31648
s_xor_b32 s97, s96, 2048
v_mfma_f32_16x16x32_bf16 v[168:171], v[96:99], a[216:219], v[168:171]
ds_read_b64_tr_b16 v[88:89], v37 offset:30784
s_add_u32 s98, s96, 135168
v_mfma_f32_16x16x32_bf16 v[200:203], v[100:103], a[216:219], v[200:203]
ds_read_b64_tr_b16 v[90:91], v37 offset:31680
v_mfma_f32_16x16x32_bf16 v[232:235], v[104:107], a[216:219], v[232:235]
ds_read_b64_tr_b16 v[92:93], v38 offset:30720
v_mfma_f32_16x16x32_bf16 v[236:239], v[104:107], a[220:223], v[236:239]
ds_read_b64_tr_b16 v[94:95], v38 offset:31616
v_mfma_f32_16x16x32_bf16 v[204:207], v[100:103], a[220:223], v[204:207]
v_mfma_f32_16x16x32_bf16 v[172:175], v[96:99], a[220:223], v[172:175]
buffer_load_dwordx4 v28, s[36:39], s76 offen offset:1024 lds
s_waitcnt lgkmcnt(0)
v_mfma_f32_16x16x32_bf16 v[144:147], v[80:83], a[224:227], v[144:147]
ds_read_b128 a[240:243], v30 offset:16384
s_add_u32 s99, s97, 135168
v_mfma_f32_16x16x32_bf16 v[176:179], v[84:87], a[224:227], v[176:179]
ds_read_b64_tr_b16 v[96:97], v37 offset:46080
v_lshrrev_b32_e64 v2, 3, v1
v_mfma_f32_16x16x32_bf16 v[208:211], v[88:91], a[224:227], v[208:211]
ds_read_b64_tr_b16 v[98:99], v37 offset:46976
v_and_b32_e64 v3, 7, v1
v_mfma_f32_16x16x32_bf16 v[240:243], v[92:95], a[224:227], v[240:243]
ds_read_b128 a[244:247], v30 offset:18432
v_lshrrev_b32_e64 v4, 4, v1
v_mfma_f32_16x16x32_bf16 v[244:247], v[92:95], a[228:231], v[244:247]
ds_read_b64_tr_b16 v[100:101], v37 offset:46112
v_xor_b32_e64 v3, v3, v4
v_mfma_f32_16x16x32_bf16 v[212:215], v[88:91], a[228:231], v[212:215]
ds_read_b64_tr_b16 v[102:103], v37 offset:47008
v_lshlrev_b32_e64 v3, 4, v3
v_mfma_f32_16x16x32_bf16 v[180:183], v[84:87], a[228:231], v[180:183]
ds_read_b64_tr_b16 v[104:105], v37 offset:46144
s_add_u32 m0, s80, 151552
s_add_u32 s76, s76, 196608
buffer_load_dwordx4 v27, s[36:39], s76 offen offset:0 lds
v_lshl_add_u32 v23, v2, 8, v3
v_mfma_f32_16x16x32_bf16 v[148:151], v[80:83], a[228:231], v[148:151]
ds_read_b64_tr_b16 v[106:107], v37 offset:47040
v_xor_b32_e64 v24, 64, v23
v_mfma_f32_16x16x32_bf16 v[160:163], v[80:83], a[232:235], v[160:163]
ds_read_b64_tr_b16 v[108:109], v38 offset:46080
v_lshl_or_b32 v25, v2, 24, v23
v_mfma_f32_16x16x32_bf16 v[192:195], v[84:87], a[232:235], v[192:195]
ds_read_b64_tr_b16 v[110:111], v38 offset:46976
v_mfma_f32_16x16x32_bf16 v[224:227], v[88:91], a[232:235], v[224:227]
v_mfma_f32_16x16x32_bf16 v[228:231], v[88:91], a[236:239], v[228:231]
v_mfma_f32_16x16x32_bf16 v[196:199], v[84:87], a[236:239], v[196:199]
v_mfma_f32_16x16x32_bf16 v[164:167], v[80:83], a[236:239], v[164:167]
buffer_load_dwordx4 v28, s[36:39], s76 offen offset:1024 lds
s_waitcnt lgkmcnt(0)
v_mfma_f32_16x16x32_bf16 v[152:155], v[96:99], a[224:227], v[152:155]
ds_read_b128 a[248:251], v32 offset:16384
v_add_u32 v24, 1024, v24
v_mfma_f32_16x16x32_bf16 v[184:187], v[100:103], a[224:227], v[184:187]
ds_read_b64_tr_b16 v[80:81], v37 offset:38400
v_add_u32 v25, 2048, v25
v_mfma_f32_16x16x32_bf16 v[216:219], v[104:107], a[224:227], v[216:219]
ds_read_b64_tr_b16 v[82:83], v37 offset:39296
v_and_b32 v2, 31, v1
v_mfma_f32_16x16x32_bf16 v[248:251], v[108:111], a[224:227], v[248:251]
ds_read_b128 a[252:255], v32 offset:18432
v_min_u32_e64 v2, 16, v2
v_mfma_f32_16x16x32_bf16 v[252:255], v[108:111], a[228:231], v[252:255]
ds_read_b64_tr_b16 v[84:85], v37 offset:38432
v_lshrrev_b32_e64 v3, 5, v1
v_mfma_f32_16x16x32_bf16 v[220:223], v[104:107], a[228:231], v[220:223]
ds_read_b64_tr_b16 v[86:87], v37 offset:39328
v_lshlrev_b32_e64 v3, 2, v3
v_mfma_f32_16x16x32_bf16 v[188:191], v[100:103], a[228:231], v[188:191]
ds_read_b64_tr_b16 v[88:89], v37 offset:38464
s_add_u32 m0, s80, 110592
s_add_u32 s76, s76, 196608
buffer_load_dwordx4 v27, s[36:39], s76 offen offset:0 lds
v_bfe_u32 v4, v2, 1, 3
v_mfma_f32_16x16x32_bf16 v[156:159], v[96:99], a[228:231], v[156:159]
ds_read_b64_tr_b16 v[90:91], v37 offset:39360
v_xor_b32_e64 v3, v3, v4
v_mfma_f32_16x16x32_bf16 v[168:171], v[96:99], a[232:235], v[168:171]
ds_read_b64_tr_b16 v[92:93], v38 offset:38400
v_lshlrev_b32_e64 v3, 4, v3
v_mfma_f32_16x16x32_bf16 v[200:203], v[100:103], a[232:235], v[200:203]
ds_read_b64_tr_b16 v[94:95], v38 offset:39296
v_mfma_f32_16x16x32_bf16 v[232:235], v[104:107], a[232:235], v[232:235]
v_mfma_f32_16x16x32_bf16 v[236:239], v[104:107], a[236:239], v[236:239]
v_mfma_f32_16x16x32_bf16 v[204:207], v[100:103], a[236:239], v[204:207]
v_mfma_f32_16x16x32_bf16 v[172:175], v[96:99], a[236:239], v[172:175]
buffer_load_dwordx4 v28, s[36:39], s76 offen offset:1024 lds
s_waitcnt lgkmcnt(0)
v_mfma_f32_16x16x32_bf16 v[144:147], v[80:83], a[240:243], v[144:147]
ds_read_b64_tr_b16 v[96:97], v37 offset:53760
v_lshl_add_u32 v3, v2, 7, v3
v_mfma_f32_16x16x32_bf16 v[176:179], v[84:87], a[240:243], v[176:179]
ds_read_b64_tr_b16 v[98:99], v37 offset:54656
s_lshl_b32 s3, s77, 13
v_mfma_f32_16x16x32_bf16 v[208:211], v[88:91], a[240:243], v[208:211]
ds_read_b64_tr_b16 v[100:101], v37 offset:53792
s_add_u32 s3, s3, 110592
v_mfma_f32_16x16x32_bf16 v[240:243], v[92:95], a[240:243], v[240:243]
ds_read_b64_tr_b16 v[102:103], v37 offset:54688
v_add_u32_e64 v16, s3, v3
v_mfma_f32_16x16x32_bf16 v[244:247], v[92:95], a[244:247], v[244:247]
ds_read_b64_tr_b16 v[104:105], v37 offset:53824
v_xor_b32_e64 v17, 16, v16
v_mfma_f32_16x16x32_bf16 v[212:215], v[88:91], a[244:247], v[212:215]
ds_read_b64_tr_b16 v[106:107], v37 offset:54720
v_xor_b32_e64 v18, 32, v16
v_mfma_f32_16x16x32_bf16 v[180:183], v[84:87], a[244:247], v[180:183]
ds_read_b64_tr_b16 v[108:109], v38 offset:53760
s_add_u32 m0, s80, 118784
s_add_u32 s76, s76, 196608
buffer_load_dwordx4 v27, s[36:39], s76 offen offset:0 lds
v_xor_b32_e64 v19, 48, v16
v_mfma_f32_16x16x32_bf16 v[148:151], v[80:83], a[244:247], v[148:151]
ds_read_b64_tr_b16 v[110:111], v38 offset:54656
s_lshl_b32 s3, s72, 2
v_mfma_f32_16x16x32_bf16 v[160:163], v[80:83], a[248:251], v[160:163]
s_add_u32 s3, s3, s68
v_mfma_f32_16x16x32_bf16 v[192:195], v[84:87], a[248:251], v[192:195]
s_mul_i32 s86, s3, 135168
v_mfma_f32_16x16x32_bf16 v[224:227], v[88:91], a[248:251], v[224:227]
v_mfma_f32_16x16x32_bf16 v[228:231], v[88:91], a[252:255], v[228:231]
v_mfma_f32_16x16x32_bf16 v[196:199], v[84:87], a[252:255], v[196:199]
v_mfma_f32_16x16x32_bf16 v[164:167], v[80:83], a[252:255], v[164:167]
buffer_load_dwordx4 v28, s[36:39], s76 offen offset:1024 lds
s_waitcnt vmcnt(9)
v_cmp_ne_u32 vcc, 0, v13
s_nop 1
s_and_b32 s92, vcc_lo, s87
s_cmp_eq_u32 s92, s87
s_cbranch_scc1 Lok9
s_mov_b32 s93, 0
Lsp9:
buffer_load_dword v13, v59, s[52:55], 0 offen sc1
s_waitcnt vmcnt(0)
v_cmp_ne_u32 vcc, 0, v13
s_add_u32 s93, s93, 1
s_nop 0
s_and_b32 s92, vcc_lo, s87
s_cmp_eq_u32 s92, s87
s_cbranch_scc1 Lok9
s_cmp_lt_u32 s93, 0x8000
s_cbranch_scc1 Lsp9
Lok9:
s_waitcnt lgkmcnt(0)
s_barrier
v_mfma_f32_16x16x32_bf16 v[152:155], v[96:99], a[240:243], v[152:155]
v_mfma_f32_16x16x32_bf16 v[184:187], v[100:103], a[240:243], v[184:187]
s_add_u32 m0, s80, 126976
s_add_u32 s76, s76, 196608
buffer_load_dwordx4 v27, s[36:39], s76 offen offset:0 lds
v_mfma_f32_16x16x32_bf16 v[216:219], v[104:107], a[240:243], v[216:219]
buffer_load_dwordx4 v28, s[36:39], s76 offen offset:1024 lds
v_mfma_f32_16x16x32_bf16 v[248:251], v[108:111], a[240:243], v[248:251]
s_add_u32 m0, s80, 135168
s_add_u32 s76, s76, 196608
buffer_load_dwordx4 v27, s[36:39], s76 offen offset:0 lds
v_mfma_f32_16x16x32_bf16 v[252:255], v[108:111], a[244:247], v[252:255]
buffer_load_dwordx4 v28, s[36:39], s76 offen offset:1024 lds
v_mfma_f32_16x16x32_bf16 v[220:223], v[104:107], a[244:247], v[220:223]
s_add_u32 m0, s80, 32768
s_add_u32 s76, s76, 196608
buffer_load_dwordx4 v27, s[36:39], s76 offen offset:0 lds
v_mfma_f32_16x16x32_bf16 v[188:191], v[100:103], a[244:247], v[188:191]
buffer_load_dwordx4 v28, s[36:39], s76 offen offset:1024 lds
v_mfma_f32_16x16x32_bf16 v[156:159], v[96:99], a[244:247], v[156:159]
v_mfma_f32_16x16x32_bf16 v[168:171], v[96:99], a[248:251], v[168:171]
s_add_u32 m0, s80, 40960
s_add_u32 s76, s76, 196608
buffer_load_dwordx4 v27, s[36:39], s76 offen offset:0 lds
v_mfma_f32_16x16x32_bf16 v[200:203], v[100:103], a[248:251], v[200:203]
buffer_load_dwordx4 v28, s[36:39], s76 offen offset:1024 lds
v_mfma_f32_16x16x32_bf16 v[232:235], v[104:107], a[248:251], v[232:235]
s_add_u32 m0, s78, 0
v_nop_e64
buffer_load_dwordx4 v44, s[40:43], s81 offen offset:0 lds
v_mfma_f32_16x16x32_bf16 v[236:239], v[104:107], a[252:255], v[236:239]
buffer_load_dwordx4 v45, s[40:43], s81 offen offset:1024 lds
v_mfma_f32_16x16x32_bf16 v[204:207], v[100:103], a[252:255], v[204:207]
buffer_load_dwordx4 v46, s[40:43], s81 offen offset:2048 lds
v_mfma_f32_16x16x32_bf16 v[172:175], v[96:99], a[252:255], v[172:175]
buffer_load_dwordx4 v47, s[40:43], s81 offen offset:3072 lds
v_pk_mul_f32 v[2:3], v[144:145], v[144:145]
v_pk_mul_f32 v[4:5], v[146:147], v[146:147]
v_pk_mul_f32 v[6:7], v[148:149], v[148:149]
v_pk_mul_f32 v[8:9], v[150:151], v[150:151]
v_pk_fma_f32 v[2:3], v[2:3], s[90:91], v[54:55] op_sel_hi:[1,0,0]
v_pk_fma_f32 v[4:5], v[4:5], s[90:91], v[54:55] op_sel_hi:[1,0,0]
v_pk_fma_f32 v[6:7], v[6:7], s[90:91], v[54:55] op_sel_hi:[1,0,0]
v_pk_fma_f32 v[8:9], v[8:9], s[90:91], v[54:55] op_sel_hi:[1,0,0]
v_pk_mul_f32 v[2:3], v[2:3], v[144:145]
v_pk_mul_f32 v[4:5], v[4:5], v[146:147]
v_pk_mul_f32 v[6:7], v[6:7], v[148:149]
v_pk_mul_f32 v[8:9], v[8:9], v[150:151]
v_exp_f32 v2, v2
v_exp_f32 v3, v3
v_exp_f32 v4, v4
v_exp_f32 v5, v5
v_exp_f32 v6, v6
v_exp_f32 v7, v7
v_exp_f32 v8, v8
v_exp_f32 v9, v9
v_pk_mul_f32 v[144:145], v[144:145], v[152:153]
v_pk_mul_f32 v[146:147], v[146:147], v[154:155]
v_pk_mul_f32 v[148:149], v[148:149], v[156:157]
v_pk_mul_f32 v[150:151], v[150:151], v[158:159]
v_pk_add_f32 v[2:3], v[2:3], 1.0 op_sel_hi:[1,0]
v_pk_add_f32 v[4:5], v[4:5], 1.0 op_sel_hi:[1,0]
v_pk_add_f32 v[6:7], v[6:7], 1.0 op_sel_hi:[1,0]
v_pk_add_f32 v[8:9], v[8:9], 1.0 op_sel_hi:[1,0]
v_rcp_f32 v2, v2
v_rcp_f32 v3, v3
v_rcp_f32 v4, v4
v_rcp_f32 v5, v5
v_rcp_f32 v6, v6
v_rcp_f32 v7, v7
v_rcp_f32 v8, v8
v_rcp_f32 v9, v9
s_add_u32 m0, s78, 49152
s_add_u32 s81, s81, 131072
buffer_load_dwordx4 v44, s[40:43], s81 offen offset:0 lds
v_pk_mul_f32 v[144:145], v[144:145], v[2:3] neg_lo:[1,0] neg_hi:[1,0]
v_pk_mul_f32 v[146:147], v[146:147], v[4:5] neg_lo:[1,0] neg_hi:[1,0]
v_pk_mul_f32 v[148:149], v[148:149], v[6:7] neg_lo:[1,0] neg_hi:[1,0]
v_pk_mul_f32 v[150:151], v[150:151], v[8:9] neg_lo:[1,0] neg_hi:[1,0]
v_cvt_pk_bf16_f32 v152, v144, v145
v_cvt_pk_bf16_f32 v154, v148, v149
v_cvt_pk_bf16_f32 v153, v146, v147
v_cvt_pk_bf16_f32 v155, v150, v151
v_pk_mul_f32 v[2:3], v[160:161], v[160:161]
v_pk_mul_f32 v[4:5], v[162:163], v[162:163]
v_permlane16_swap_b32 v152, v154
v_permlane16_swap_b32 v153, v155
v_pk_mul_f32 v[6:7], v[164:165], v[164:165]
v_pk_mul_f32 v[8:9], v[166:167], v[166:167]
buffer_store_dwordx4 v[152:155], v14, s[48:51], s32 offen offset:0 sc1
v_pk_fma_f32 v[2:3], v[2:3], s[90:91], v[54:55] op_sel_hi:[1,0,0]
v_pk_fma_f32 v[4:5], v[4:5], s[90:91], v[54:55] op_sel_hi:[1,0,0]
v_pk_fma_f32 v[6:7], v[6:7], s[90:91], v[54:55] op_sel_hi:[1,0,0]
v_pk_fma_f32 v[8:9], v[8:9], s[90:91], v[54:55] op_sel_hi:[1,0,0]
v_pk_mul_f32 v[2:3], v[2:3], v[160:161]
v_pk_mul_f32 v[4:5], v[4:5], v[162:163]
v_pk_mul_f32 v[6:7], v[6:7], v[164:165]
v_pk_mul_f32 v[8:9], v[8:9], v[166:167]
v_exp_f32 v2, v2
v_exp_f32 v3, v3
v_exp_f32 v4, v4
v_exp_f32 v5, v5
v_exp_f32 v6, v6
v_exp_f32 v7, v7
v_exp_f32 v8, v8
v_exp_f32 v9, v9
v_pk_mul_f32 v[160:161], v[160:161], v[168:169]
v_pk_mul_f32 v[162:163], v[162:163], v[170:171]
v_pk_mul_f32 v[164:165], v[164:165], v[172:173]
v_pk_mul_f32 v[166:167], v[166:167], v[174:175]
v_pk_add_f32 v[2:3], v[2:3], 1.0 op_sel_hi:[1,0]
buffer_load_dwordx4 v45, s[40:43], s81 offen offset:1024 lds
v_pk_add_f32 v[4:5], v[4:5], 1.0 op_sel_hi:[1,0]
v_pk_add_f32 v[6:7], v[6:7], 1.0 op_sel_hi:[1,0]
v_pk_add_f32 v[8:9], v[8:9], 1.0 op_sel_hi:[1,0]
v_rcp_f32 v2, v2
v_rcp_f32 v3, v3
v_rcp_f32 v4, v4
v_rcp_f32 v5, v5
v_rcp_f32 v6, v6
v_rcp_f32 v7, v7
v_rcp_f32 v8, v8
v_rcp_f32 v9, v9
v_pk_mul_f32 v[160:161], v[160:161], v[2:3] neg_lo:[1,0] neg_hi:[1,0]
v_pk_mul_f32 v[162:163], v[162:163], v[4:5] neg_lo:[1,0] neg_hi:[1,0]
v_pk_mul_f32 v[164:165], v[164:165], v[6:7] neg_lo:[1,0] neg_hi:[1,0]
v_pk_mul_f32 v[166:167], v[166:167], v[8:9] neg_lo:[1,0] neg_hi:[1,0]
v_cvt_pk_bf16_f32 v168, v160, v161
v_cvt_pk_bf16_f32 v170, v164, v165
v_cvt_pk_bf16_f32 v169, v162, v163
v_cvt_pk_bf16_f32 v171, v166, v167
v_pk_mul_f32 v[2:3], v[176:177], v[176:177]
v_pk_mul_f32 v[4:5], v[178:179], v[178:179]
v_permlane16_swap_b32 v168, v170
v_permlane16_swap_b32 v169, v171
v_pk_mul_f32 v[6:7], v[180:181], v[180:181]
v_pk_mul_f32 v[8:9], v[182:183], v[182:183]
buffer_store_dwordx4 v[168:171], v14, s[48:51], s33 offen offset:0 sc1
v_pk_fma_f32 v[2:3], v[2:3], s[90:91], v[54:55] op_sel_hi:[1,0,0]
v_pk_fma_f32 v[4:5], v[4:5], s[90:91], v[54:55] op_sel_hi:[1,0,0]
v_pk_fma_f32 v[6:7], v[6:7], s[90:91], v[54:55] op_sel_hi:[1,0,0]
v_pk_fma_f32 v[8:9], v[8:9], s[90:91], v[54:55] op_sel_hi:[1,0,0]
v_pk_mul_f32 v[2:3], v[2:3], v[176:177]
v_pk_mul_f32 v[4:5], v[4:5], v[178:179]
v_pk_mul_f32 v[6:7], v[6:7], v[180:181]
v_pk_mul_f32 v[8:9], v[8:9], v[182:183]
v_exp_f32 v2, v2
v_exp_f32 v3, v3
buffer_load_dwordx4 v46, s[40:43], s81 offen offset:2048 lds
v_exp_f32 v4, v4
v_exp_f32 v5, v5
v_exp_f32 v6, v6
v_exp_f32 v7, v7
v_exp_f32 v8, v8
v_exp_f32 v9, v9
v_pk_mul_f32 v[176:177], v[176:177], v[184:185]
v_pk_mul_f32 v[178:179], v[178:179], v[186:187]
v_pk_mul_f32 v[180:181], v[180:181], v[188:189]
v_pk_mul_f32 v[182:183], v[182:183], v[190:191]
v_pk_add_f32 v[2:3], v[2:3], 1.0 op_sel_hi:[1,0]
v_pk_add_f32 v[4:5], v[4:5], 1.0 op_sel_hi:[1,0]
v_pk_add_f32 v[6:7], v[6:7], 1.0 op_sel_hi:[1,0]
v_pk_add_f32 v[8:9], v[8:9], 1.0 op_sel_hi:[1,0]
v_rcp_f32 v2, v2
v_rcp_f32 v3, v3
v_rcp_f32 v4, v4
v_rcp_f32 v5, v5
v_rcp_f32 v6, v6
v_rcp_f32 v7, v7
v_rcp_f32 v8, v8
v_rcp_f32 v9, v9
v_pk_mul_f32 v[176:177], v[176:177], v[2:3] neg_lo:[1,0] neg_hi:[1,0]
v_pk_mul_f32 v[178:179], v[178:179], v[4:5] neg_lo:[1,0] neg_hi:[1,0]
v_pk_mul_f32 v[180:181], v[180:181], v[6:7] neg_lo:[1,0] neg_hi:[1,0]
v_pk_mul_f32 v[182:183], v[182:183], v[8:9] neg_lo:[1,0] neg_hi:[1,0]
v_cvt_pk_bf16_f32 v184, v176, v177
v_cvt_pk_bf16_f32 v186, v180, v181
v_cvt_pk_bf16_f32 v185, v178, v179
v_cvt_pk_bf16_f32 v187, v182, v183
v_pk_mul_f32 v[2:3], v[192:193], v[192:193]
v_pk_mul_f32 v[4:5], v[194:195], v[194:195]
v_permlane16_swap_b32 v184, v186
v_permlane16_swap_b32 v185, v187
v_pk_mul_f32 v[6:7], v[196:197], v[196:197]
v_pk_mul_f32 v[8:9], v[198:199], v[198:199]
buffer_load_dwordx4 v47, s[40:43], s81 offen offset:3072 lds
buffer_store_dwordx4 v[184:187], v14, s[48:51], s34 offen offset:0 sc1
v_pk_fma_f32 v[2:3], v[2:3], s[90:91], v[54:55] op_sel_hi:[1,0,0]
v_pk_fma_f32 v[4:5], v[4:5], s[90:91], v[54:55] op_sel_hi:[1,0,0]
v_pk_fma_f32 v[6:7], v[6:7], s[90:91], v[54:55] op_sel_hi:[1,0,0]
v_pk_fma_f32 v[8:9], v[8:9], s[90:91], v[54:55] op_sel_hi:[1,0,0]
v_pk_mul_f32 v[2:3], v[2:3], v[192:193]
v_pk_mul_f32 v[4:5], v[4:5], v[194:195]
v_pk_mul_f32 v[6:7], v[6:7], v[196:197]
v_pk_mul_f32 v[8:9], v[8:9], v[198:199]
v_exp_f32 v2, v2
v_exp_f32 v3, v3
v_exp_f32 v4, v4
v_exp_f32 v5, v5
v_exp_f32 v6, v6
v_exp_f32 v7, v7
v_exp_f32 v8, v8
v_exp_f32 v9, v9
v_pk_mul_f32 v[192:193], v[192:193], v[200:201]
v_pk_mul_f32 v[194:195], v[194:195], v[202:203]
v_pk_mul_f32 v[196:197], v[196:197], v[204:205]
v_pk_mul_f32 v[198:199], v[198:199], v[206:207]
v_pk_add_f32 v[2:3], v[2:3], 1.0 op_sel_hi:[1,0]
v_pk_add_f32 v[4:5], v[4:5], 1.0 op_sel_hi:[1,0]
v_pk_add_f32 v[6:7], v[6:7], 1.0 op_sel_hi:[1,0]
v_pk_add_f32 v[8:9], v[8:9], 1.0 op_sel_hi:[1,0]
v_rcp_f32 v2, v2
v_rcp_f32 v3, v3
v_rcp_f32 v4, v4
v_rcp_f32 v5, v5
v_rcp_f32 v6, v6
v_rcp_f32 v7, v7
v_rcp_f32 v8, v8
v_rcp_f32 v9, v9
v_pk_mul_f32 v[192:193], v[192:193], v[2:3] neg_lo:[1,0] neg_hi:[1,0]
v_pk_mul_f32 v[194:195], v[194:195], v[4:5] neg_lo:[1,0] neg_hi:[1,0]
v_pk_mul_f32 v[196:197], v[196:197], v[6:7] neg_lo:[1,0] neg_hi:[1,0]
s_add_u32 m0, s78, 16384
s_add_u32 s81, s81, 131072
buffer_load_dwordx4 v44, s[40:43], s81 offen offset:0 lds
v_pk_mul_f32 v[198:199], v[198:199], v[8:9] neg_lo:[1,0] neg_hi:[1,0]
v_cvt_pk_bf16_f32 v200, v192, v193
v_cvt_pk_bf16_f32 v202, v196, v197
v_cvt_pk_bf16_f32 v201, v194, v195
v_cvt_pk_bf16_f32 v203, v198, v199
v_pk_mul_f32 v[2:3], v[208:209], v[208:209]
v_pk_mul_f32 v[4:5], v[210:211], v[210:211]
v_permlane16_swap_b32 v200, v202
v_permlane16_swap_b32 v201, v203
v_pk_mul_f32 v[6:7], v[212:213], v[212:213]
v_pk_mul_f32 v[8:9], v[214:215], v[214:215]
buffer_store_dwordx4 v[200:203], v14, s[48:51], s35 offen offset:0 sc1
v_pk_fma_f32 v[2:3], v[2:3], s[90:91], v[54:55] op_sel_hi:[1,0,0]
v_pk_fma_f32 v[4:5], v[4:5], s[90:91], v[54:55] op_sel_hi:[1,0,0]
v_pk_fma_f32 v[6:7], v[6:7], s[90:91], v[54:55] op_sel_hi:[1,0,0]
v_pk_fma_f32 v[8:9], v[8:9], s[90:91], v[54:55] op_sel_hi:[1,0,0]
v_pk_mul_f32 v[2:3], v[2:3], v[208:209]
v_pk_mul_f32 v[4:5], v[4:5], v[210:211]
v_pk_mul_f32 v[6:7], v[6:7], v[212:213]
v_pk_mul_f32 v[8:9], v[8:9], v[214:215]
v_exp_f32 v2, v2
v_exp_f32 v3, v3
v_exp_f32 v4, v4
v_exp_f32 v5, v5
v_exp_f32 v6, v6
v_exp_f32 v7, v7
v_exp_f32 v8, v8
v_exp_f32 v9, v9
v_pk_mul_f32 v[208:209], v[208:209], v[216:217]
v_pk_mul_f32 v[210:211], v[210:211], v[218:219]
v_pk_mul_f32 v[212:213], v[212:213], v[220:221]
v_pk_mul_f32 v[214:215], v[214:215], v[222:223]
v_pk_add_f32 v[2:3], v[2:3], 1.0 op_sel_hi:[1,0]
v_pk_add_f32 v[4:5], v[4:5], 1.0 op_sel_hi:[1,0]
v_pk_add_f32 v[6:7], v[6:7], 1.0 op_sel_hi:[1,0]
v_pk_add_f32 v[8:9], v[8:9], 1.0 op_sel_hi:[1,0]
buffer_load_dwordx4 v45, s[40:43], s81 offen offset:1024 lds
v_rcp_f32 v2, v2
v_rcp_f32 v3, v3
v_rcp_f32 v4, v4
v_rcp_f32 v5, v5
v_rcp_f32 v6, v6
v_rcp_f32 v7, v7
v_rcp_f32 v8, v8
v_rcp_f32 v9, v9
v_pk_mul_f32 v[208:209], v[208:209], v[2:3] neg_lo:[1,0] neg_hi:[1,0]
v_pk_mul_f32 v[210:211], v[210:211], v[4:5] neg_lo:[1,0] neg_hi:[1,0]
v_pk_mul_f32 v[212:213], v[212:213], v[6:7] neg_lo:[1,0] neg_hi:[1,0]
v_pk_mul_f32 v[214:215], v[214:215], v[8:9] neg_lo:[1,0] neg_hi:[1,0]
v_cvt_pk_bf16_f32 v216, v208, v209
v_cvt_pk_bf16_f32 v218, v212, v213
v_cvt_pk_bf16_f32 v217, v210, v211
v_cvt_pk_bf16_f32 v219, v214, v215
v_pk_mul_f32 v[2:3], v[224:225], v[224:225]
v_pk_mul_f32 v[4:5], v[226:227], v[226:227]
v_permlane16_swap_b32 v216, v218
v_permlane16_swap_b32 v217, v219
v_pk_mul_f32 v[6:7], v[228:229], v[228:229]
v_pk_mul_f32 v[8:9], v[230:231], v[230:231]
buffer_store_dwordx4 v[216:219], v14, s[48:51], s79 offen offset:0 sc1
v_pk_fma_f32 v[2:3], v[2:3], s[90:91], v[54:55] op_sel_hi:[1,0,0]
v_pk_fma_f32 v[4:5], v[4:5], s[90:91], v[54:55] op_sel_hi:[1,0,0]
v_pk_fma_f32 v[6:7], v[6:7], s[90:91], v[54:55] op_sel_hi:[1,0,0]
v_pk_fma_f32 v[8:9], v[8:9], s[90:91], v[54:55] op_sel_hi:[1,0,0]
v_pk_mul_f32 v[2:3], v[2:3], v[224:225]
v_pk_mul_f32 v[4:5], v[4:5], v[226:227]
v_pk_mul_f32 v[6:7], v[6:7], v[228:229]
v_pk_mul_f32 v[8:9], v[8:9], v[230:231]
v_exp_f32 v2, v2
v_exp_f32 v3, v3
v_exp_f32 v4, v4
v_exp_f32 v5, v5
v_exp_f32_e64 v6, v6
buffer_load_dwordx4 v46, s[40:43], s81 offen offset:2048 lds
v_exp_f32 v7, v7
v_exp_f32 v8, v8
v_exp_f32_e64 v9, v9
v_pk_mul_f32 v[224:225], v[224:225], v[232:233]
v_pk_mul_f32 v[226:227], v[226:227], v[234:235]
v_pk_mul_f32 v[228:229], v[228:229], v[236:237]
v_pk_mul_f32 v[230:231], v[230:231], v[238:239]
v_pk_add_f32 v[2:3], v[2:3], 1.0 op_sel_hi:[1,0]
v_pk_add_f32 v[4:5], v[4:5], 1.0 op_sel_hi:[1,0]
v_pk_add_f32 v[6:7], v[6:7], 1.0 op_sel_hi:[1,0]
v_pk_add_f32 v[8:9], v[8:9], 1.0 op_sel_hi:[1,0]
v_rcp_f32 v2, v2
v_rcp_f32 v3, v3
v_rcp_f32 v4, v4
v_rcp_f32 v5, v5
v_rcp_f32 v6, v6
v_rcp_f32 v7, v7
v_rcp_f32 v8, v8
v_rcp_f32 v9, v9
v_pk_mul_f32 v[224:225], v[224:225], v[2:3] neg_lo:[1,0] neg_hi:[1,0]
v_pk_mul_f32 v[226:227], v[226:227], v[4:5] neg_lo:[1,0] neg_hi:[1,0]
v_pk_mul_f32 v[228:229], v[228:229], v[6:7] neg_lo:[1,0] neg_hi:[1,0]
v_pk_mul_f32 v[230:231], v[230:231], v[8:9] neg_lo:[1,0] neg_hi:[1,0]
v_cvt_pk_bf16_f32 v232, v224, v225
v_cvt_pk_bf16_f32 v234, v228, v229
v_cvt_pk_bf16_f32 v233, v226, v227
v_cvt_pk_bf16_f32 v235, v230, v231
v_pk_mul_f32 v[2:3], v[240:241], v[240:241]
v_pk_mul_f32 v[4:5], v[242:243], v[242:243]
v_permlane16_swap_b32 v232, v234
v_permlane16_swap_b32 v233, v235
v_pk_mul_f32 v[6:7], v[244:245], v[244:245]
v_pk_mul_f32 v[8:9], v[246:247], v[246:247]
buffer_store_dwordx4 v[232:235], v14, s[48:51], s75 offen offset:0 sc1
v_pk_fma_f32 v[2:3], v[2:3], s[90:91], v[54:55] op_sel_hi:[1,0,0]
v_pk_fma_f32 v[4:5], v[4:5], s[90:91], v[54:55] op_sel_hi:[1,0,0]
buffer_load_dwordx4 v47, s[40:43], s81 offen offset:3072 lds
v_pk_fma_f32 v[6:7], v[6:7], s[90:91], v[54:55] op_sel_hi:[1,0,0]
v_pk_fma_f32 v[8:9], v[8:9], s[90:91], v[54:55] op_sel_hi:[1,0,0]
v_pk_mul_f32 v[2:3], v[2:3], v[240:241]
v_pk_mul_f32 v[4:5], v[4:5], v[242:243]
v_pk_mul_f32 v[6:7], v[6:7], v[244:245]
v_pk_mul_f32 v[8:9], v[8:9], v[246:247]
v_exp_f32 v2, v2
v_exp_f32 v3, v3
v_exp_f32 v4, v4
v_exp_f32 v5, v5
v_exp_f32 v6, v6
v_exp_f32 v7, v7
v_exp_f32 v8, v8
v_exp_f32 v9, v9
v_pk_mul_f32 v[240:241], v[240:241], v[248:249]
v_pk_mul_f32 v[242:243], v[242:243], v[250:251]
v_pk_mul_f32 v[244:245], v[244:245], v[252:253]
v_pk_mul_f32 v[246:247], v[246:247], v[254:255]
v_pk_add_f32 v[2:3], v[2:3], 1.0 op_sel_hi:[1,0]
v_pk_add_f32 v[4:5], v[4:5], 1.0 op_sel_hi:[1,0]
v_pk_add_f32 v[6:7], v[6:7], 1.0 op_sel_hi:[1,0]
v_pk_add_f32 v[8:9], v[8:9], 1.0 op_sel_hi:[1,0]
v_rcp_f32 v2, v2
v_rcp_f32 v3, v3
v_rcp_f32 v4, v4
v_rcp_f32 v5, v5
v_rcp_f32 v6, v6
v_rcp_f32 v7, v7
v_rcp_f32 v8, v8
v_rcp_f32 v9, v9
v_pk_mul_f32 v[240:241], v[240:241], v[2:3] neg_lo:[1,0] neg_hi:[1,0]
v_pk_mul_f32 v[242:243], v[242:243], v[4:5] neg_lo:[1,0] neg_hi:[1,0]
v_pk_mul_f32 v[244:245], v[244:245], v[6:7] neg_lo:[1,0] neg_hi:[1,0]
v_pk_mul_f32 v[246:247], v[246:247], v[8:9] neg_lo:[1,0] neg_hi:[1,0]
v_cvt_pk_bf16_f32 v248, v240, v241
v_cvt_pk_bf16_f32 v250, v244, v245
v_cvt_pk_bf16_f32 v249, v242, v243
v_cvt_pk_bf16_f32 v251, v246, v247
v_permlane16_swap_b32 v248, v250
v_nop_e64
v_permlane16_swap_b32 v249, v251
buffer_store_dwordx4 v[248:251], v14, s[48:51], s74 offen offset:0 sc1
LhopB2:
s_cbranch_execz LbackB
s_waitcnt vmcnt(19)
s_barrier
ds_read_b64_tr_b16 v[80:81], v33 offset:32768
ds_read_b64_tr_b16 v[82:83], v33 offset:33280
ds_read_b64_tr_b16 v[84:85], v34 offset:32768
ds_read_b64_tr_b16 v[86:87], v34 offset:33280
s_waitcnt lgkmcnt(2)
v_mfma_f32_16x16x32_bf16 v[112:115], v[80:83], a[0:3], 0
ds_read_b64_tr_b16 v[88:89], v33 offset:36864
v_mfma_f32_16x16x32_bf16 v[116:119], v[80:83], a[4:7], 0
ds_read_b64_tr_b16 v[90:91], v33 offset:37376
v_mfma_f32_16x16x32_bf16 v[128:131], v[80:83], a[8:11], 0
v_mfma_f32_16x16x32_bf16 v[132:135], v[80:83], a[12:15], 0
s_waitcnt lgkmcnt(2)
v_mfma_f32_16x16x32_bf16 v[120:123], v[84:87], a[0:3], 0
ds_read_b64_tr_b16 v[92:93], v34 offset:36864
v_mfma_f32_16x16x32_bf16 v[124:127], v[84:87], a[4:7], 0
ds_read_b64_tr_b16 v[94:95], v34 offset:37376
v_mfma_f32_16x16x32_bf16 v[136:139], v[84:87], a[8:11], 0
v_mfma_f32_16x16x32_bf16 v[140:143], v[84:87], a[12:15], 0
s_waitcnt lgkmcnt(2)
v_mfma_f32_16x16x32_bf16 v[112:115], v[88:91], a[16:19], v[112:115]
ds_read_b64_tr_b16 v[80:81], v33 offset:40960
v_mfma_f32_16x16x32_bf16 v[116:119], v[88:91], a[20:23], v[116:119]
ds_read_b64_tr_b16 v[82:83], v33 offset:41472
v_mfma_f32_16x16x32_bf16 v[128:131], v[88:91], a[24:27], v[128:131]
v_mfma_f32_16x16x32_bf16 v[132:135], v[88:91], a[28:31], v[132:135]
s_waitcnt lgkmcnt(2)
v_mfma_f32_16x16x32_bf16 v[120:123], v[92:95], a[16:19], v[120:123]
ds_read_b64_tr_b16 v[84:85], v34 offset:40960
v_mfma_f32_16x16x32_bf16 v[124:127], v[92:95], a[20:23], v[124:127]
ds_read_b64_tr_b16 v[86:87], v34 offset:41472
v_mfma_f32_16x16x32_bf16 v[136:139], v[92:95], a[24:27], v[136:139]
v_mfma_f32_16x16x32_bf16 v[140:143], v[92:95], a[28:31], v[140:143]
s_waitcnt lgkmcnt(2)
v_mfma_f32_16x16x32_bf16 v[112:115], v[80:83], a[32:35], v[112:115]
ds_read_b64_tr_b16 v[88:89], v33 offset:45056
v_mfma_f32_16x16x32_bf16 v[116:119], v[80:83], a[36:39], v[116:119]
ds_read_b64_tr_b16 v[90:91], v33 offset:45568
v_mfma_f32_16x16x32_bf16 v[128:131], v[80:83], a[40:43], v[128:131]
v_mfma_f32_16x16x32_bf16 v[132:135], v[80:83], a[44:47], v[132:135]
s_add_u32 m0, s78, 65536
s_add_u32 s81, s81, 131072
buffer_load_dwordx4 v44, s[40:43], s81 offen offset:0 lds
s_waitcnt lgkmcnt(2)
v_mfma_f32_16x16x32_bf16 v[120:123], v[84:87], a[32:35], v[120:123]
ds_read_b64_tr_b16 v[92:93], v34 offset:45056
v_mfma_f32_16x16x32_bf16 v[124:127], v[84:87], a[36:39], v[124:127]
ds_read_b64_tr_b16 v[94:95], v34 offset:45568
v_mfma_f32_16x16x32_bf16 v[136:139], v[84:87], a[40:43], v[136:139]
v_mfma_f32_16x16x32_bf16 v[140:143], v[84:87], a[44:47], v[140:143]
buffer_load_dwordx4 v45, s[40:43], s81 offen offset:1024 lds
s_waitcnt lgkmcnt(2)
v_mfma_f32_16x16x32_bf16 v[112:115], v[88:91], a[48:51], v[112:115]
ds_read_b64_tr_b16 v[80:81], v33 offset:0
v_mfma_f32_16x16x32_bf16 v[116:119], v[88:91], a[52:55], v[116:119]
ds_read_b64_tr_b16 v[82:83], v33 offset:512
v_mfma_f32_16x16x32_bf16 v[128:131], v[88:91], a[56:59], v[128:131]
v_mfma_f32_16x16x32_bf16 v[132:135], v[88:91], a[60:63], v[132:135]
buffer_load_dwordx4 v46, s[40:43], s81 offen offset:2048 lds
s_waitcnt lgkmcnt(2)
v_mfma_f32_16x16x32_bf16 v[120:123], v[92:95], a[48:51], v[120:123]
ds_read_b64_tr_b16 v[84:85], v34 offset:0
v_mfma_f32_16x16x32_bf16 v[124:127], v[92:95], a[52:55], v[124:127]
ds_read_b64_tr_b16 v[86:87], v34 offset:512
v_mfma_f32_16x16x32_bf16 v[136:139], v[92:95], a[56:59], v[136:139]
v_mfma_f32_16x16x32_bf16 v[140:143], v[92:95], a[60:63], v[140:143]
buffer_load_dwordx4 v47, s[40:43], s81 offen offset:3072 lds
s_waitcnt lgkmcnt(2)
v_mfma_f32_16x16x32_bf16 v[112:115], v[80:83], a[64:67], v[112:115]
ds_read_b64_tr_b16 v[88:89], v33 offset:4096
s_waitcnt vmcnt(19)
ds_read_b64_tr_b16 a[0:1], v48 offset:0
v_mfma_f32_16x16x32_bf16 v[116:119], v[80:83], a[68:71], v[116:119]
ds_read_b64_tr_b16 v[90:91], v33 offset:4608
ds_read_b64_tr_b16 a[2:3], v48 offset:1024
v_mfma_f32_16x16x32_bf16 v[128:131], v[80:83], a[72:75], v[128:131]
v_mfma_f32_16x16x32_bf16 v[132:135], v[80:83], a[76:79], v[132:135]
s_add_u32 m0, s78, 81920
s_add_u32 s81, s81, 131072
buffer_load_dwordx4 v44, s[40:43], s81 offen offset:0 lds
s_waitcnt lgkmcnt(4)
v_mfma_f32_16x16x32_bf16 v[120:123], v[84:87], a[64:67], v[120:123]
ds_read_b64_tr_b16 v[92:93], v34 offset:4096
ds_read_b64_tr_b16 a[4:5], v49 offset:0
v_mfma_f32_16x16x32_bf16 v[124:127], v[84:87], a[68:71], v[124:127]
ds_read_b64_tr_b16 v[94:95], v34 offset:4608
ds_read_b64_tr_b16 a[6:7], v49 offset:1024
v_mfma_f32_16x16x32_bf16 v[136:139], v[84:87], a[72:75], v[136:139]
v_mfma_f32_16x16x32_bf16 v[140:143], v[84:87], a[76:79], v[140:143]
buffer_load_dwordx4 v45, s[40:43], s81 offen offset:1024 lds
s_waitcnt lgkmcnt(5)
v_mfma_f32_16x16x32_bf16 v[112:115], v[88:91], a[80:83], v[112:115]
ds_read_b64_tr_b16 v[80:81], v33 offset:8192
ds_read_b64_tr_b16 a[8:9], v50 offset:0
v_mfma_f32_16x16x32_bf16 v[116:119], v[88:91], a[84:87], v[116:119]
ds_read_b64_tr_b16 v[82:83], v33 offset:8704
ds_read_b64_tr_b16 a[10:11], v50 offset:1024
v_mfma_f32_16x16x32_bf16 v[128:131], v[88:91], a[88:91], v[128:131]
v_mfma_f32_16x16x32_bf16 v[132:135], v[88:91], a[92:95], v[132:135]
buffer_load_dwordx4 v46, s[40:43], s81 offen offset:2048 lds
s_waitcnt lgkmcnt(5)
v_mfma_f32_16x16x32_bf16 v[120:123], v[92:95], a[80:83], v[120:123]
ds_read_b64_tr_b16 v[84:85], v34 offset:8192
ds_read_b64_tr_b16 a[12:13], v51 offset:0
v_mfma_f32_16x16x32_bf16 v[124:127], v[92:95], a[84:87], v[124:127]
ds_read_b64_tr_b16 v[86:87], v34 offset:8704
ds_read_b64_tr_b16 a[14:15], v51 offset:1024
v_mfma_f32_16x16x32_bf16 v[136:139], v[92:95], a[88:91], v[136:139]
v_mfma_f32_16x16x32_bf16 v[140:143], v[92:95], a[92:95], v[140:143]
buffer_load_dwordx4 v47, s[40:43], s81 offen offset:3072 lds
s_waitcnt lgkmcnt(5)
v_mfma_f32_16x16x32_bf16 v[112:115], v[80:83], a[96:99], v[112:115]
ds_read_b64_tr_b16 v[88:89], v33 offset:12288
s_waitcnt vmcnt(17)
ds_read_b64_tr_b16 a[16:17], v48 offset:49152
v_mfma_f32_16x16x32_bf16 v[116:119], v[80:83], a[100:103], v[116:119]
ds_read_b64_tr_b16 v[90:91], v33 offset:12800
ds_read_b64_tr_b16 a[18:19], v48 offset:50176
v_mfma_f32_16x16x32_bf16 v[128:131], v[80:83], a[104:107], v[128:131]
v_mfma_f32_16x16x32_bf16 v[132:135], v[80:83], a[108:111], v[132:135]
s_waitcnt lgkmcnt(4)
s_add_u32 m0, s78, 0
s_add_u32 s81, s81, 131072
buffer_load_dwordx4 v44, s[40:43], s81 offen offset:0 lds
v_mfma_f32_16x16x32_bf16 v[120:123], v[84:87], a[96:99], v[120:123]
ds_read_b64_tr_b16 v[92:93], v34 offset:12288
ds_read_b64_tr_b16 a[20:21], v49 offset:49152
v_mfma_f32_16x16x32_bf16 v[124:127], v[84:87], a[100:103], v[124:127]
ds_read_b64_tr_b16 v[94:95], v34 offset:12800
ds_read_b64_tr_b16 a[22:23], v49 offset:50176
v_mfma_f32_16x16x32_bf16 v[136:139], v[84:87], a[104:107], v[136:139]
v_mfma_f32_16x16x32_bf16 v[140:143], v[84:87], a[108:111], v[140:143]
buffer_load_dwordx4 v45, s[40:43], s81 offen offset:1024 lds
s_waitcnt lgkmcnt(5)
v_mfma_f32_16x16x32_bf16 v[112:115], v[88:91], a[112:115], v[112:115]
ds_read_b64_tr_b16 v[80:81], v33 offset:16384
ds_read_b64_tr_b16 a[24:25], v50 offset:49152
v_mfma_f32_16x16x32_bf16 v[116:119], v[88:91], a[116:119], v[116:119]
ds_read_b64_tr_b16 v[82:83], v33 offset:16896
ds_read_b64_tr_b16 a[26:27], v50 offset:50176
v_mfma_f32_16x16x32_bf16 v[128:131], v[88:91], a[120:123], v[128:131]
v_mfma_f32_16x16x32_bf16 v[132:135], v[88:91], a[124:127], v[132:135]
buffer_load_dwordx4 v46, s[40:43], s81 offen offset:2048 lds
s_waitcnt lgkmcnt(5)
v_mfma_f32_16x16x32_bf16 v[120:123], v[92:95], a[112:115], v[120:123]
ds_read_b64_tr_b16 v[84:85], v34 offset:16384
ds_read_b64_tr_b16 a[28:29], v51 offset:49152
v_mfma_f32_16x16x32_bf16 v[124:127], v[92:95], a[116:119], v[124:127]
ds_read_b64_tr_b16 v[86:87], v34 offset:16896
ds_read_b64_tr_b16 a[30:31], v51 offset:50176
v_mfma_f32_16x16x32_bf16 v[136:139], v[92:95], a[120:123], v[136:139]
v_mfma_f32_16x16x32_bf16 v[140:143], v[92:95], a[124:127], v[140:143]
buffer_load_dwordx4 v47, s[40:43], s81 offen offset:3072 lds
s_waitcnt vmcnt(12)
s_barrier
s_cmp_lg_u32 s68, 0
s_cbranch_scc1 Lfl10
s_atomic_add s85, s[48:49], s60
Lfl10:
s_waitcnt lgkmcnt(5)
v_mfma_f32_16x16x32_bf16 v[112:115], v[80:83], a[128:131], v[112:115]
ds_read_b64_tr_b16 v[88:89], v33 offset:20480
ds_read_b64_tr_b16 a[32:33], v48 offset:16384
v_mfma_f32_16x16x32_bf16 v[116:119], v[80:83], a[132:135], v[116:119]
ds_read_b64_tr_b16 v[90:91], v33 offset:20992
ds_read_b64_tr_b16 a[34:35], v48 offset:17408
v_mfma_f32_16x16x32_bf16 v[128:131], v[80:83], a[136:139], v[128:131]
v_mfma_f32_16x16x32_bf16 v[132:135], v[80:83], a[140:143], v[132:135]
s_waitcnt lgkmcnt(4)
s_add_u32 m0, s78, 49152
s_add_u32 s81, s81, 131072
buffer_load_dwordx4 v44, s[40:43], s81 offen offset:0 lds
v_mfma_f32_16x16x32_bf16 v[120:123], v[84:87], a[128:131], v[120:123]
ds_read_b64_tr_b16 v[92:93], v34 offset:20480
ds_read_b64_tr_b16 a[36:37], v49 offset:16384
v_mfma_f32_16x16x32_bf16 v[124:127], v[84:87], a[132:135], v[124:127]
ds_read_b64_tr_b16 v[94:95], v34 offset:20992
ds_read_b64_tr_b16 a[38:39], v49 offset:17408
v_mfma_f32_16x16x32_bf16 v[136:139], v[84:87], a[136:139], v[136:139]
v_mfma_f32_16x16x32_bf16 v[140:143], v[84:87], a[140:143], v[140:143]
buffer_load_dwordx4 v45, s[40:43], s81 offen offset:1024 lds
s_waitcnt lgkmcnt(5)
v_mfma_f32_16x16x32_bf16 v[112:115], v[88:91], a[144:147], v[112:115]
ds_read_b64_tr_b16 v[80:81], v33 offset:24576
ds_read_b64_tr_b16 a[40:41], v50 offset:16384
v_mfma_f32_16x16x32_bf16 v[116:119], v[88:91], a[148:151], v[116:119]
ds_read_b64_tr_b16 v[82:83], v33 offset:25088
ds_read_b64_tr_b16 a[42:43], v50 offset:17408
v_mfma_f32_16x16x32_bf16 v[128:131], v[88:91], a[152:155], v[128:131]
v_mfma_f32_16x16x32_bf16 v[132:135], v[88:91], a[156:159], v[132:135]
buffer_load_dwordx4 v46, s[40:43], s81 offen offset:2048 lds
s_waitcnt lgkmcnt(5)
v_mfma_f32_16x16x32_bf16 v[120:123], v[92:95], a[144:147], v[120:123]
ds_read_b64_tr_b16 v[84:85], v34 offset:24576
ds_read_b64_tr_b16 a[44:45], v51 offset:16384
v_mfma_f32_16x16x32_bf16 v[124:127], v[92:95], a[148:151], v[124:127]
ds_read_b64_tr_b16 v[86:87], v34 offset:25088
ds_read_b64_tr_b16 a[46:47], v51 offset:17408
v_mfma_f32_16x16x32_bf16 v[136:139], v[92:95], a[152:155], v[136:139]
v_mfma_f32_16x16x32_bf16 v[140:143], v[92:95], a[156:159], v[140:143]
buffer_load_dwordx4 v47, s[40:43], s81 offen offset:3072 lds
s_waitcnt lgkmcnt(5)
v_mfma_f32_16x16x32_bf16 v[112:115], v[80:83], a[160:163], v[112:115]
ds_read_b64_tr_b16 v[88:89], v33 offset:28672
s_waitcnt vmcnt(12)
v_add_u32 v48, 65536, v48
ds_read_b64_tr_b16 a[48:49], v48 offset:0
v_mfma_f32_16x16x32_bf16 v[116:119], v[80:83], a[164:167], v[116:119]
ds_read_b64_tr_b16 v[90:91], v33 offset:29184
ds_read_b64_tr_b16 a[50:51], v48 offset:1024
v_mfma_f32_16x16x32_bf16 v[128:131], v[80:83], a[168:171], v[128:131]
v_mfma_f32_16x16x32_bf16 v[132:135], v[80:83], a[172:175], v[132:135]
s_waitcnt lgkmcnt(4)
s_add_u32 m0, s78, 16384
s_add_u32 s81, s81, 131072
buffer_load_dwordx4 v44, s[40:43], s81 offen offset:0 lds
v_mfma_f32_16x16x32_bf16 v[120:123], v[84:87], a[160:163], v[120:123]
ds_read_b64_tr_b16 v[92:93], v34 offset:28672
v_add_u32 v49, 65536, v49
ds_read_b64_tr_b16 a[52:53], v49 offset:0
v_mfma_f32_16x16x32_bf16 v[124:127], v[84:87], a[164:167], v[124:127]
ds_read_b64_tr_b16 v[94:95], v34 offset:29184
ds_read_b64_tr_b16 a[54:55], v49 offset:1024
v_mfma_f32_16x16x32_bf16 v[136:139], v[84:87], a[168:171], v[136:139]
v_mfma_f32_16x16x32_bf16 v[140:143], v[84:87], a[172:175], v[140:143]
buffer_load_dwordx4 v45, s[40:43], s81 offen offset:1024 lds
s_waitcnt lgkmcnt(5)
v_mfma_f32_16x16x32_bf16 v[112:115], v[88:91], a[176:179], v[112:115]
ds_read_b64_tr_b16 v[80:81], v35 offset:0
v_add_u32 v50, 65536, v50
ds_read_b64_tr_b16 a[56:57], v50 offset:0
v_mfma_f32_16x16x32_bf16 v[116:119], v[88:91], a[180:183], v[116:119]
ds_read_b64_tr_b16 v[82:83], v35 offset:512
ds_read_b64_tr_b16 a[58:59], v50 offset:1024
v_mfma_f32_16x16x32_bf16 v[128:131], v[88:91], a[184:187], v[128:131]
v_mfma_f32_16x16x32_bf16 v[132:135], v[88:91], a[188:191], v[132:135]
buffer_load_dwordx4 v46, s[40:43], s81 offen offset:2048 lds
s_waitcnt lgkmcnt(5)
v_mfma_f32_16x16x32_bf16 v[120:123], v[92:95], a[176:179], v[120:123]
ds_read_b64_tr_b16 v[84:85], v36 offset:0
v_add_u32 v51, 65536, v51
ds_read_b64_tr_b16 a[60:61], v51 offset:0
v_mfma_f32_16x16x32_bf16 v[124:127], v[92:95], a[180:183], v[124:127]
ds_read_b64_tr_b16 v[86:87], v36 offset:512
ds_read_b64_tr_b16 a[62:63], v51 offset:1024
v_mfma_f32_16x16x32_bf16 v[136:139], v[92:95], a[184:187], v[136:139]
v_mfma_f32_16x16x32_bf16 v[140:143], v[92:95], a[188:191], v[140:143]
buffer_load_dwordx4 v47, s[40:43], s81 offen offset:3072 lds
s_waitcnt lgkmcnt(5)
v_mfma_f32_16x16x32_bf16 v[112:115], v[80:83], a[192:195], v[112:115]
ds_read_b64_tr_b16 v[88:89], v35 offset:4096
s_waitcnt vmcnt(12)
ds_read_b64_tr_b16 a[64:65], v48 offset:16384
v_mfma_f32_16x16x32_bf16 v[116:119], v[80:83], a[196:199], v[116:119]
ds_read_b64_tr_b16 v[90:91], v35 offset:4608
ds_read_b64_tr_b16 a[66:67], v48 offset:17408
v_mfma_f32_16x16x32_bf16 v[128:131], v[80:83], a[200:203], v[128:131]
v_mfma_f32_16x16x32_bf16 v[132:135], v[80:83], a[204:207], v[132:135]
s_waitcnt lgkmcnt(5)
v_mfma_f32_16x16x32_bf16 v[120:123], v[84:87], a[192:195], v[120:123]
ds_read_b64_tr_b16 v[92:93], v36 offset:4096
ds_read_b64_tr_b16 a[68:69], v49 offset:16384
v_mfma_f32_16x16x32_bf16 v[124:127], v[84:87], a[196:199], v[124:127]
ds_read_b64_tr_b16 v[94:95], v36 offset:4608
ds_read_b64_tr_b16 a[70:71], v49 offset:17408
v_mfma_f32_16x16x32_bf16 v[136:139], v[84:87], a[200:203], v[136:139]
v_mfma_f32_16x16x32_bf16 v[140:143], v[84:87], a[204:207], v[140:143]
s_waitcnt lgkmcnt(5)
v_mfma_f32_16x16x32_bf16 v[112:115], v[88:91], a[208:211], v[112:115]
ds_read_b64_tr_b16 v[80:81], v35 offset:8192
ds_read_b64_tr_b16 a[72:73], v50 offset:16384
v_mfma_f32_16x16x32_bf16 v[116:119], v[88:91], a[212:215], v[116:119]
ds_read_b64_tr_b16 v[82:83], v35 offset:8704
ds_read_b64_tr_b16 a[74:75], v50 offset:17408
v_mfma_f32_16x16x32_bf16 v[128:131], v[88:91], a[216:219], v[128:131]
v_mfma_f32_16x16x32_bf16 v[132:135], v[88:91], a[220:223], v[132:135]
s_waitcnt lgkmcnt(5)
v_mfma_f32_16x16x32_bf16 v[120:123], v[92:95], a[208:211], v[120:123]
ds_read_b64_tr_b16 v[84:85], v36 offset:8192
ds_read_b64_tr_b16 a[76:77], v51 offset:16384
v_mfma_f32_16x16x32_bf16 v[124:127], v[92:95], a[212:215], v[124:127]
ds_read_b64_tr_b16 v[86:87], v36 offset:8704
ds_read_b64_tr_b16 a[78:79], v51 offset:17408
v_mfma_f32_16x16x32_bf16 v[136:139], v[92:95], a[216:219], v[136:139]
v_mfma_f32_16x16x32_bf16 v[140:143], v[92:95], a[220:223], v[140:143]
s_waitcnt lgkmcnt(5)
v_mfma_f32_16x16x32_bf16 v[112:115], v[80:83], a[224:227], v[112:115]
ds_read_b64_tr_b16 v[88:89], v35 offset:12288
s_waitcnt vmcnt(8)
v_subrev_u32 v48, 65536, v48
ds_read_b64_tr_b16 a[80:81], v48 offset:0
v_mfma_f32_16x16x32_bf16 v[116:119], v[80:83], a[228:231], v[116:119]
ds_read_b64_tr_b16 v[90:91], v35 offset:12800
s_cmp_lg_u32 s68, 0
s_cbranch_scc1 Lpi11
s_mov_b32 s84, 0
s_atomic_add s84, s[48:49], s62 glc
Lpi11:
ds_read_b64_tr_b16 a[82:83], v48 offset:1024
v_mfma_f32_16x16x32_bf16 v[128:131], v[80:83], a[232:235], v[128:131]
v_mfma_f32_16x16x32_bf16 v[132:135], v[80:83], a[236:239], v[132:135]
s_add_u32 m0, s78, 65536
s_add_u32 s81, s81, 131072
buffer_load_dwordx4 v44, s[40:43], s81 offen offset:0 lds
s_waitcnt lgkmcnt(5)
v_mfma_f32_16x16x32_bf16 v[120:123], v[84:87], a[224:227], v[120:123]
ds_read_b64_tr_b16 v[92:93], v36 offset:12288
v_subrev_u32 v49, 65536, v49
ds_read_b64_tr_b16 a[84:85], v49 offset:0
v_mfma_f32_16x16x32_bf16 v[124:127], v[84:87], a[228:231], v[124:127]
ds_read_b64_tr_b16 v[94:95], v36 offset:12800
ds_read_b64_tr_b16 a[86:87], v49 offset:1024
v_mfma_f32_16x16x32_bf16 v[136:139], v[84:87], a[232:235], v[136:139]
v_mfma_f32_16x16x32_bf16 v[140:143], v[84:87], a[236:239], v[140:143]
buffer_load_dwordx4 v45, s[40:43], s81 offen offset:1024 lds
s_waitcnt lgkmcnt(5)
v_mfma_f32_16x16x32_bf16 v[112:115], v[88:91], a[240:243], v[112:115]
v_subrev_u32 v50, 65536, v50
ds_read_b64_tr_b16 a[88:89], v50 offset:0
v_mfma_f32_16x16x32_bf16 v[116:119], v[88:91], a[244:247], v[116:119]
ds_read_b64_tr_b16 a[90:91], v50 offset:1024
v_mfma_f32_16x16x32_bf16 v[128:131], v[88:91], a[248:251], v[128:131]
v_mfma_f32_16x16x32_bf16 v[132:135], v[88:91], a[252:255], v[132:135]
s_cmp_ge_u32 s68, 2
s_cselect_b32 s0, 0x40000000, s81
buffer_load_dwordx4 v46, s[40:43], s0 offen offset:2048 lds
s_waitcnt lgkmcnt(3)
v_mfma_f32_16x16x32_bf16 v[120:123], v[92:95], a[240:243], v[120:123]
v_subrev_u32 v51, 65536, v51
ds_read_b64_tr_b16 a[92:93], v51 offset:0
v_mfma_f32_16x16x32_bf16 v[124:127], v[92:95], a[244:247], v[124:127]
ds_read_b64_tr_b16 a[94:95], v51 offset:1024
v_mfma_f32_16x16x32_bf16 v[136:139], v[92:95], a[248:251], v[136:139]
v_mfma_f32_16x16x32_bf16 v[140:143], v[92:95], a[252:255], v[140:143]
buffer_load_dwordx4 v47, s[40:43], s0 offen offset:3072 lds
v_and_b32 v31, 7, v1
v_lshlrev_b32 v31, 4, v31
v_bfe_u32 v29, v1, 3, 1
v_lshl_add_u32 v31, v29, 8, v31
v_bfe_u32 v29, v1, 4, 1
v_lshl_add_u32 v31, v29, 10, v31
v_lshrrev_b32_e64 v29, 5, v1
v_lshl_add_u32 v31, v29, 12, v31
s_add_u32 m0, s78, 81920
s_add_u32 s81, s81, 98304
buffer_load_dwordx4 v44, s[40:43], s81 offen offset:0 lds
s_lshr_b32 s3, s68, 1
v_and_b32 v29, s3, v29
v_lshl_or_b32 v29, v29, 30, v31
v_and_b32 v30, 15, v1
v_lshlrev_b32 v30, 2, v30
v_cvt_pk_bf16_f32 v96, v112, v113
v_cvt_pk_bf16_f32 v97, v114, v115
v_cvt_pk_bf16_f32 v98, v116, v117
buffer_load_dwordx4 v45, s[40:43], s81 offen offset:1024 lds
v_cvt_pk_bf16_f32 v99, v118, v119
v_cvt_pk_bf16_f32 v100, v128, v129
v_cvt_pk_bf16_f32 v101, v130, v131
v_cvt_pk_bf16_f32 v102, v132, v133
v_cvt_pk_bf16_f32 v103, v134, v135
v_cvt_pk_bf16_f32 v104, v120, v121
v_cvt_pk_bf16_f32 v105, v122, v123
v_cvt_pk_bf16_f32 v106, v124, v125
buffer_load_dwordx4 v46, s[40:43], s81 offen offset:2048 lds
v_cvt_pk_bf16_f32 v107, v126, v127
v_cvt_pk_bf16_f32 v108, v136, v137
v_cvt_pk_bf16_f32 v109, v138, v139
v_cvt_pk_bf16_f32 v110, v140, v141
v_cvt_pk_bf16_f32 v111, v142, v143
v_permlane16_swap_b32 v96, v98
v_permlane16_swap_b32 v97, v99
v_permlane16_swap_b32 v100, v102
buffer_load_dwordx4 v47, s[40:43], s81 offen offset:3072 lds
v_permlane16_swap_b32 v101, v103
v_mfma_f32_32x32x16_bf16 v[144:159], v[60:63], v[96:99], 0
v_permlane16_swap_b32 v104, v106
v_permlane16_swap_b32 v105, v107
v_mfma_f32_32x32x16_bf16 v[160:175], v[60:63], v[100:103], 0
v_permlane16_swap_b32 v108, v110
v_permlane16_swap_b32 v109, v111
v_mfma_f32_32x32x16_bf16 v[176:191], v[64:67], v[104:107], 0
v_nop_e64
v_mfma_f32_32x32x16_bf16 v[192:207], v[64:67], v[108:111], 0
s_waitcnt lgkmcnt(0)
s_cmp_lg_u32 s68, 0
s_cbranch_scc1 Lok12
s_cmp_ge_u32 s84, 16
s_cbranch_scc1 Lok12
s_mov_b32 s93, 0
Lsp12:
s_mov_b32 s84, 0
s_atomic_add s84, s[48:49], s62 glc
s_add_u32 s93, s93, 1
s_waitcnt lgkmcnt(0)
s_cmp_ge_u32 s84, 16
s_cbranch_scc1 Lok12
s_cmp_lt_u32 s93, 0x8000
s_cbranch_scc1 Lsp12
Lok12:
s_add_u32 m0, s78, 110592
s_barrier
s_nop 0
buffer_load_dwordx4 v23, s[48:51], s82 offen offset:0 sc1 lds
buffer_load_dwordx4 v24, s[48:51], s82 offen offset:1024 sc1 lds
buffer_load_dwordx4 v25, s[48:51], s82 offen offset:2048 sc1 lds
v_max3_f32 v2, v144, v145, v146
v_max3_f32 v3, v147, v148, v149
v_max3_f32 v4, v150, v151, v152
v_max3_f32 v5, v153, v154, v155
v_max3_f32 v6, v156, v157, v158
v_max3_f32 v2, v2, v3, v159
v_max3_f32 v4, v4, v5, v6
v_max_f32 v2, v2, v4
s_cmp_lg_u32 s68, 0
s_cbranch_scc1 Lpi13
s_mov_b32 s84, 0
s_atomic_add s84, s[48:49], s63 glc
Lpi13:
v_mul_f32 v2, 0xbfb8aa3b, v2
v_pk_fma_f32 v[144:145], v[144:145], s[88:89], v[2:3] op_sel_hi:[1,0,0]
v_pk_fma_f32 v[146:147], v[146:147], s[88:89], v[2:3] op_sel_hi:[1,0,0]
v_pk_fma_f32 v[148:149], v[148:149], s[88:89], v[2:3] op_sel_hi:[1,0,0]
v_pk_fma_f32 v[150:151], v[150:151], s[88:89], v[2:3] op_sel_hi:[1,0,0]
v_pk_fma_f32 v[152:153], v[152:153], s[88:89], v[2:3] op_sel_hi:[1,0,0]
v_pk_fma_f32 v[154:155], v[154:155], s[88:89], v[2:3] op_sel_hi:[1,0,0]
v_pk_fma_f32 v[156:157], v[156:157], s[88:89], v[2:3] op_sel_hi:[1,0,0]
s_add_u32 m0, s78, 0
s_add_u32 s81, s81, 131072
buffer_load_dwordx4 v44, s[40:43], s81 offen offset:0 lds
v_pk_fma_f32 v[158:159], v[158:159], s[88:89], v[2:3] op_sel_hi:[1,0,0]
v_exp_f32 v144, v144
v_exp_f32 v145, v145
v_exp_f32 v146, v146
v_exp_f32 v147, v147
v_exp_f32 v148, v148
v_exp_f32 v149, v149
v_exp_f32 v150, v150
buffer_load_dwordx4 v45, s[40:43], s81 offen offset:1024 lds
v_exp_f32 v151, v151
v_exp_f32 v152, v152
v_exp_f32 v153, v153
v_exp_f32 v154, v154
v_exp_f32 v155, v155
v_exp_f32 v156, v156
v_exp_f32 v157, v157
v_exp_f32 v158, v158
buffer_load_dwordx4 v46, s[40:43], s81 offen offset:2048 lds
v_exp_f32_e64 v159, v159
v_pk_add_f32 v[2:3], v[144:145], v[146:147]
v_pk_add_f32 v[4:5], v[148:149], v[150:151]
v_pk_add_f32 v[6:7], v[152:153], v[154:155]
v_pk_add_f32 v[8:9], v[156:157], v[158:159]
v_pk_add_f32 v[2:3], v[2:3], v[4:5]
v_pk_add_f32 v[6:7], v[6:7], v[8:9]
v_pk_add_f32 v[2:3], v[2:3], v[6:7]
buffer_load_dwordx4 v47, s[40:43], s81 offen offset:3072 lds
v_add_f32 v2, v2, v3
v_rcp_f32 v2, v2
v_nop_e64
v_pk_mul_f32 v[144:145], v[144:145], v[2:3] op_sel_hi:[1,0]
v_pk_mul_f32 v[146:147], v[146:147], v[2:3] op_sel_hi:[1,0]
v_pk_mul_f32 v[148:149], v[148:149], v[2:3] op_sel_hi:[1,0]
v_pk_mul_f32 v[150:151], v[150:151], v[2:3] op_sel_hi:[1,0]
v_pk_mul_f32 v[152:153], v[152:153], v[2:3] op_sel_hi:[1,0]
v_pk_mul_f32 v[154:155], v[154:155], v[2:3] op_sel_hi:[1,0]
s_waitcnt vmcnt(19)
s_nop 0
ds_read_b64_tr_b16 a[96:97], v48 offset:49152
v_pk_mul_f32 v[156:157], v[156:157], v[2:3] op_sel_hi:[1,0]
v_pk_mul_f32 v[158:159], v[158:159], v[2:3] op_sel_hi:[1,0]
v_cvt_pk_bf16_f32 v224, v144, v145
v_cvt_pk_bf16_f32 v225, v146, v147
v_cvt_pk_bf16_f32 v226, v148, v149
v_cvt_pk_bf16_f32 v227, v150, v151
v_cvt_pk_bf16_f32 v228, v152, v153
v_cvt_pk_bf16_f32 v229, v154, v155
ds_read_b64_tr_b16 a[98:99], v48 offset:50176
v_cvt_pk_bf16_f32 v230, v156, v157
v_cvt_pk_bf16_f32 v231, v158, v159
v_max3_f32 v2, v160, v161, v162
v_max3_f32 v3, v163, v164, v165
v_max3_f32 v4, v166, v167, v168
v_max3_f32 v5, v169, v170, v171
v_max3_f32 v6, v172, v173, v174
v_max3_f32 v2, v2, v3, v175
ds_read_b64_tr_b16 a[100:101], v49 offset:49152
v_max3_f32 v4, v4, v5, v6
v_max_f32_e64 v2, v2, v4
v_mul_f32 v2, 0xbfb8aa3b, v2
v_pk_fma_f32 v[160:161], v[160:161], s[88:89], v[2:3] op_sel_hi:[1,0,0]
v_pk_fma_f32 v[162:163], v[162:163], s[88:89], v[2:3] op_sel_hi:[1,0,0]
v_pk_fma_f32 v[164:165], v[164:165], s[88:89], v[2:3] op_sel_hi:[1,0,0]
v_pk_fma_f32 v[166:167], v[166:167], s[88:89], v[2:3] op_sel_hi:[1,0,0]
v_pk_fma_f32 v[168:169], v[168:169], s[88:89], v[2:3] op_sel_hi:[1,0,0]
ds_read_b64_tr_b16 a[102:103], v49 offset:50176
v_pk_fma_f32 v[170:171], v[170:171], s[88:89], v[2:3] op_sel_hi:[1,0,0]
v_pk_fma_f32 v[172:173], v[172:173], s[88:89], v[2:3] op_sel_hi:[1,0,0]
v_pk_fma_f32 v[174:175], v[174:175], s[88:89], v[2:3] op_sel_hi:[1,0,0]
v_exp_f32 v160, v160
v_exp_f32 v161, v161
v_exp_f32 v162, v162
v_exp_f32 v163, v163
v_exp_f32_e64 v164, v164
ds_read_b64_tr_b16 a[104:105], v50 offset:49152
v_exp_f32 v165, v165
v_exp_f32 v166, v166
v_exp_f32 v167, v167
v_exp_f32 v168, v168
v_exp_f32 v169, v169
v_exp_f32 v170, v170
v_exp_f32 v171, v171
v_exp_f32 v172, v172
ds_read_b64_tr_b16 a[106:107], v50 offset:50176
v_exp_f32 v173, v173
v_exp_f32 v174, v174
v_exp_f32_e64 v175, v175
v_pk_add_f32 v[2:3], v[160:161], v[162:163]
v_pk_add_f32 v[4:5], v[164:165], v[166:167]
v_pk_add_f32 v[6:7], v[168:169], v[170:171]
v_pk_add_f32 v[8:9], v[172:173], v[174:175]
v_pk_add_f32 v[2:3], v[2:3], v[4:5]
ds_read_b64_tr_b16 a[108:109], v51 offset:49152
v_pk_add_f32 v[6:7], v[6:7], v[8:9]
v_pk_add_f32 v[2:3], v[2:3], v[6:7]
v_add_f32 v2, v2, v3
v_rcp_f32 v2, v2
v_nop_e64
v_pk_mul_f32 v[160:161], v[160:161], v[2:3] op_sel_hi:[1,0]
v_pk_mul_f32 v[162:163], v[162:163], v[2:3] op_sel_hi:[1,0]
v_pk_mul_f32 v[164:165], v[164:165], v[2:3] op_sel_hi:[1,0]
v_pk_mul_f32 v[166:167], v[166:167], v[2:3] op_sel_hi:[1,0]
ds_read_b64_tr_b16 a[110:111], v51 offset:50176
v_pk_mul_f32 v[168:169], v[168:169], v[2:3] op_sel_hi:[1,0]
v_pk_mul_f32 v[170:171], v[170:171], v[2:3] op_sel_hi:[1,0]
v_pk_mul_f32 v[172:173], v[172:173], v[2:3] op_sel_hi:[1,0]
v_pk_mul_f32 v[174:175], v[174:175], v[2:3] op_sel_hi:[1,0]
v_cvt_pk_bf16_f32 v232, v160, v161
v_cvt_pk_bf16_f32 v233, v162, v163
v_cvt_pk_bf16_f32 v234, v164, v165
v_cvt_pk_bf16_f32 v235, v166, v167
v_cvt_pk_bf16_f32 v236, v168, v169
v_cvt_pk_bf16_f32 v237, v170, v171
v_cvt_pk_bf16_f32 v238, v172, v173
v_cvt_pk_bf16_f32 v239, v174, v175
s_waitcnt lgkmcnt(0)
s_cmp_lg_u32 s68, 0
s_cbranch_scc1 Lok14
s_cmp_ge_u32 s84, 8
s_cbranch_scc1 Lok14
s_mov_b32 s93, 0
Lsp14:
s_mov_b32 s84, 0
s_atomic_add s84, s[48:49], s63 glc
s_add_u32 s93, s93, 1
s_waitcnt lgkmcnt(0)
s_cmp_ge_u32 s84, 8
s_cbranch_scc1 Lok14
s_cmp_lt_u32 s93, 0x8000
s_cbranch_scc1 Lsp14
Lok14:
s_waitcnt vmcnt(4)
s_barrier
ds_read_b128 v[112:115], v16 offset:0
ds_read_b128 v[116:119], v17 offset:0
ds_read_b128 v[120:123], v18 offset:0
ds_read_b128 v[124:127], v19 offset:0
ds_read_b128 v[128:131], v16 offset:4096
ds_read_b128 v[132:135], v17 offset:4096
ds_read_b128 v[136:139], v18 offset:4096
ds_read_b128 v[140:143], v19 offset:4096
v_max3_f32 v2, v176, v177, v178
v_max3_f32 v3, v179, v180, v181
v_max3_f32 v4, v182, v183, v184
v_max3_f32 v5, v185, v186, v187
v_max3_f32 v6, v188, v189, v190
buffer_load_dwordx4 v[56:59], v31, s[48:51], s86 offen offset:0 sc1
v_max3_f32 v2, v2, v3, v191
v_max3_f32 v4, v4, v5, v6
v_max_f32_e64 v2, v2, v4
v_mul_f32 v2, 0xbfb8aa3b, v2
v_pk_fma_f32 v[176:177], v[176:177], s[88:89], v[2:3] op_sel_hi:[1,0,0]
v_pk_fma_f32 v[178:179], v[178:179], s[88:89], v[2:3] op_sel_hi:[1,0,0]
v_pk_fma_f32 v[180:181], v[180:181], s[88:89], v[2:3] op_sel_hi:[1,0,0]
LhopB3:
s_cbranch_execz LbackB
v_pk_fma_f32 v[182:183], v[182:183], s[88:89], v[2:3] op_sel_hi:[1,0,0]
v_pk_fma_f32 v[184:185], v[184:185], s[88:89], v[2:3] op_sel_hi:[1,0,0]
v_pk_fma_f32 v[186:187], v[186:187], s[88:89], v[2:3] op_sel_hi:[1,0,0]
v_pk_fma_f32 v[188:189], v[188:189], s[88:89], v[2:3] op_sel_hi:[1,0,0]
v_pk_fma_f32 v[190:191], v[190:191], s[88:89], v[2:3] op_sel_hi:[1,0,0]
s_waitcnt lgkmcnt(7)
v_cvt_pk_bf16_f32 v208, v112, v113
buffer_load_dwordx4 v[60:63], v31, s[48:51], s86 offen offset:512 sc1
v_cvt_pk_bf16_f32 v209, v114, v115
s_waitcnt lgkmcnt(6)
v_cvt_pk_bf16_f32 v210, v116, v117
v_cvt_pk_bf16_f32 v211, v118, v119
s_waitcnt lgkmcnt(5)
v_cvt_pk_bf16_f32 v212, v120, v121
v_cvt_pk_bf16_f32 v213, v122, v123
s_waitcnt lgkmcnt(4)
v_cvt_pk_bf16_f32 v214, v124, v125
v_cvt_pk_bf16_f32 v215, v126, v127
s_waitcnt lgkmcnt(3)
v_cvt_pk_bf16_f32 v216, v128, v129
v_cvt_pk_bf16_f32 v217, v130, v131
s_waitcnt lgkmcnt(2)
v_cvt_pk_bf16_f32 v218, v132, v133
v_cvt_pk_bf16_f32 v219, v134, v135
s_waitcnt lgkmcnt(1)
v_cvt_pk_bf16_f32 v220, v136, v137
v_cvt_pk_bf16_f32 v221, v138, v139
buffer_load_dwordx4 v[64:67], v31, s[48:51], s86 offen offset:2048 sc1
s_waitcnt lgkmcnt(0)
v_cvt_pk_bf16_f32 v222, v140, v141
v_cvt_pk_bf16_f32 v223, v142, v143
v_exp_f32 v176, v176
v_exp_f32 v177, v177
v_exp_f32 v178, v178
v_mfma_f32_32x32x16_bf16 v[144:159], v[208:211], v[224:227], 0
v_exp_f32 v179, v179
v_exp_f32 v180, v180
v_exp_f32_e64 v181, v181
v_mfma_f32_32x32x16_bf16 v[144:159], v[212:215], v[228:231], v[144:159]
v_exp_f32 v182, v182
v_exp_f32 v183, v183
v_exp_f32_e64 v184, v184
buffer_load_dwordx4 v[68:71], v31, s[48:51], s86 offen offset:2560 sc1
s_add_u32 s86, s86, 8192
v_mfma_f32_32x32x16_bf16 v[160:175], v[208:211], v[232:235], 0
v_exp_f32 v185, v185
v_exp_f32 v186, v186
v_exp_f32_e64 v187, v187
v_mfma_f32_32x32x16_bf16 v[160:175], v[212:215], v[236:239], v[160:175]
v_exp_f32 v188, v188
v_exp_f32 v189, v189
v_exp_f32 v190, v190
v_exp_f32 v191, v191
v_pk_add_f32 v[2:3], v[176:177], v[178:179]
v_pk_add_f32 v[4:5], v[180:181], v[182:183]
v_pk_add_f32 v[6:7], v[184:185], v[186:187]
v_pk_add_f32 v[8:9], v[188:189], v[190:191]
buffer_load_dwordx4 v[72:75], v31, s[48:51], s86 offen offset:0 sc1
v_pk_add_f32 v[2:3], v[2:3], v[4:5]
v_pk_add_f32 v[6:7], v[6:7], v[8:9]
v_pk_add_f32 v[2:3], v[2:3], v[6:7]
v_add_f32 v2, v2, v3
v_rcp_f32 v2, v2
v_nop_e64
v_pk_mul_f32 v[176:177], v[176:177], v[2:3] op_sel_hi:[1,0]
v_pk_mul_f32 v[178:179], v[178:179], v[2:3] op_sel_hi:[1,0]
v_pk_mul_f32 v[180:181], v[180:181], v[2:3] op_sel_hi:[1,0]
v_pk_mul_f32 v[182:183], v[182:183], v[2:3] op_sel_hi:[1,0]
v_pk_mul_f32 v[184:185], v[184:185], v[2:3] op_sel_hi:[1,0]
v_pk_mul_f32 v[186:187], v[186:187], v[2:3] op_sel_hi:[1,0]
v_pk_mul_f32 v[188:189], v[188:189], v[2:3] op_sel_hi:[1,0]
v_pk_mul_f32 v[190:191], v[190:191], v[2:3] op_sel_hi:[1,0]
buffer_load_dwordx4 v[76:79], v31, s[48:51], s86 offen offset:512 sc1
v_cvt_pk_bf16_f32 v240, v176, v177
v_cvt_pk_bf16_f32 v241, v178, v179
v_cvt_pk_bf16_f32 v242, v180, v181
v_cvt_pk_bf16_f32 v243, v182, v183
v_cvt_pk_bf16_f32 v244, v184, v185
v_cvt_pk_bf16_f32 v245, v186, v187
v_cvt_pk_bf16_f32 v246, v188, v189
v_cvt_pk_bf16_f32 v247, v190, v191
v_max3_f32 v2, v192, v193, v194
v_max3_f32 v3, v195, v196, v197
v_max3_f32 v4, v198, v199, v200
v_max3_f32 v5, v201, v202, v203
v_max3_f32 v6, v204, v205, v206
buffer_load_dwordx4 v[80:83], v31, s[48:51], s86 offen offset:2048 sc1
v_max3_f32 v2, v2, v3, v207
v_max3_f32 v4, v4, v5, v6
v_max_f32_e64 v2, v2, v4
v_mul_f32 v2, 0xbfb8aa3b, v2
v_pk_fma_f32 v[192:193], v[192:193], s[88:89], v[2:3] op_sel_hi:[1,0,0]
v_pk_fma_f32 v[194:195], v[194:195], s[88:89], v[2:3] op_sel_hi:[1,0,0]
v_pk_fma_f32 v[196:197], v[196:197], s[88:89], v[2:3] op_sel_hi:[1,0,0]
v_pk_fma_f32 v[198:199], v[198:199], s[88:89], v[2:3] op_sel_hi:[1,0,0]
v_pk_fma_f32 v[200:201], v[200:201], s[88:89], v[2:3] op_sel_hi:[1,0,0]
v_pk_fma_f32 v[202:203], v[202:203], s[88:89], v[2:3] op_sel_hi:[1,0,0]
v_pk_fma_f32 v[204:205], v[204:205], s[88:89], v[2:3] op_sel_hi:[1,0,0]
v_pk_fma_f32 v[206:207], v[206:207], s[88:89], v[2:3] op_sel_hi:[1,0,0]
v_exp_f32_e64 v192, v192
buffer_load_dwordx4 v[84:87], v31, s[48:51], s86 offen offset:2560 sc1
s_add_u32 s86, s86, 8192
v_exp_f32 v193, v193
v_exp_f32 v194, v194
v_mfma_f32_32x32x16_bf16 v[176:191], v[216:219], v[240:243], 0
v_exp_f32 v195, v195
v_exp_f32 v196, v196
v_exp_f32_e64 v197, v197
v_mfma_f32_32x32x16_bf16 v[176:191], v[220:223], v[244:247], v[176:191]
v_exp_f32 v198, v198
v_exp_f32 v199, v199
v_exp_f32 v200, v200
v_exp_f32 v201, v201
v_exp_f32 v202, v202
v_exp_f32 v203, v203
buffer_load_dwordx4 v[88:91], v31, s[48:51], s86 offen offset:0 sc1
v_exp_f32 v204, v204
v_exp_f32 v205, v205
v_exp_f32 v206, v206
v_exp_f32 v207, v207
v_pk_add_f32 v[2:3], v[192:193], v[194:195]
v_pk_add_f32 v[4:5], v[196:197], v[198:199]
v_pk_add_f32 v[6:7], v[200:201], v[202:203]
v_pk_add_f32 v[8:9], v[204:205], v[206:207]
v_pk_add_f32 v[2:3], v[2:3], v[4:5]
v_pk_add_f32 v[6:7], v[6:7], v[8:9]
v_pk_add_f32 v[2:3], v[2:3], v[6:7]
v_add_f32 v2, v2, v3
v_rcp_f32 v2, v2
buffer_load_dwordx4 v[92:95], v31, s[48:51], s86 offen offset:512 sc1
v_pk_mul_f32 v[192:193], v[192:193], v[2:3] op_sel_hi:[1,0]
v_pk_mul_f32 v[194:195], v[194:195], v[2:3] op_sel_hi:[1,0]
v_pk_mul_f32 v[196:197], v[196:197], v[2:3] op_sel_hi:[1,0]
v_pk_mul_f32 v[198:199], v[198:199], v[2:3] op_sel_hi:[1,0]
v_pk_mul_f32 v[200:201], v[200:201], v[2:3] op_sel_hi:[1,0]
v_pk_mul_f32 v[202:203], v[202:203], v[2:3] op_sel_hi:[1,0]
v_pk_mul_f32 v[204:205], v[204:205], v[2:3] op_sel_hi:[1,0]
v_pk_mul_f32 v[206:207], v[206:207], v[2:3] op_sel_hi:[1,0]
v_cvt_pk_bf16_f32 v248, v192, v193
v_cvt_pk_bf16_f32 v249, v194, v195
v_cvt_pk_bf16_f32 v250, v196, v197
v_cvt_pk_bf16_f32 v251, v198, v199
v_cvt_pk_bf16_f32 v252, v200, v201
v_cvt_pk_bf16_f32 v253, v202, v203
v_cvt_pk_bf16_f32 v254, v204, v205
v_cvt_pk_bf16_f32 v255, v206, v207
v_mfma_f32_32x32x16_bf16 v[192:207], v[216:219], v[248:251], 0
v_nop_e64
v_mfma_f32_32x32x16_bf16 v[192:207], v[220:223], v[252:255], v[192:207]
v_add_f32 v152, 0x358637bd, v152
v_rcp_f32 v152, v152
s_nop 0
v_pk_mul_f32 v[144:145], v[144:145], v[152:153] op_sel_hi:[1,0]
v_pk_mul_f32 v[146:147], v[146:147], v[152:153] op_sel_hi:[1,0]
v_pk_mul_f32 v[148:149], v[148:149], v[152:153] op_sel_hi:[1,0]
v_pk_mul_f32 v[150:151], v[150:151], v[152:153] op_sel_hi:[1,0]
v_cvt_pk_bf16_f32 v156, v144, v145
v_cvt_pk_bf16_f32 v157, v146, v147
v_cvt_pk_bf16_f32 v158, v148, v149
v_cvt_pk_bf16_f32 v159, v150, v151
buffer_store_dwordx4 v[156:159], v14, s[48:51], s96 offen sc1
v_add_f32 v168, 0x358637bd, v168
v_rcp_f32 v168, v168
s_nop 0
v_pk_mul_f32 v[160:161], v[160:161], v[168:169] op_sel_hi:[1,0]
v_pk_mul_f32 v[162:163], v[162:163], v[168:169] op_sel_hi:[1,0]
v_pk_mul_f32 v[164:165], v[164:165], v[168:169] op_sel_hi:[1,0]
v_pk_mul_f32 v[166:167], v[166:167], v[168:169] op_sel_hi:[1,0]
v_cvt_pk_bf16_f32 v172, v160, v161
v_cvt_pk_bf16_f32 v173, v162, v163
v_cvt_pk_bf16_f32 v174, v164, v165
v_cvt_pk_bf16_f32 v175, v166, v167
buffer_store_dwordx4 v[172:175], v14, s[48:51], s97 offen sc1
v_add_f32 v184, 0x358637bd, v184
v_rcp_f32 v184, v184
s_nop 0
v_pk_mul_f32 v[176:177], v[176:177], v[184:185] op_sel_hi:[1,0]
v_pk_mul_f32 v[178:179], v[178:179], v[184:185] op_sel_hi:[1,0]
v_pk_mul_f32 v[180:181], v[180:181], v[184:185] op_sel_hi:[1,0]
v_pk_mul_f32 v[182:183], v[182:183], v[184:185] op_sel_hi:[1,0]
v_cvt_pk_bf16_f32 v188, v176, v177
v_cvt_pk_bf16_f32 v189, v178, v179
v_cvt_pk_bf16_f32 v190, v180, v181
v_cvt_pk_bf16_f32 v191, v182, v183
buffer_store_dwordx4 v[188:191], v14, s[48:51], s98 offen sc1
v_add_f32 v200, 0x358637bd, v200
v_rcp_f32 v200, v200
s_nop 0
v_pk_mul_f32 v[192:193], v[192:193], v[200:201] op_sel_hi:[1,0]
v_pk_mul_f32 v[194:195], v[194:195], v[200:201] op_sel_hi:[1,0]
v_pk_mul_f32 v[196:197], v[196:197], v[200:201] op_sel_hi:[1,0]
v_pk_mul_f32 v[198:199], v[198:199], v[200:201] op_sel_hi:[1,0]
v_cvt_pk_bf16_f32 v204, v192, v193
v_cvt_pk_bf16_f32 v205, v194, v195
v_cvt_pk_bf16_f32 v206, v196, v197
v_cvt_pk_bf16_f32 v207, v198, v199
buffer_store_dwordx4 v[204:207], v14, s[48:51], s99 offen sc1
s_waitcnt vmcnt(13)
v_mfma_f32_16x16x32_bf16 v[128:131], a[0:3], v[56:59], 0
s_waitcnt vmcnt(12)
v_mfma_f32_16x16x32_bf16 v[144:147], a[0:3], v[60:63], 0
buffer_load_dwordx4 v[96:99], v31, s[48:51], s86 offen offset:2048 sc1
v_mfma_f32_16x16x32_bf16 v[132:135], a[4:7], v[56:59], 0
v_mfma_f32_16x16x32_bf16 v[148:151], a[4:7], v[60:63], 0
v_mfma_f32_16x16x32_bf16 v[136:139], a[8:11], v[56:59], 0
buffer_load_dwordx4 v[100:103], v31, s[48:51], s86 offen offset:2560 sc1
v_mfma_f32_16x16x32_bf16 v[152:155], a[8:11], v[60:63], 0
s_add_u32 s86, s86, 8192
v_mfma_f32_16x16x32_bf16 v[140:143], a[12:15], v[56:59], 0
v_mfma_f32_16x16x32_bf16 v[156:159], a[12:15], v[60:63], 0
s_waitcnt vmcnt(13)
v_mfma_f32_16x16x32_bf16 v[160:163], a[0:3], v[64:67], 0
buffer_load_dwordx4 v[104:107], v31, s[48:51], s86 offen offset:0 sc1
s_waitcnt vmcnt(13)
v_mfma_f32_16x16x32_bf16 v[176:179], a[0:3], v[68:71], 0
ds_read_b64_tr_b16 a[112:113], v48 offset:16384
ds_read_b64_tr_b16 a[114:115], v48 offset:17408
v_mfma_f32_16x16x32_bf16 v[164:167], a[4:7], v[64:67], 0
ds_read_b64_tr_b16 a[116:117], v49 offset:16384
v_mfma_f32_16x16x32_bf16 v[180:183], a[4:7], v[68:71], 0
ds_read_b64_tr_b16 a[118:119], v49 offset:17408
v_mfma_f32_16x16x32_bf16 v[168:171], a[8:11], v[64:67], 0
buffer_load_dwordx4 v[108:111], v31, s[48:51], s86 offen offset:512 sc1
v_mfma_f32_16x16x32_bf16 v[184:187], a[8:11], v[68:71], 0
ds_read_b64_tr_b16 a[120:121], v50 offset:16384
ds_read_b64_tr_b16 a[122:123], v50 offset:17408
v_mfma_f32_16x16x32_bf16 v[172:175], a[12:15], v[64:67], 0
ds_read_b64_tr_b16 a[124:125], v51 offset:16384
v_mfma_f32_16x16x32_bf16 v[188:191], a[12:15], v[68:71], 0
ds_read_b64_tr_b16 a[126:127], v51 offset:17408
s_waitcnt vmcnt(13)
v_mfma_f32_16x16x32_bf16 v[128:131], a[16:19], v[72:75], v[128:131]
s_waitcnt vmcnt(12)
v_mfma_f32_16x16x32_bf16 v[144:147], a[16:19], v[76:79], v[144:147]
buffer_load_dwordx4 v[112:115], v31, s[48:51], s86 offen offset:2048 sc1
v_mfma_f32_16x16x32_bf16 v[132:135], a[20:23], v[72:75], v[132:135]
v_mfma_f32_16x16x32_bf16 v[148:151], a[20:23], v[76:79], v[148:151]
v_mfma_f32_16x16x32_bf16 v[136:139], a[24:27], v[72:75], v[136:139]
buffer_load_dwordx4 v[116:119], v31, s[48:51], s86 offen offset:2560 sc1
v_mfma_f32_16x16x32_bf16 v[152:155], a[24:27], v[76:79], v[152:155]
s_add_u32 s86, s86, 8192
v_mfma_f32_16x16x32_bf16 v[140:143], a[28:31], v[72:75], v[140:143]
v_mfma_f32_16x16x32_bf16 v[156:159], a[28:31], v[76:79], v[156:159]
s_waitcnt vmcnt(13)
v_mfma_f32_16x16x32_bf16 v[160:163], a[16:19], v[80:83], v[160:163]
buffer_load_dwordx4 v[120:123], v31, s[48:51], s86 offen offset:0 sc1
s_waitcnt vmcnt(13)
v_mfma_f32_16x16x32_bf16 v[176:179], a[16:19], v[84:87], v[176:179]
v_add_u32 v48, 65536, v48
ds_read_b64_tr_b16 a[128:129], v48 offset:0
ds_read_b64_tr_b16 a[130:131], v48 offset:1024
v_mfma_f32_16x16x32_bf16 v[164:167], a[20:23], v[80:83], v[164:167]
v_add_u32 v49, 65536, v49
v_mfma_f32_16x16x32_bf16 v[180:183], a[20:23], v[84:87], v[180:183]
ds_read_b64_tr_b16 a[132:133], v49 offset:0
ds_read_b64_tr_b16 a[134:135], v49 offset:1024
v_mfma_f32_16x16x32_bf16 v[168:171], a[24:27], v[80:83], v[168:171]
buffer_load_dwordx4 v[124:127], v31, s[48:51], s86 offen offset:512 sc1
v_add_u32 v50, 65536, v50
v_mfma_f32_16x16x32_bf16 v[184:187], a[24:27], v[84:87], v[184:187]
ds_read_b64_tr_b16 a[136:137], v50 offset:0
ds_read_b64_tr_b16 a[138:139], v50 offset:1024
v_mfma_f32_16x16x32_bf16 v[172:175], a[28:31], v[80:83], v[172:175]
v_add_u32 v51, 65536, v51
v_mfma_f32_16x16x32_bf16 v[188:191], a[28:31], v[84:87], v[188:191]
ds_read_b64_tr_b16 a[140:141], v51 offset:0
ds_read_b64_tr_b16 a[142:143], v51 offset:1024
s_waitcnt vmcnt(8)
s_barrier
s_cmp_lg_u32 s68, 0
s_cbranch_scc1 Lfl15
s_atomic_add s85, s[48:49], s61
Lfl15:
v_mfma_f32_16x16x32_bf16 v[128:131], a[32:35], v[88:91], v[128:131]
v_mfma_f32_16x16x32_bf16 v[144:147], a[32:35], v[92:95], v[144:147]
buffer_load_dwordx4 v[56:59], v31, s[48:51], s86 offen offset:2048 sc1
v_mfma_f32_16x16x32_bf16 v[132:135], a[36:39], v[88:91], v[132:135]
v_mfma_f32_16x16x32_bf16 v[148:151], a[36:39], v[92:95], v[148:151]
v_mfma_f32_16x16x32_bf16 v[136:139], a[40:43], v[88:91], v[136:139]
buffer_load_dwordx4 v[60:63], v31, s[48:51], s86 offen offset:2560 sc1
v_mfma_f32_16x16x32_bf16 v[152:155], a[40:43], v[92:95], v[152:155]
s_add_u32 s86, s86, 8192
v_mfma_f32_16x16x32_bf16 v[140:143], a[44:47], v[88:91], v[140:143]
v_mfma_f32_16x16x32_bf16 v[156:159], a[44:47], v[92:95], v[156:159]
s_waitcnt vmcnt(9)
v_mfma_f32_16x16x32_bf16 v[160:163], a[32:35], v[96:99], v[160:163]
buffer_load_dwordx4 v[64:67], v31, s[48:51], s86 offen offset:0 sc1
s_waitcnt vmcnt(9)
v_mfma_f32_16x16x32_bf16 v[176:179], a[32:35], v[100:103], v[176:179]
ds_read_b64_tr_b16 a[144:145], v48 offset:16384
ds_read_b64_tr_b16 a[146:147], v48 offset:17408
v_mfma_f32_16x16x32_bf16 v[164:167], a[36:39], v[96:99], v[164:167]
ds_read_b64_tr_b16 a[148:149], v49 offset:16384
v_mfma_f32_16x16x32_bf16 v[180:183], a[36:39], v[100:103], v[180:183]
ds_read_b64_tr_b16 a[150:151], v49 offset:17408
v_mfma_f32_16x16x32_bf16 v[168:171], a[40:43], v[96:99], v[168:171]
buffer_load_dwordx4 v[68:71], v31, s[48:51], s86 offen offset:512 sc1
v_mfma_f32_16x16x32_bf16 v[184:187], a[40:43], v[100:103], v[184:187]
ds_read_b64_tr_b16 a[152:153], v50 offset:16384
ds_read_b64_tr_b16 a[154:155], v50 offset:17408
v_mfma_f32_16x16x32_bf16 v[172:175], a[44:47], v[96:99], v[172:175]
ds_read_b64_tr_b16 a[156:157], v51 offset:16384
v_mfma_f32_16x16x32_bf16 v[188:191], a[44:47], v[100:103], v[188:191]
ds_read_b64_tr_b16 a[158:159], v51 offset:17408
s_waitcnt vmcnt(9)
v_mfma_f32_16x16x32_bf16 v[128:131], a[48:51], v[104:107], v[128:131]
s_waitcnt vmcnt(8)
v_mfma_f32_16x16x32_bf16 v[144:147], a[48:51], v[108:111], v[144:147]
buffer_load_dwordx4 v[72:75], v31, s[48:51], s86 offen offset:2048 sc1
v_mfma_f32_16x16x32_bf16 v[132:135], a[52:55], v[104:107], v[132:135]
v_mfma_f32_16x16x32_bf16 v[148:151], a[52:55], v[108:111], v[148:151]
v_mfma_f32_16x16x32_bf16 v[136:139], a[56:59], v[104:107], v[136:139]
buffer_load_dwordx4 v[76:79], v31, s[48:51], s86 offen offset:2560 sc1
v_mfma_f32_16x16x32_bf16 v[152:155], a[56:59], v[108:111], v[152:155]
s_add_u32 s86, s86, 8192
v_mfma_f32_16x16x32_bf16 v[140:143], a[60:63], v[104:107], v[140:143]
v_mfma_f32_16x16x32_bf16 v[156:159], a[60:63], v[108:111], v[156:159]
s_waitcnt vmcnt(9)
v_mfma_f32_16x16x32_bf16 v[160:163], a[48:51], v[112:115], v[160:163]
buffer_load_dwordx4 v[80:83], v31, s[48:51], s86 offen offset:0 sc1
s_add_u32 s63, s63, 4096
s_waitcnt vmcnt(9)
v_mfma_f32_16x16x32_bf16 v[176:179], a[48:51], v[116:119], v[176:179]
s_cmp_lg_u32 s68, 0
s_cbranch_scc1 Lpi16
s_mov_b32 s84, 0
s_atomic_add s84, s[48:49], s63 glc
Lpi16:
s_add_u32 m0, s78, 49152
s_sub_u32 s81, s81, 1277952
buffer_load_dwordx4 v44, s[44:47], s81 offen offset:0 lds
buffer_load_dwordx4 v45, s[44:47], s81 offen offset:1024 lds
v_mfma_f32_16x16x32_bf16 v[164:167], a[52:55], v[112:115], v[164:167]
buffer_load_dwordx4 v46, s[44:47], s81 offen offset:2048 lds
v_mfma_f32_16x16x32_bf16 v[180:183], a[52:55], v[116:119], v[180:183]
buffer_load_dwordx4 v47, s[44:47], s81 offen offset:3072 lds
v_mfma_f32_16x16x32_bf16 v[168:171], a[56:59], v[112:115], v[168:171]
buffer_load_dwordx4 v[84:87], v31, s[48:51], s86 offen offset:512 sc1
s_waitcnt lgkmcnt(14)
s_add_u32 m0, s78, 16384
v_mfma_f32_16x16x32_bf16 v[184:187], a[56:59], v[116:119], v[184:187]
s_add_u32 s81, s81, 131072
buffer_load_dwordx4 v44, s[44:47], s81 offen offset:0 lds
buffer_load_dwordx4 v45, s[44:47], s81 offen offset:1024 lds
v_mfma_f32_16x16x32_bf16 v[172:175], a[60:63], v[112:115], v[172:175]
buffer_load_dwordx4 v46, s[44:47], s81 offen offset:2048 lds
v_mfma_f32_16x16x32_bf16 v[188:191], a[60:63], v[116:119], v[188:191]
buffer_load_dwordx4 v47, s[44:47], s81 offen offset:3072 lds
s_waitcnt vmcnt(17)
v_mfma_f32_16x16x32_bf16 v[128:131], a[64:67], v[120:123], v[128:131]
s_waitcnt vmcnt(16)
v_mfma_f32_16x16x32_bf16 v[144:147], a[64:67], v[124:127], v[144:147]
buffer_load_dwordx4 v[88:91], v31, s[48:51], s86 offen offset:2048 sc1
v_mfma_f32_16x16x32_bf16 v[132:135], a[68:71], v[120:123], v[132:135]
v_mfma_f32_16x16x32_bf16 v[148:151], a[68:71], v[124:127], v[148:151]
v_mfma_f32_16x16x32_bf16 v[136:139], a[72:75], v[120:123], v[136:139]
buffer_load_dwordx4 v[92:95], v31, s[48:51], s86 offen offset:2560 sc1
v_mfma_f32_16x16x32_bf16 v[152:155], a[72:75], v[124:127], v[152:155]
s_add_u32 s86, s86, 8192
v_mfma_f32_16x16x32_bf16 v[140:143], a[76:79], v[120:123], v[140:143]
v_mfma_f32_16x16x32_bf16 v[156:159], a[76:79], v[124:127], v[156:159]
s_waitcnt lgkmcnt(0)
s_cmp_lg_u32 s68, 0
s_cbranch_scc1 Lok17
s_cmp_ge_u32 s84, 8
s_cbranch_scc1 Lok17
s_mov_b32 s93, 0
Lsp17:
s_mov_b32 s84, 0
s_atomic_add s84, s[48:49], s63 glc
s_add_u32 s93, s93, 1
s_waitcnt lgkmcnt(0)
s_cmp_ge_u32 s84, 8
s_cbranch_scc1 Lok17
s_cmp_lt_u32 s93, 0x8000
s_cbranch_scc1 Lsp17
Lok17:
s_barrier
s_waitcnt vmcnt(17)
v_mfma_f32_16x16x32_bf16 v[160:163], a[64:67], v[56:59], v[160:163]
buffer_load_dwordx4 v[96:99], v31, s[48:51], s86 offen offset:0 sc1
s_waitcnt vmcnt(17)
v_mfma_f32_16x16x32_bf16 v[176:179], a[64:67], v[60:63], v[176:179]
v_subrev_u32 v48, 65536, v48
ds_read_b64_tr_b16 a[160:161], v48 offset:0
ds_read_b64_tr_b16 a[162:163], v48 offset:1024
v_mfma_f32_16x16x32_bf16 v[164:167], a[68:71], v[56:59], v[164:167]
v_subrev_u32 v49, 65536, v49
v_mfma_f32_16x16x32_bf16 v[180:183], a[68:71], v[60:63], v[180:183]
ds_read_b64_tr_b16 a[164:165], v49 offset:0
ds_read_b64_tr_b16 a[166:167], v49 offset:1024
v_mfma_f32_16x16x32_bf16 v[168:171], a[72:75], v[56:59], v[168:171]
buffer_load_dwordx4 v[100:103], v31, s[48:51], s86 offen offset:512 sc1
v_subrev_u32 v50, 65536, v50
v_mfma_f32_16x16x32_bf16 v[184:187], a[72:75], v[60:63], v[184:187]
ds_read_b64_tr_b16 a[168:169], v50 offset:0
ds_read_b64_tr_b16 a[170:171], v50 offset:1024
v_mfma_f32_16x16x32_bf16 v[172:175], a[76:79], v[56:59], v[172:175]
v_subrev_u32 v51, 65536, v51
v_mfma_f32_16x16x32_bf16 v[188:191], a[76:79], v[60:63], v[188:191]
ds_read_b64_tr_b16 a[172:173], v51 offset:0
ds_read_b64_tr_b16 a[174:175], v51 offset:1024
s_waitcnt vmcnt(17)
v_mfma_f32_16x16x32_bf16 v[128:131], a[80:83], v[64:67], v[128:131]
s_waitcnt vmcnt(16)
v_mfma_f32_16x16x32_bf16 v[144:147], a[80:83], v[68:71], v[144:147]
buffer_load_dwordx4 v[104:107], v31, s[48:51], s86 offen offset:2048 sc1
v_mfma_f32_16x16x32_bf16 v[132:135], a[84:87], v[64:67], v[132:135]
v_mfma_f32_16x16x32_bf16 v[148:151], a[84:87], v[68:71], v[148:151]
v_mfma_f32_16x16x32_bf16 v[136:139], a[88:91], v[64:67], v[136:139]
buffer_load_dwordx4 v[108:111], v31, s[48:51], s86 offen offset:2560 sc1
v_mfma_f32_16x16x32_bf16 v[152:155], a[88:91], v[68:71], v[152:155]
s_add_u32 s86, s86, 8192
v_mfma_f32_16x16x32_bf16 v[140:143], a[92:95], v[64:67], v[140:143]
v_mfma_f32_16x16x32_bf16 v[156:159], a[92:95], v[68:71], v[156:159]
s_waitcnt vmcnt(17)
v_mfma_f32_16x16x32_bf16 v[160:163], a[80:83], v[72:75], v[160:163]
s_waitcnt vmcnt(16)
v_mfma_f32_16x16x32_bf16 v[176:179], a[80:83], v[76:79], v[176:179]
buffer_load_dwordx4 v[112:115], v29, s[48:51], s86 offen offset:0 sc1
v_mfma_f32_16x16x32_bf16 v[164:167], a[84:87], v[72:75], v[164:167]
v_mfma_f32_16x16x32_bf16 v[180:183], a[84:87], v[76:79], v[180:183]
v_mfma_f32_16x16x32_bf16 v[168:171], a[88:91], v[72:75], v[168:171]
v_mfma_f32_16x16x32_bf16 v[184:187], a[88:91], v[76:79], v[184:187]
buffer_load_dwordx4 v[116:119], v29, s[48:51], s86 offen offset:512 sc1
v_mfma_f32_16x16x32_bf16 v[172:175], a[92:95], v[72:75], v[172:175]
v_mfma_f32_16x16x32_bf16 v[188:191], a[92:95], v[76:79], v[188:191]
s_waitcnt vmcnt(17)
v_mfma_f32_16x16x32_bf16 v[128:131], a[96:99], v[80:83], v[128:131]
s_waitcnt vmcnt(12)
v_mfma_f32_16x16x32_bf16 v[144:147], a[96:99], v[84:87], v[144:147]
buffer_load_dwordx4 v[120:123], v29, s[48:51], s86 offen offset:2048 sc1
v_mfma_f32_16x16x32_bf16 v[132:135], a[100:103], v[80:83], v[132:135]
v_mfma_f32_16x16x32_bf16 v[148:151], a[100:103], v[84:87], v[148:151]
v_mfma_f32_16x16x32_bf16 v[136:139], a[104:107], v[80:83], v[136:139]
buffer_load_dwordx4 v[124:127], v29, s[48:51], s86 offen offset:2560 sc1
v_mfma_f32_16x16x32_bf16 v[152:155], a[104:107], v[84:87], v[152:155]
s_add_u32 s86, s86, 8192
v_mfma_f32_16x16x32_bf16 v[140:143], a[108:111], v[80:83], v[140:143]
v_mfma_f32_16x16x32_bf16 v[156:159], a[108:111], v[84:87], v[156:159]
s_waitcnt vmcnt(9)
v_mfma_f32_16x16x32_bf16 v[160:163], a[96:99], v[88:91], v[160:163]
buffer_load_dwordx4 v[56:59], v31, s[48:51], s86 offen offset:0 sc1
s_waitcnt vmcnt(9)
v_mfma_f32_16x16x32_bf16 v[176:179], a[96:99], v[92:95], v[176:179]
ds_read_b64_tr_b16 a[176:177], v48 offset:49152
ds_read_b64_tr_b16 a[178:179], v48 offset:50176
v_mfma_f32_16x16x32_bf16 v[164:167], a[100:103], v[88:91], v[164:167]
ds_read_b64_tr_b16 a[180:181], v49 offset:49152
v_mfma_f32_16x16x32_bf16 v[180:183], a[100:103], v[92:95], v[180:183]
ds_read_b64_tr_b16 a[182:183], v49 offset:50176
v_mfma_f32_16x16x32_bf16 v[168:171], a[104:107], v[88:91], v[168:171]
buffer_load_dwordx4 v[60:63], v31, s[48:51], s86 offen offset:512 sc1
v_mfma_f32_16x16x32_bf16 v[184:187], a[104:107], v[92:95], v[184:187]
ds_read_b64_tr_b16 a[184:185], v50 offset:49152
ds_read_b64_tr_b16 a[186:187], v50 offset:50176
v_mfma_f32_16x16x32_bf16 v[172:175], a[108:111], v[88:91], v[172:175]
ds_read_b64_tr_b16 a[188:189], v51 offset:49152
v_mfma_f32_16x16x32_bf16 v[188:191], a[108:111], v[92:95], v[188:191]
ds_read_b64_tr_b16 a[190:191], v51 offset:50176
s_waitcnt vmcnt(9)
v_mfma_f32_16x16x32_bf16 v[128:131], a[112:115], v[96:99], v[128:131]
buffer_load_dwordx4 v[64:67], v31, s[48:51], s86 offen offset:2048 sc1
s_waitcnt vmcnt(9)
v_mfma_f32_16x16x32_bf16 v[144:147], a[112:115], v[100:103], v[144:147]
ds_read_b64_tr_b16 a[192:193], v48 offset:16384
ds_read_b64_tr_b16 a[194:195], v48 offset:17408
v_mfma_f32_16x16x32_bf16 v[132:135], a[116:119], v[96:99], v[132:135]
ds_read_b64_tr_b16 a[196:197], v49 offset:16384
v_mfma_f32_16x16x32_bf16 v[148:151], a[116:119], v[100:103], v[148:151]
ds_read_b64_tr_b16 a[198:199], v49 offset:17408
v_mfma_f32_16x16x32_bf16 v[136:139], a[120:123], v[96:99], v[136:139]
buffer_load_dwordx4 v[68:71], v31, s[48:51], s86 offen offset:2560 sc1
s_add_u32 s86, s86, 8192
v_mfma_f32_16x16x32_bf16 v[152:155], a[120:123], v[100:103], v[152:155]
ds_read_b64_tr_b16 a[200:201], v50 offset:16384
ds_read_b64_tr_b16 a[202:203], v50 offset:17408
v_mfma_f32_16x16x32_bf16 v[140:143], a[124:127], v[96:99], v[140:143]
ds_read_b64_tr_b16 a[204:205], v51 offset:16384
v_mfma_f32_16x16x32_bf16 v[156:159], a[124:127], v[100:103], v[156:159]
ds_read_b64_tr_b16 a[206:207], v51 offset:17408
s_waitcnt vmcnt(9)
v_mfma_f32_16x16x32_bf16 v[160:163], a[112:115], v[104:107], v[160:163]
buffer_load_dwordx4 v[72:75], v31, s[48:51], s86 offen offset:0 sc1
s_waitcnt vmcnt(9)
v_mfma_f32_16x16x32_bf16 v[176:179], a[112:115], v[108:111], v[176:179]
s_cmp_lg_u32 s68, 0
s_cbranch_scc1 Lpi18
s_mov_b32 s84, 0
s_atomic_add s84, s[48:49], s64 glc
Lpi18:
s_add_u32 m0, s78, 65536
s_add_u32 s81, s81, 131072
buffer_load_dwordx4 v44, s[44:47], s81 offen offset:0 lds
v_mfma_f32_16x16x32_bf16 v[164:167], a[116:119], v[104:107], v[164:167]
v_mfma_f32_16x16x32_bf16 v[180:183], a[116:119], v[108:111], v[180:183]
buffer_load_dwordx4 v45, s[44:47], s81 offen offset:1024 lds
v_mfma_f32_16x16x32_bf16 v[168:171], a[120:123], v[104:107], v[168:171]
buffer_load_dwordx4 v[76:79], v31, s[48:51], s86 offen offset:512 sc1
v_mfma_f32_16x16x32_bf16 v[184:187], a[120:123], v[108:111], v[184:187]
buffer_load_dwordx4 v46, s[44:47], s81 offen offset:2048 lds
v_mfma_f32_16x16x32_bf16 v[172:175], a[124:127], v[104:107], v[172:175]
v_mfma_f32_16x16x32_bf16 v[188:191], a[124:127], v[108:111], v[188:191]
buffer_load_dwordx4 v47, s[44:47], s81 offen offset:3072 lds
s_waitcnt vmcnt(13)
v_mfma_f32_16x16x32_bf16 v[128:131], a[128:131], v[112:115], v[128:131]
buffer_load_dwordx4 v[80:83], v31, s[48:51], s86 offen offset:2048 sc1
s_waitcnt vmcnt(13)
v_mfma_f32_16x16x32_bf16 v[144:147], a[128:131], v[116:119], v[144:147]
s_add_u32 m0, s78, 81920
s_add_u32 s81, s81, 131072
buffer_load_dwordx4 v44, s[44:47], s81 offen offset:0 lds
v_mfma_f32_16x16x32_bf16 v[132:135], a[132:135], v[112:115], v[132:135]
v_mfma_f32_16x16x32_bf16 v[148:151], a[132:135], v[116:119], v[148:151]
buffer_load_dwordx4 v45, s[44:47], s81 offen offset:1024 lds
v_mfma_f32_16x16x32_bf16 v[136:139], a[136:139], v[112:115], v[136:139]
buffer_load_dwordx4 v[84:87], v31, s[48:51], s86 offen offset:2560 sc1
v_mfma_f32_16x16x32_bf16 v[152:155], a[136:139], v[116:119], v[152:155]
s_add_u32 s86, s86, 8192
buffer_load_dwordx4 v46, s[44:47], s81 offen offset:2048 lds
v_mfma_f32_16x16x32_bf16 v[140:143], a[140:143], v[112:115], v[140:143]
v_mfma_f32_16x16x32_bf16 v[156:159], a[140:143], v[116:119], v[156:159]
buffer_load_dwordx4 v47, s[44:47], s81 offen offset:3072 lds
s_waitcnt lgkmcnt(0)
s_cmp_lg_u32 s68, 0
s_cbranch_scc1 Lok19
s_cmp_ge_u32 s84, 8
s_cbranch_scc1 Lok19
s_mov_b32 s93, 0
Lsp19:
s_mov_b32 s84, 0
s_atomic_add s84, s[48:49], s64 glc
s_add_u32 s93, s93, 1
s_waitcnt lgkmcnt(0)
s_cmp_ge_u32 s84, 8
s_cbranch_scc1 Lok19
s_cmp_lt_u32 s93, 0x8000
s_cbranch_scc1 Lsp19
Lok19:
s_barrier
buffer_load_dword v24, v30, s[48:51], s65 offen offset:0 sc1
buffer_load_dword v26, v30, s[48:51], s65 offen offset:64 sc1
buffer_load_dword v36, v30, s[48:51], s65 offen offset:128 sc1
buffer_load_dword v38, v30, s[48:51], s65 offen offset:192 sc1
s_waitcnt vmcnt(21)
v_mfma_f32_16x16x32_bf16 v[160:163], a[128:131], v[120:123], v[160:163]
s_waitcnt vmcnt(20)
v_mfma_f32_16x16x32_bf16 v[176:179], a[128:131], v[124:127], v[176:179]
buffer_load_dwordx4 v[88:91], v31, s[48:51], s86 offen offset:0 sc1
v_mfma_f32_16x16x32_bf16 v[164:167], a[132:135], v[120:123], v[164:167]
v_mfma_f32_16x16x32_bf16 v[180:183], a[132:135], v[124:127], v[180:183]
v_mfma_f32_16x16x32_bf16 v[168:171], a[136:139], v[120:123], v[168:171]
v_add_u32 v29, 8192, v31
v_mfma_f32_16x16x32_bf16 v[184:187], a[136:139], v[124:127], v[184:187]
buffer_load_dwordx4 v[92:95], v29, s[48:51], s86 offen offset:0 sc1
s_add_u32 s86, s86, 16384
v_mfma_f32_16x16x32_bf16 v[172:175], a[140:143], v[120:123], v[172:175]
v_mfma_f32_16x16x32_bf16 v[188:191], a[140:143], v[124:127], v[188:191]
s_waitcnt vmcnt(21)
v_mfma_f32_16x16x32_bf16 v[128:131], a[144:147], v[56:59], v[128:131]
buffer_load_dwordx4 v[96:99], v31, s[48:51], s86 offen offset:0 sc1
s_waitcnt vmcnt(13)
v_add_u32 v48, 65536, v48
ds_read_b64_tr_b16 a[208:209], v48 offset:0
v_mfma_f32_16x16x32_bf16 v[144:147], a[144:147], v[60:63], v[144:147]
ds_read_b64_tr_b16 a[210:211], v48 offset:1024
v_and_b32 v2, 15, v1
v_lshrrev_b32 v3, 4, v1
v_and_b32 v8, 7, v1
v_xor_b32_e64 v3, v3, v8
v_mfma_f32_16x16x32_bf16 v[132:135], a[148:151], v[56:59], v[132:135]
v_add_u32 v49, 65536, v49
ds_read_b64_tr_b16 a[212:213], v49 offset:0
ds_read_b64_tr_b16 a[214:215], v49 offset:1024
v_mfma_f32_16x16x32_bf16 v[148:151], a[148:151], v[60:63], v[148:151]
v_lshlrev_b32_e64 v3, 4, v3
v_lshl_add_u32 v3, v2, 8, v3
v_add_u32 v16, s78, v3
v_xor_b32 v17, 64, v16
v_mfma_f32_16x16x32_bf16 v[136:139], a[152:155], v[56:59], v[136:139]
buffer_load_dwordx4 v[100:103], v29, s[48:51], s86 offen offset:0 sc1
LhopB4:
s_cbranch_execz LbackB
s_sub_u32 s86, s86, 16384
v_add_u32 v50, 65536, v50
ds_read_b64_tr_b16 a[216:217], v50 offset:0
v_mfma_f32_16x16x32_bf16 v[152:155], a[152:155], v[60:63], v[152:155]
ds_read_b64_tr_b16 a[218:219], v50 offset:1024
v_lshrrev_b32 v2, 3, v0
v_and_b32 v3, 7, v2
v_lshlrev_b32 v9, 1, v8
v_xor_b32_e64 v3, v3, v9
v_mfma_f32_16x16x32_bf16 v[140:143], a[156:159], v[56:59], v[140:143]
v_add_u32 v51, 65536, v51
ds_read_b64_tr_b16 a[220:221], v51 offset:0
ds_read_b64_tr_b16 a[222:223], v51 offset:1024
v_mfma_f32_16x16x32_bf16 v[156:159], a[156:159], v[60:63], v[156:159]
v_lshlrev_b32 v3, 4, v3
v_and_b32 v9, 15, v2
v_lshl_add_u32 v3, v9, 8, v3
v_lshrrev_b32_e64 v9, 7, v0
v_mfma_f32_16x16x32_bf16 v[160:163], a[144:147], v[64:67], v[160:163]
buffer_load_dwordx4 v[104:107], v31, s[48:51], s86 offen offset:512 sc1
v_lshl_add_u32 v20, v9, 14, v3
v_mfma_f32_16x16x32_bf16 v[176:179], a[144:147], v[68:71], v[176:179]
v_xor_b32 v21, 16, v20
v_lshlrev_b32 v8, 4, v8
v_lshl_add_u32 v22, v2, 10, v8
v_mfma_f32_16x16x32_bf16 v[164:167], a[148:151], v[64:67], v[164:167]
v_mfma_f32_16x16x32_bf16 v[180:183], a[148:151], v[68:71], v[180:183]
v_mfma_f32_16x16x32_bf16 v[168:171], a[152:155], v[64:67], v[168:171]
buffer_load_dwordx4 v[108:111], v29, s[48:51], s86 offen offset:512 sc1
v_mfma_f32_16x16x32_bf16 v[184:187], a[152:155], v[68:71], v[184:187]
s_add_u32 s86, s86, 16384
v_mfma_f32_16x16x32_bf16 v[172:175], a[156:159], v[64:67], v[172:175]
v_mfma_f32_16x16x32_bf16 v[188:191], a[156:159], v[68:71], v[188:191]
v_mfma_f32_16x16x32_bf16 v[128:131], a[160:163], v[72:75], v[128:131]
v_mfma_f32_16x16x32_bf16 v[144:147], a[160:163], v[76:79], v[144:147]
buffer_load_dwordx4 v[112:115], v31, s[48:51], s86 offen offset:512 sc1
v_mfma_f32_16x16x32_bf16 v[132:135], a[164:167], v[72:75], v[132:135]
v_mfma_f32_16x16x32_bf16 v[148:151], a[164:167], v[76:79], v[148:151]
v_mfma_f32_16x16x32_bf16 v[136:139], a[168:171], v[72:75], v[136:139]
buffer_load_dwordx4 v[116:119], v29, s[48:51], s86 offen offset:512 sc1
v_mfma_f32_16x16x32_bf16 v[152:155], a[168:171], v[76:79], v[152:155]
s_sub_u32 s86, s86, 16384
v_mfma_f32_16x16x32_bf16 v[140:143], a[172:175], v[72:75], v[140:143]
v_mfma_f32_16x16x32_bf16 v[156:159], a[172:175], v[76:79], v[156:159]
s_waitcnt vmcnt(17)
v_mfma_f32_16x16x32_bf16 v[160:163], a[160:163], v[80:83], v[160:163]
buffer_load_dwordx4 v[120:123], v31, s[48:51], s86 offen offset:2048 sc1
s_waitcnt vmcnt(13)
v_mfma_f32_16x16x32_bf16 v[176:179], a[160:163], v[84:87], v[176:179]
ds_read_b64_tr_b16 a[224:225], v48 offset:16384
ds_read_b64_tr_b16 a[226:227], v48 offset:17408
v_mfma_f32_16x16x32_bf16 v[164:167], a[164:167], v[80:83], v[164:167]
ds_read_b64_tr_b16 a[228:229], v49 offset:16384
v_mfma_f32_16x16x32_bf16 v[180:183], a[164:167], v[84:87], v[180:183]
ds_read_b64_tr_b16 a[230:231], v49 offset:17408
v_mfma_f32_16x16x32_bf16 v[168:171], a[168:171], v[80:83], v[168:171]
buffer_load_dwordx4 v[124:127], v29, s[48:51], s86 offen offset:2048 sc1
s_add_u32 s86, s86, 16384
v_mfma_f32_16x16x32_bf16 v[184:187], a[168:171], v[84:87], v[184:187]
ds_read_b64_tr_b16 a[232:233], v50 offset:16384
ds_read_b64_tr_b16 a[234:235], v50 offset:17408
v_mfma_f32_16x16x32_bf16 v[172:175], a[172:175], v[80:83], v[172:175]
ds_read_b64_tr_b16 a[236:237], v51 offset:16384
v_mfma_f32_16x16x32_bf16 v[188:191], a[172:175], v[84:87], v[188:191]
ds_read_b64_tr_b16 a[238:239], v51 offset:17408
s_waitcnt vmcnt(9)
v_mfma_f32_16x16x32_bf16 v[192:195], a[176:179], v[88:91], v[128:131]
v_mfma_f32_16x16x32_bf16 v[196:199], a[180:183], v[88:91], v[132:135]
buffer_load_dwordx4 v[56:59], v31, s[48:51], s86 offen offset:2048 sc1
v_mfma_f32_16x16x32_bf16 v[200:203], a[184:187], v[88:91], v[136:139]
v_mfma_f32_16x16x32_bf16 v[204:207], a[188:191], v[88:91], v[140:143]
s_waitcnt vmcnt(9)
v_mfma_f32_16x16x32_bf16 v[192:195], a[192:195], v[92:95], v[192:195]
buffer_load_dwordx4 v[60:63], v29, s[48:51], s86 offen offset:2048 sc1
v_mfma_f32_16x16x32_bf16 v[196:199], a[196:199], v[92:95], v[196:199]
s_sub_u32 s86, s86, 16384
v_mfma_f32_16x16x32_bf16 v[200:203], a[200:203], v[92:95], v[200:203]
v_mfma_f32_16x16x32_bf16 v[204:207], a[204:207], v[92:95], v[204:207]
s_waitcnt vmcnt(9) lgkmcnt(14)
v_mfma_f32_16x16x32_bf16 v[192:195], a[208:211], v[96:99], v[192:195]
s_waitcnt lgkmcnt(12)
v_mfma_f32_16x16x32_bf16 v[196:199], a[212:215], v[96:99], v[196:199]
buffer_load_dwordx4 v[64:67], v31, s[48:51], s86 offen offset:2560 sc1
s_waitcnt lgkmcnt(10)
v_mfma_f32_16x16x32_bf16 v[200:203], a[216:219], v[96:99], v[200:203]
s_waitcnt lgkmcnt(8)
v_mfma_f32_16x16x32_bf16 v[204:207], a[220:223], v[96:99], v[204:207]
s_waitcnt vmcnt(9) lgkmcnt(6)
v_mfma_f32_16x16x32_bf16 v[192:195], a[224:227], v[100:103], v[192:195]
buffer_load_dwordx4 v[68:71], v29, s[48:51], s86 offen offset:2560 sc1
s_waitcnt lgkmcnt(4)
v_mfma_f32_16x16x32_bf16 v[196:199], a[228:231], v[100:103], v[196:199]
s_add_u32 s86, s86, 16384
s_waitcnt lgkmcnt(2)
v_mfma_f32_16x16x32_bf16 v[200:203], a[232:235], v[100:103], v[200:203]
s_waitcnt lgkmcnt(0)
v_mfma_f32_16x16x32_bf16 v[204:207], a[236:239], v[100:103], v[204:207]
s_waitcnt vmcnt(9)
v_mfma_f32_16x16x32_bf16 v[208:211], a[176:179], v[104:107], v[144:147]
buffer_load_dwordx4 v[72:75], v31, s[48:51], s86 offen offset:2560 sc1
v_fma_f32 v128, v192, v24, -v128
v_mfma_f32_16x16x32_bf16 v[212:215], a[180:183], v[104:107], v[148:151]
v_fma_f32 v129, v193, v24, -v129
v_fma_f32 v130, v194, v24, -v130
v_mfma_f32_16x16x32_bf16 v[216:219], a[184:187], v[104:107], v[152:155]
v_fma_f32 v131, v195, v24, -v131
v_mfma_f32_16x16x32_bf16 v[220:223], a[188:191], v[104:107], v[156:159]
ds_write_b128 v16, v[128:131] offset:0
v_fma_f32 v132, v196, v24, -v132
s_waitcnt vmcnt(9)
v_mfma_f32_16x16x32_bf16 v[208:211], a[192:195], v[108:111], v[208:211]
buffer_load_dwordx4 v[76:79], v29, s[48:51], s86 offen offset:2560 sc1
v_fma_f32 v133, v197, v24, -v133
v_mfma_f32_16x16x32_bf16 v[212:215], a[196:199], v[108:111], v[212:215]
v_fma_f32 v134, v198, v24, -v134
v_fma_f32 v135, v199, v24, -v135
v_mfma_f32_16x16x32_bf16 v[216:219], a[200:203], v[108:111], v[216:219]
ds_write_b128 v17, v[132:135] offset:0
v_mfma_f32_16x16x32_bf16 v[220:223], a[204:207], v[108:111], v[220:223]
v_fma_f32 v136, v200, v24, -v136
v_fma_f32 v137, v201, v24, -v137
s_waitcnt vmcnt(9)
v_mfma_f32_16x16x32_bf16 v[208:211], a[208:211], v[112:115], v[208:211]
v_fma_f32 v138, v202, v24, -v138
v_mfma_f32_16x16x32_bf16 v[212:215], a[212:215], v[112:115], v[212:215]
v_fma_f32 v139, v203, v24, -v139
ds_write_b128 v16, v[136:139] offset:128
v_mfma_f32_16x16x32_bf16 v[216:219], a[216:219], v[112:115], v[216:219]
v_fma_f32 v140, v204, v24, -v140
v_mfma_f32_16x16x32_bf16 v[220:223], a[220:223], v[112:115], v[220:223]
v_fma_f32 v141, v205, v24, -v141
v_fma_f32 v142, v206, v24, -v142
s_waitcnt vmcnt(8)
v_mfma_f32_16x16x32_bf16 v[208:211], a[224:227], v[116:119], v[208:211]
v_fma_f32 v143, v207, v24, -v143
v_mfma_f32_16x16x32_bf16 v[212:215], a[228:231], v[116:119], v[212:215]
ds_write_b128 v17, v[140:143] offset:128
v_mfma_f32_16x16x32_bf16 v[216:219], a[232:235], v[116:119], v[216:219]
v_mfma_f32_16x16x32_bf16 v[220:223], a[236:239], v[116:119], v[220:223]
s_waitcnt vmcnt(7)
v_mfma_f32_16x16x32_bf16 v[224:227], a[176:179], v[120:123], v[160:163]
s_nop 0
v_fma_f32 v144, v208, v26, -v144
v_mfma_f32_16x16x32_bf16 v[228:231], a[180:183], v[120:123], v[164:167]
v_fma_f32 v145, v209, v26, -v145
v_fma_f32 v146, v210, v26, -v146
v_mfma_f32_16x16x32_bf16 v[232:235], a[184:187], v[120:123], v[168:171]
v_fma_f32 v147, v211, v26, -v147
v_mfma_f32_16x16x32_bf16 v[236:239], a[188:191], v[120:123], v[172:175]
ds_write_b128 v16, v[144:147] offset:16384
v_fma_f32 v148, v212, v26, -v148
s_waitcnt vmcnt(6)
v_mfma_f32_16x16x32_bf16 v[224:227], a[192:195], v[124:127], v[224:227]
v_fma_f32 v149, v213, v26, -v149
v_mfma_f32_16x16x32_bf16 v[228:231], a[196:199], v[124:127], v[228:231]
v_fma_f32 v150, v214, v26, -v150
v_fma_f32 v151, v215, v26, -v151
v_mfma_f32_16x16x32_bf16 v[232:235], a[200:203], v[124:127], v[232:235]
ds_write_b128 v17, v[148:151] offset:16384
v_mfma_f32_16x16x32_bf16 v[236:239], a[204:207], v[124:127], v[236:239]
v_fma_f32 v152, v216, v26, -v152
v_fma_f32 v153, v217, v26, -v153
s_waitcnt vmcnt(5)
v_mfma_f32_16x16x32_bf16 v[224:227], a[208:211], v[56:59], v[224:227]
v_fma_f32 v154, v218, v26, -v154
v_mfma_f32_16x16x32_bf16 v[228:231], a[212:215], v[56:59], v[228:231]
v_fma_f32 v155, v219, v26, -v155
ds_write_b128 v16, v[152:155] offset:16512
v_mfma_f32_16x16x32_bf16 v[232:235], a[216:219], v[56:59], v[232:235]
v_fma_f32 v156, v220, v26, -v156
v_mfma_f32_16x16x32_bf16 v[236:239], a[220:223], v[56:59], v[236:239]
v_fma_f32 v157, v221, v26, -v157
v_fma_f32 v158, v222, v26, -v158
s_waitcnt vmcnt(4)
v_mfma_f32_16x16x32_bf16 v[224:227], a[224:227], v[60:63], v[224:227]
v_fma_f32 v159, v223, v26, -v159
v_mfma_f32_16x16x32_bf16 v[228:231], a[228:231], v[60:63], v[228:231]
ds_write_b128 v17, v[156:159] offset:16512
v_mfma_f32_16x16x32_bf16 v[232:235], a[232:235], v[60:63], v[232:235]
v_mfma_f32_16x16x32_bf16 v[236:239], a[236:239], v[60:63], v[236:239]
s_waitcnt lgkmcnt(0)
s_barrier
s_waitcnt vmcnt(3)
v_mfma_f32_16x16x32_bf16 v[240:243], a[176:179], v[64:67], v[176:179]
ds_read_b128 v[88:91], v20 offset:0
ds_read_b128 v[92:95], v21 offset:0
v_mfma_f32_16x16x32_bf16 v[244:247], a[180:183], v[64:67], v[180:183]
ds_read_b128 v[96:99], v20 offset:4096
ds_read_b128 v[100:103], v21 offset:4096
ds_read_b128 v[104:107], v20 offset:8192
v_mfma_f32_16x16x32_bf16 v[248:251], a[184:187], v[64:67], v[184:187]
ds_read_b128 v[108:111], v21 offset:8192
ds_read_b128 v[112:115], v20 offset:12288
v_mfma_f32_16x16x32_bf16 v[252:255], a[188:191], v[64:67], v[188:191]
ds_read_b128 v[116:119], v21 offset:12288
v_fma_f32 v160, v224, v36, -v160
v_fma_f32 v161, v225, v36, -v161
s_waitcnt vmcnt(2)
v_mfma_f32_16x16x32_bf16 v[240:243], a[192:195], v[68:71], v[240:243]
v_fma_f32 v162, v226, v36, -v162
v_fma_f32 v163, v227, v36, -v163
v_mfma_f32_16x16x32_bf16 v[244:247], a[196:199], v[68:71], v[244:247]
ds_write_b128 v16, v[160:163] offset:32768
v_fma_f32 v164, v228, v36, -v164
v_fma_f32 v165, v229, v36, -v165
v_mfma_f32_16x16x32_bf16 v[248:251], a[200:203], v[68:71], v[248:251]
v_fma_f32 v166, v230, v36, -v166
v_fma_f32 v167, v231, v36, -v167
v_mfma_f32_16x16x32_bf16 v[252:255], a[204:207], v[68:71], v[252:255]
ds_write_b128 v17, v[164:167] offset:32768
v_fma_f32 v168, v232, v36, -v168
v_fma_f32 v169, v233, v36, -v169
s_waitcnt vmcnt(1)
v_mfma_f32_16x16x32_bf16 v[240:243], a[208:211], v[72:75], v[240:243]
v_fma_f32 v170, v234, v36, -v170
v_fma_f32 v171, v235, v36, -v171
v_mfma_f32_16x16x32_bf16 v[244:247], a[212:215], v[72:75], v[244:247]
ds_write_b128 v16, v[168:171] offset:32896
v_fma_f32 v172, v236, v36, -v172
v_fma_f32 v173, v237, v36, -v173
v_mfma_f32_16x16x32_bf16 v[248:251], a[216:219], v[72:75], v[248:251]
v_fma_f32 v174, v238, v36, -v174
v_mfma_f32_16x16x32_bf16 v[252:255], a[220:223], v[72:75], v[252:255]
v_fma_f32 v175, v239, v36, -v175
ds_write_b128 v17, v[172:175] offset:32896
s_waitcnt vmcnt(0)
v_mfma_f32_16x16x32_bf16 v[240:243], a[224:227], v[76:79], v[240:243]
v_mfma_f32_16x16x32_bf16 v[244:247], a[228:231], v[76:79], v[244:247]
v_mfma_f32_16x16x32_bf16 v[248:251], a[232:235], v[76:79], v[248:251]
v_mfma_f32_16x16x32_bf16 v[252:255], a[236:239], v[76:79], v[252:255]
s_nop 4
v_pk_fma_f32 v[176:177], v[240:241], v[38:39], v[176:177] op_sel_hi:[1,0,1] neg_lo:[0,0,1] neg_hi:[0,0,1]
v_pk_fma_f32 v[178:179], v[242:243], v[38:39], v[178:179] op_sel_hi:[1,0,1] neg_lo:[0,0,1] neg_hi:[0,0,1]
ds_write_b128 v16, v[176:179] offset:49152
v_pk_fma_f32 v[180:181], v[244:245], v[38:39], v[180:181] op_sel_hi:[1,0,1] neg_lo:[0,0,1] neg_hi:[0,0,1]
v_pk_fma_f32 v[182:183], v[246:247], v[38:39], v[182:183] op_sel_hi:[1,0,1] neg_lo:[0,0,1] neg_hi:[0,0,1]
ds_write_b128 v17, v[180:183] offset:49152
v_pk_fma_f32 v[184:185], v[248:249], v[38:39], v[184:185] op_sel_hi:[1,0,1] neg_lo:[0,0,1] neg_hi:[0,0,1]
v_pk_fma_f32 v[186:187], v[250:251], v[38:39], v[186:187] op_sel_hi:[1,0,1] neg_lo:[0,0,1] neg_hi:[0,0,1]
ds_write_b128 v16, v[184:187] offset:49280
v_pk_fma_f32 v[188:189], v[252:253], v[38:39], v[188:189] op_sel_hi:[1,0,1] neg_lo:[0,0,1] neg_hi:[0,0,1]
v_pk_fma_f32 v[190:191], v[254:255], v[38:39], v[190:191] op_sel_hi:[1,0,1] neg_lo:[0,0,1] neg_hi:[0,0,1]
ds_write_b128 v17, v[188:191] offset:49280
s_waitcnt lgkmcnt(13)
v_pk_add_f32 v[88:89], v[88:89], v[96:97]
v_pk_add_f32 v[90:91], v[90:91], v[98:99]
s_waitcnt lgkmcnt(12)
v_pk_add_f32 v[92:93], v[92:93], v[100:101]
v_pk_add_f32 v[94:95], v[94:95], v[102:103]
s_waitcnt lgkmcnt(9)
v_pk_add_f32 v[104:105], v[104:105], v[112:113]
v_pk_add_f32 v[106:107], v[106:107], v[114:115]
s_waitcnt lgkmcnt(8)
v_pk_add_f32 v[108:109], v[108:109], v[116:117]
v_pk_add_f32 v[110:111], v[110:111], v[118:119]
s_waitcnt lgkmcnt(0)
s_barrier
ds_read_b128 v[56:59], v20 offset:32768
ds_read_b128 v[60:63], v21 offset:32768
ds_read_b128 v[64:67], v20 offset:36864
ds_read_b128 v[68:71], v21 offset:36864
ds_read_b128 v[72:75], v20 offset:40960
ds_read_b128 v[76:79], v21 offset:40960
ds_read_b128 v[80:83], v20 offset:45056
ds_read_b128 v[84:87], v21 offset:45056
v_pk_add_f32 v[88:89], v[88:89], v[104:105]
v_pk_add_f32 v[90:91], v[90:91], v[106:107]
v_pk_add_f32 v[92:93], v[92:93], v[108:109]
v_pk_add_f32 v[94:95], v[94:95], v[110:111]
v_cvt_pk_bf16_f32 v96, v88, v89
v_cvt_pk_bf16_f32 v97, v90, v91
v_cvt_pk_bf16_f32 v98, v92, v93
v_cvt_pk_bf16_f32 v99, v94, v95
buffer_store_dwordx4 v[96:99], v22, s[56:59], s66 offen sc1
s_waitcnt lgkmcnt(5)
v_pk_add_f32 v[56:57], v[56:57], v[64:65]
v_pk_add_f32 v[58:59], v[58:59], v[66:67]
s_waitcnt lgkmcnt(4)
v_pk_add_f32 v[60:61], v[60:61], v[68:69]
v_pk_add_f32 v[62:63], v[62:63], v[70:71]
s_waitcnt lgkmcnt(1)
v_pk_add_f32 v[72:73], v[72:73], v[80:81]
v_pk_add_f32 v[74:75], v[74:75], v[82:83]
s_waitcnt lgkmcnt(0)
v_pk_add_f32 v[76:77], v[76:77], v[84:85]
v_pk_add_f32 v[78:79], v[78:79], v[86:87]
v_pk_add_f32 v[56:57], v[56:57], v[72:73]
v_pk_add_f32 v[58:59], v[58:59], v[74:75]
v_pk_add_f32 v[60:61], v[60:61], v[76:77]
v_pk_add_f32 v[62:63], v[62:63], v[78:79]
v_cvt_pk_bf16_f32 v64, v56, v57
v_cvt_pk_bf16_f32 v65, v58, v59
v_cvt_pk_bf16_f32 v66, v60, v61
v_cvt_pk_bf16_f32 v67, v62, v63
buffer_store_dwordx4 v[64:67], v22, s[56:59], s67 offen sc1
s_endpgm
Lend:
s_endpgm
.fill (50432-(.-Lpc))/4, 4, 0xbf810000
Lpad:
s_endpgm
.section .rodata,"a"
.p2align 6
.amdhsa_kernel gated_mix__linear_kernel_hedgehog__glu_gated_geglu__prompt_kernel
  .amdhsa_next_free_vgpr 512
  .amdhsa_next_free_sgpr 102
  .amdhsa_accum_offset 256
  .amdhsa_group_segment_fixed_size 0
  .amdhsa_kernarg_size 96
  .amdhsa_user_sgpr_count 2
  .amdhsa_user_sgpr_kernarg_segment_ptr 1
  .amdhsa_system_sgpr_workgroup_id_x 1
  .amdhsa_float_denorm_mode_32 3
.end_amdhsa_kernel
```
